```python
import torch

def _softmax(x, axis=-1):
    return torch.softmax(x, dim=axis)

def _gelu(x):
    return torch.nn.functional.gelu(x, approximate='tanh')

def _silu(x):
    return torch.nn.functional.silu(x)

def _sigmoid(x):
    return torch.sigmoid(x)

def _layernorm(x, axis=-1, eps=1e-05):
    m = x.mean(dim=axis, keepdim=True)
    v = x.var(dim=axis, keepdim=True, unbiased=False)
    return (x - m) / torch.sqrt(v + eps)

def _scatter_add(tgt, idx, src, axis=0):
    return tgt.clone().index_add_(axis, idx, src)

def _segment_sum(src, seg, n):
    out = torch.zeros((n,) + src.shape[1:], dtype=src.dtype)
    return out.index_add_(0, seg, src)

def _pad(x, pw):
    flat = tuple((v for pair in reversed(pw) for v in pair))
    return torch.nn.functional.pad(x, flat)
kernel_name = 'adaLN_cond__gqa_block_cached__glu_gated_reglu__prompt'

def setup_inputs():

    _w = lambda a: (lambda t: t.to(torch.bfloat16) if t.is_floating_point() else t)(torch.as_tensor(a))

    def _A_setup():
        B, Sq, D = (1, 2048, 640)
        Hq, Hkv, Sk, Dh = (32, 32, 2048, 128)
        assert Hq % Hkv == 0, (Hq, Hkv)
        return {'x': _w((lambda *s: torch.randn(*s, dtype=torch.bfloat16) * 0.05)(B, Sq, D)), 'k_cache': _w((lambda *s: torch.randn(*s, dtype=torch.bfloat16) * 1.6)(B, Hkv, Sk, Dh)), 'v_cache': _w((lambda *s: torch.randn(*s, dtype=torch.bfloat16) * 0.8)(B, Hkv, Sk, Dh)), 'wq': _w((lambda *s: torch.randn(*s, dtype=torch.bfloat16) * 1.6)(D, Hq * Dh) * D ** (-0.5)), 'wo': _w((lambda *s: torch.randn(*s, dtype=torch.bfloat16) * 0.8)(Hq * Dh, D) * (Hq * Dh) ** (-0.5))}
    _A_in = _A_setup()

    def _B_setup():
        B, S, D, F = (1, 2048, 640, 1728)
        return {'x': _w((lambda *s: torch.randn(*s, dtype=torch.bfloat16) * 0.05)(B, S, D)), 'W_gate': _w((lambda *s: torch.randn(*s, dtype=torch.bfloat16) * 0.4)(D, F) * (2.0 / D) ** 0.5), 'W_up': _w((lambda *s: torch.randn(*s, dtype=torch.bfloat16) * 0.4)(D, F) * (2.0 / D) ** 0.5), 'W_down': _w((lambda *s: torch.randn(*s, dtype=torch.bfloat16) * 0.4)(F, D) * (1.0 / F) ** 0.5)}
    _B_in = _B_setup()
    return {'A_x': _A_in['x'], 'A_k_cache': _A_in['k_cache'], 'A_v_cache': _A_in['v_cache'], 'A_wq': _A_in['wq'], 'A_wo': _A_in['wo'], 'B_x': _B_in['x'], 'B_W_gate': _B_in['W_gate'], 'B_W_up': _B_in['W_up'], 'B_W_down': _B_in['W_down'], 'c': _w((lambda *s: torch.randn(*s, dtype=torch.bfloat16) * 0.2)(1, 640) * 8.0), 'w_mod': _w((lambda *s: torch.randn(*s, dtype=torch.bfloat16) * 0.2)(640, 6 * 640) * 640 ** (-0.5) * 8.0)}

def reference(A_x, A_k_cache, A_v_cache, A_wq, A_wo, B_x, B_W_gate, B_W_up, B_W_down, c, w_mod):

    def _A_ref(x, k_cache, v_cache, wq, wo):
        B, Sq, D = x.shape
        Hq, Dh = (32, 128)
        Hkv = k_cache.shape[1]
        rep = Hq // Hkv
        q = (lambda x, *d: x.permute(*d))((x @ wq).reshape(B, Sq, Hq, Dh), 0, 2, 1, 3)
        k = (lambda x, n, axis: torch.repeat_interleave(x, n, dim=axis))(k_cache, rep, axis=1)
        v = (lambda x, n, axis: torch.repeat_interleave(x, n, dim=axis))(v_cache, rep, axis=1)
        scores = torch.einsum('bhqd,bhkd->bhqk', q, k) * Dh ** (-0.5)
        p = _softmax(scores, axis=-1)
        o = torch.einsum('bhqk,bhkd->bhqd', p, v)
        return (lambda x, *d: x.permute(*d))(o, 0, 2, 1, 3).reshape(B, Sq, Hq * Dh) @ wo

    def _B_ref(x, W_gate, W_up, W_down):
        gate = torch.einsum('bsd,df->bsf', x, W_gate)
        up = torch.einsum('bsd,df->bsf', x, W_up)
        gate = gate * (lambda x, dt: x.to(dt))(gate > 0, gate.dtype)
        h = gate * up
        return torch.einsum('bsf,fd->bsd', h, W_down)
    x = A_x
    mod = (_silu(c) @ w_mod).reshape(c.shape[0], 6, 1, -1)
    sa, ca, ga, sb, cb, gb = (mod[:, 0].clone(), mod[:, 1].clone(), mod[:, 2].clone(), mod[:, 3].clone(), mod[:, 4].clone(), mod[:, 5].clone())
    h = _layernorm(x, axis=-1) * (1 + ca) + sa
    x = x + ga * _A_ref(h, A_k_cache, A_v_cache, A_wq, A_wo)
    h = _layernorm(x, axis=-1) * (1 + cb) + sb
    x = x + gb * _B_ref(h, B_W_gate, B_W_up, B_W_down)
    return x
```

```asm
; @launch grid=(256,1,1) block=(256,1,1) lds=163840
.amdgcn_target "amdgcn-amd-amdhsa--gfx950"
.text
.globl adaLN_cond__gqa_block_cached__glu_gated_reglu__prompt_kernel
.p2align 8
.type adaLN_cond__gqa_block_cached__glu_gated_reglu__prompt_kernel,@function
adaLN_cond__gqa_block_cached__glu_gated_reglu__prompt_kernel:
    s_cmp_ge_u32 s2, 256
    s_cbranch_scc1 Lend
    s_load_dwordx4 s[40:43], s[0:1], 96
    s_load_dwordx4 s[12:15], s[0:1], 72
    s_load_dwordx8 s[4:11], s[0:1], 0
    s_load_dwordx4 s[56:59], s[0:1], 48
    s_load_dwordx2 s[90:91], s[0:1], 32
    s_load_dwordx2 s[92:93], s[0:1], 64
    s_memrealtime s[46:47]
    s_getpc_b64 s[48:49]
    s_mov_b32 s50, 8192
    s_mov_b32 s51, 0x20000
    v_lshlrev_b32 v16, 7, v0
    s_andn2_b32 s48, s48, 127
    buffer_load_dwordx2 v[18:19], v16, s[48:51], 0 offen offset:0
    v_and_b32 v1, 63, v0
    v_lshrrev_b32 v2, 6, v0
    v_and_b32 v3, 15, v0
    v_bfe_u32 v4, v0, 4, 2
    v_bfe_u32 v5, v0, 2, 2
    v_and_b32 v6, 3, v0
    v_readfirstlane_b32 s28, v2
    v_and_b32 v12, 7, v0
    v_lshrrev_b32 v13, 3, v0
    v_mov_b32 v15, 0
    s_and_b32 s44, s2, 7
    s_lshl_b32 s44, s44, 2
    s_bfe_u32 s45, s2, 0x20003
    s_or_b32 s44, s44, s45
    s_lshr_b32 s45, s2, 5
    s_lshl_b32 s29, s28, 12
    v_lshlrev_b32 v7, 1, v4
    v_xor_b32 v8, v3, v7
    v_xor_b32 v9, 8, v8
    v_lshl_add_u32 v10, v2, 4, v4
    v_lshlrev_b32 v11, 13, v10
    v_lshl_add_u32 v238, v8, 4, v11
    v_lshl_add_u32 v239, v8, 4, v11
    v_add_u32 v239, 31744, v239
    v_lshl_add_u32 v240, v9, 4, v11
    v_add_u32 v240, 63488, v240
    v_lshl_add_u32 v241, v9, 4, v11
    v_add_u32 v241, 95232, v241
    v_lshlrev_b32 v11, 8, v10
    v_lshl_add_u32 v224, v8, 4, v11
    v_lshl_add_u32 v225, v9, 4, v11
    s_waitcnt lgkmcnt(0)
    s_mov_b32 s36, s40
    s_mov_b32 s37, s41
    s_mov_b32 s38, 256
    s_mov_b32 s39, 0x20000
    s_mov_b32 s52, s42
    s_mov_b32 s53, s43
    s_mov_b32 s54, 57671680
    s_mov_b32 s55, 0x20000
    s_mov_b32 s62, s46
    s_or_b32 s46, s46, 1
    s_or_b32 s47, s2, s28
    s_cmp_lg_u32 s47, 0
    s_cbranch_scc1 Lnn
    v_mov_b32 v14, s46
    buffer_store_dword v14, v15, s[36:39], 0 offen sc1
Lnn:
    s_lshl_b32 s46, s44, 8
    s_add_u32 s16, s10, s46
    s_addc_u32 s17, s11, 0
    s_sub_u32 s18, 5242880, s46
    s_mov_b32 s19, 0x20000
    s_mov_b32 s33, 0
    s_lshl_b32 s35, s2, 4
    s_add_u32 s35, s35, 48349184
    s_cmp_ge_u32 s2, 128
    s_cbranch_scc1 Lcons
    s_cmp_ge_u32 s2, 80
    s_cbranch_scc1 Lidle
    s_mov_b32 s20, s12
    s_mov_b32 s21, s13
    s_mov_b32 s22, 1280
    s_mov_b32 s23, 0x20000
    s_mov_b32 s24, s14
    s_mov_b32 s25, s15
    s_mov_b32 s26, 4915200
    s_mov_b32 s27, 0x20000
    s_mul_i32 s30, s2, 3277
    s_lshr_b32 s30, s30, 16
    s_mul_i32 s31, s30, 20
    s_sub_u32 s31, s2, s31
    s_sub_u32 s46, s2, 20
    s_cmp_ge_u32 s2, 40
    s_cselect_b32 s30, 0, s30
    s_cselect_b32 s31, s46, s31
    s_lshl_b32 s46, s31, 7
    s_mul_i32 s47, s30, 2457600
    s_add_u32 s46, s46, s47
    s_mul_i32 s47, s30, 640
    v_mul_u32_u24 v11, 7680, v13
    v_lshl_add_u32 v11, v12, 4, v11
    v_lshlrev_b32 v10, 1, v13
    buffer_load_ushort v96, v10, s[20:23], s47 offen offset:0
    buffer_load_ushort v97, v10, s[20:23], s47 offen offset:64
    buffer_load_ushort v98, v10, s[20:23], s47 offen offset:128
    buffer_load_ushort v99, v10, s[20:23], s47 offen offset:192
    buffer_load_ushort v100, v10, s[20:23], s47 offen offset:256
    buffer_load_ushort v101, v10, s[20:23], s47 offen offset:320
    buffer_load_ushort v102, v10, s[20:23], s47 offen offset:384
    buffer_load_ushort v103, v10, s[20:23], s47 offen offset:448
    buffer_load_ushort v104, v10, s[20:23], s47 offen offset:512
    buffer_load_ushort v105, v10, s[20:23], s47 offen offset:576
    buffer_load_ushort v106, v10, s[20:23], s47 offen offset:640
    buffer_load_ushort v107, v10, s[20:23], s47 offen offset:704
    buffer_load_ushort v108, v10, s[20:23], s47 offen offset:768
    buffer_load_ushort v109, v10, s[20:23], s47 offen offset:832
    buffer_load_ushort v110, v10, s[20:23], s47 offen offset:896
    buffer_load_ushort v111, v10, s[20:23], s47 offen offset:960
    buffer_load_ushort v112, v10, s[20:23], s47 offen offset:1024
    buffer_load_ushort v113, v10, s[20:23], s47 offen offset:1088
    buffer_load_ushort v114, v10, s[20:23], s47 offen offset:1152
    buffer_load_ushort v115, v10, s[20:23], s47 offen offset:1216
    buffer_load_dwordx4 v[16:19], v11, s[24:27], s46 offen nt
    s_add_u32 s46, s46, 245760
    buffer_load_dwordx4 v[20:23], v11, s[24:27], s46 offen nt
    s_add_u32 s46, s46, 245760
    buffer_load_dwordx4 v[24:27], v11, s[24:27], s46 offen nt
    s_add_u32 s46, s46, 245760
    buffer_load_dwordx4 v[28:31], v11, s[24:27], s46 offen nt
    s_add_u32 s46, s46, 245760
    buffer_load_dwordx4 v[32:35], v11, s[24:27], s46 offen nt
    s_add_u32 s46, s46, 245760
    buffer_load_dwordx4 v[36:39], v11, s[24:27], s46 offen nt
    s_add_u32 s46, s46, 245760
    buffer_load_dwordx4 v[40:43], v11, s[24:27], s46 offen nt
    s_add_u32 s46, s46, 245760
    buffer_load_dwordx4 v[44:47], v11, s[24:27], s46 offen nt
    s_add_u32 s46, s46, 245760
    buffer_load_dwordx4 v[48:51], v11, s[24:27], s46 offen nt
    s_add_u32 s46, s46, 245760
    buffer_load_dwordx4 v[52:55], v11, s[24:27], s46 offen nt
    s_add_u32 s46, s46, 245760
    s_cmp_lt_u32 s2, 40
    s_cbranch_scc1 Lhalf
    buffer_load_dwordx4 v[56:59], v11, s[24:27], s46 offen nt
    s_add_u32 s46, s46, 245760
    buffer_load_dwordx4 v[60:63], v11, s[24:27], s46 offen nt
    s_add_u32 s46, s46, 245760
    buffer_load_dwordx4 v[64:67], v11, s[24:27], s46 offen nt
    s_add_u32 s46, s46, 245760
    buffer_load_dwordx4 v[68:71], v11, s[24:27], s46 offen nt
    s_add_u32 s46, s46, 245760
    buffer_load_dwordx4 v[72:75], v11, s[24:27], s46 offen nt
    s_add_u32 s46, s46, 245760
    buffer_load_dwordx4 v[76:79], v11, s[24:27], s46 offen nt
    s_add_u32 s46, s46, 245760
    buffer_load_dwordx4 v[80:83], v11, s[24:27], s46 offen nt
    s_add_u32 s46, s46, 245760
    buffer_load_dwordx4 v[84:87], v11, s[24:27], s46 offen nt
    s_add_u32 s46, s46, 245760
    buffer_load_dwordx4 v[88:91], v11, s[24:27], s46 offen nt
    s_add_u32 s46, s46, 245760
    buffer_load_dwordx4 v[92:95], v11, s[24:27], s46 offen nt
    s_add_u32 s46, s46, 245760
Lhalf:
    s_waitcnt vmcnt(10)
    s_mov_b32 s46, 0xbfb8aa3b
    v_lshlrev_b32 v96, 16, v96
    v_lshlrev_b32 v97, 16, v97
    v_lshlrev_b32 v98, 16, v98
    v_lshlrev_b32 v99, 16, v99
    v_lshlrev_b32 v100, 16, v100
    v_lshlrev_b32 v101, 16, v101
    v_lshlrev_b32 v102, 16, v102
    v_lshlrev_b32 v103, 16, v103
    v_lshlrev_b32 v104, 16, v104
    v_lshlrev_b32 v105, 16, v105
    v_mul_f32 v144, s46, v96
    v_mul_f32 v145, s46, v97
    v_mul_f32 v146, s46, v98
    v_mul_f32 v147, s46, v99
    v_mul_f32 v148, s46, v100
    v_mul_f32 v149, s46, v101
    v_mul_f32 v150, s46, v102
    v_mul_f32 v151, s46, v103
    v_mul_f32 v152, s46, v104
    v_mul_f32 v153, s46, v105
    v_exp_f32 v144, v144
    v_exp_f32 v145, v145
    v_exp_f32 v146, v146
    v_exp_f32 v147, v147
    v_exp_f32 v148, v148
    v_exp_f32 v149, v149
    v_exp_f32 v150, v150
    v_exp_f32 v151, v151
    v_exp_f32 v152, v152
    v_exp_f32 v153, v153
    v_add_f32 v144, 1.0, v144
    v_add_f32 v145, 1.0, v145
    v_add_f32 v146, 1.0, v146
    v_add_f32 v147, 1.0, v147
    v_add_f32 v148, 1.0, v148
    v_add_f32 v149, 1.0, v149
    v_add_f32 v150, 1.0, v150
    v_add_f32 v151, 1.0, v151
    v_add_f32 v152, 1.0, v152
    v_add_f32 v153, 1.0, v153
    v_rcp_f32 v144, v144
    v_rcp_f32 v145, v145
    v_rcp_f32 v146, v146
    v_rcp_f32 v147, v147
    v_rcp_f32 v148, v148
    v_rcp_f32 v149, v149
    v_rcp_f32 v150, v150
    v_rcp_f32 v151, v151
    v_rcp_f32 v152, v152
    v_rcp_f32 v153, v153
    v_mul_f32 v144, v144, v96
    v_mul_f32 v145, v145, v97
    v_mul_f32 v146, v146, v98
    v_mul_f32 v147, v147, v99
    v_mul_f32 v148, v148, v100
    v_mul_f32 v149, v149, v101
    v_mul_f32 v150, v150, v102
    v_mul_f32 v151, v151, v103
    v_mul_f32 v152, v152, v104
    v_mul_f32 v153, v153, v105
    v_cvt_pk_bf16_f32 v96, v144, 0
    v_cvt_pk_bf16_f32 v116, 0, v144
    v_cvt_pk_bf16_f32 v97, v145, 0
    v_cvt_pk_bf16_f32 v117, 0, v145
    v_cvt_pk_bf16_f32 v98, v146, 0
    v_cvt_pk_bf16_f32 v118, 0, v146
    v_cvt_pk_bf16_f32 v99, v147, 0
    v_cvt_pk_bf16_f32 v119, 0, v147
    v_cvt_pk_bf16_f32 v100, v148, 0
    v_cvt_pk_bf16_f32 v120, 0, v148
    v_cvt_pk_bf16_f32 v101, v149, 0
    v_cvt_pk_bf16_f32 v121, 0, v149
    v_cvt_pk_bf16_f32 v102, v150, 0
    v_cvt_pk_bf16_f32 v122, 0, v150
    v_cvt_pk_bf16_f32 v103, v151, 0
    v_cvt_pk_bf16_f32 v123, 0, v151
    v_cvt_pk_bf16_f32 v104, v152, 0
    v_cvt_pk_bf16_f32 v124, 0, v152
    v_cvt_pk_bf16_f32 v105, v153, 0
    v_cvt_pk_bf16_f32 v125, 0, v153
    s_cmp_lt_u32 s2, 40
    s_cbranch_scc1 Lsil
    v_lshlrev_b32 v106, 16, v106
    v_lshlrev_b32 v107, 16, v107
    v_lshlrev_b32 v108, 16, v108
    v_lshlrev_b32 v109, 16, v109
    v_lshlrev_b32 v110, 16, v110
    v_lshlrev_b32 v111, 16, v111
    v_lshlrev_b32 v112, 16, v112
    v_lshlrev_b32 v113, 16, v113
    v_lshlrev_b32 v114, 16, v114
    v_lshlrev_b32 v115, 16, v115
    v_mul_f32 v154, s46, v106
    v_mul_f32 v155, s46, v107
    v_mul_f32 v156, s46, v108
    v_mul_f32 v157, s46, v109
    v_mul_f32 v158, s46, v110
    v_mul_f32 v159, s46, v111
    v_mul_f32 v160, s46, v112
    v_mul_f32 v161, s46, v113
    v_mul_f32 v162, s46, v114
    v_mul_f32 v163, s46, v115
    v_exp_f32 v154, v154
    v_exp_f32 v155, v155
    v_exp_f32 v156, v156
    v_exp_f32 v157, v157
    v_exp_f32 v158, v158
    v_exp_f32 v159, v159
    v_exp_f32 v160, v160
    v_exp_f32 v161, v161
    v_exp_f32 v162, v162
    v_exp_f32 v163, v163
    v_add_f32 v154, 1.0, v154
    v_add_f32 v155, 1.0, v155
    v_add_f32 v156, 1.0, v156
    v_add_f32 v157, 1.0, v157
    v_add_f32 v158, 1.0, v158
    v_add_f32 v159, 1.0, v159
    v_add_f32 v160, 1.0, v160
    v_add_f32 v161, 1.0, v161
    v_add_f32 v162, 1.0, v162
    v_add_f32 v163, 1.0, v163
    v_rcp_f32 v154, v154
    v_rcp_f32 v155, v155
    v_rcp_f32 v156, v156
    v_rcp_f32 v157, v157
    v_rcp_f32 v158, v158
    v_rcp_f32 v159, v159
    v_rcp_f32 v160, v160
    v_rcp_f32 v161, v161
    v_rcp_f32 v162, v162
    v_rcp_f32 v163, v163
    v_mul_f32 v154, v154, v106
    v_mul_f32 v155, v155, v107
    v_mul_f32 v156, v156, v108
    v_mul_f32 v157, v157, v109
    v_mul_f32 v158, v158, v110
    v_mul_f32 v159, v159, v111
    v_mul_f32 v160, v160, v112
    v_mul_f32 v161, v161, v113
    v_mul_f32 v162, v162, v114
    v_mul_f32 v163, v163, v115
    v_cvt_pk_bf16_f32 v106, v154, 0
    v_cvt_pk_bf16_f32 v126, 0, v154
    v_cvt_pk_bf16_f32 v107, v155, 0
    v_cvt_pk_bf16_f32 v127, 0, v155
    v_cvt_pk_bf16_f32 v108, v156, 0
    v_cvt_pk_bf16_f32 v128, 0, v156
    v_cvt_pk_bf16_f32 v109, v157, 0
    v_cvt_pk_bf16_f32 v129, 0, v157
    v_cvt_pk_bf16_f32 v110, v158, 0
    v_cvt_pk_bf16_f32 v130, 0, v158
    v_cvt_pk_bf16_f32 v111, v159, 0
    v_cvt_pk_bf16_f32 v131, 0, v159
    v_cvt_pk_bf16_f32 v112, v160, 0
    v_cvt_pk_bf16_f32 v132, 0, v160
    v_cvt_pk_bf16_f32 v113, v161, 0
    v_cvt_pk_bf16_f32 v133, 0, v161
    v_cvt_pk_bf16_f32 v114, v162, 0
    v_cvt_pk_bf16_f32 v134, 0, v162
    v_cvt_pk_bf16_f32 v115, v163, 0
    v_cvt_pk_bf16_f32 v135, 0, v163
Lsil:
    s_waitcnt vmcnt(0)
    buffer_load_dword v14, v15, s[36:39], 0 offen sc1
    v_dot2_f32_bf16 v136, v16, v96, 0
    v_dot2_f32_bf16 v137, v16, v116, 0
    v_dot2_f32_bf16 v138, v17, v96, 0
    v_dot2_f32_bf16 v139, v17, v116, 0
    v_dot2_f32_bf16 v140, v18, v96, 0
    v_dot2_f32_bf16 v141, v18, v116, 0
    v_dot2_f32_bf16 v142, v19, v96, 0
    v_dot2_f32_bf16 v143, v19, v116, 0
    v_dot2_f32_bf16 v136, v20, v97, v136
    v_dot2_f32_bf16 v137, v20, v117, v137
    v_dot2_f32_bf16 v138, v21, v97, v138
    v_dot2_f32_bf16 v139, v21, v117, v139
    v_dot2_f32_bf16 v140, v22, v97, v140
    v_dot2_f32_bf16 v141, v22, v117, v141
    v_dot2_f32_bf16 v142, v23, v97, v142
    v_dot2_f32_bf16 v143, v23, v117, v143
    v_dot2_f32_bf16 v136, v24, v98, v136
    v_dot2_f32_bf16 v137, v24, v118, v137
    v_dot2_f32_bf16 v138, v25, v98, v138
    v_dot2_f32_bf16 v139, v25, v118, v139
    v_dot2_f32_bf16 v140, v26, v98, v140
    v_dot2_f32_bf16 v141, v26, v118, v141
    v_dot2_f32_bf16 v142, v27, v98, v142
    v_dot2_f32_bf16 v143, v27, v118, v143
    v_dot2_f32_bf16 v136, v28, v99, v136
    v_dot2_f32_bf16 v137, v28, v119, v137
    v_dot2_f32_bf16 v138, v29, v99, v138
    v_dot2_f32_bf16 v139, v29, v119, v139
    v_dot2_f32_bf16 v140, v30, v99, v140
    v_dot2_f32_bf16 v141, v30, v119, v141
    v_dot2_f32_bf16 v142, v31, v99, v142
    v_dot2_f32_bf16 v143, v31, v119, v143
    v_dot2_f32_bf16 v136, v32, v100, v136
    v_dot2_f32_bf16 v137, v32, v120, v137
    v_dot2_f32_bf16 v138, v33, v100, v138
    v_dot2_f32_bf16 v139, v33, v120, v139
    v_dot2_f32_bf16 v140, v34, v100, v140
    v_dot2_f32_bf16 v141, v34, v120, v141
    v_dot2_f32_bf16 v142, v35, v100, v142
    v_dot2_f32_bf16 v143, v35, v120, v143
    v_dot2_f32_bf16 v136, v36, v101, v136
    v_dot2_f32_bf16 v137, v36, v121, v137
    v_dot2_f32_bf16 v138, v37, v101, v138
    v_dot2_f32_bf16 v139, v37, v121, v139
    v_dot2_f32_bf16 v140, v38, v101, v140
    v_dot2_f32_bf16 v141, v38, v121, v141
    v_dot2_f32_bf16 v142, v39, v101, v142
    v_dot2_f32_bf16 v143, v39, v121, v143
    v_dot2_f32_bf16 v136, v40, v102, v136
    v_dot2_f32_bf16 v137, v40, v122, v137
    v_dot2_f32_bf16 v138, v41, v102, v138
    v_dot2_f32_bf16 v139, v41, v122, v139
    v_dot2_f32_bf16 v140, v42, v102, v140
    v_dot2_f32_bf16 v141, v42, v122, v141
    v_dot2_f32_bf16 v142, v43, v102, v142
    v_dot2_f32_bf16 v143, v43, v122, v143
    v_dot2_f32_bf16 v136, v44, v103, v136
    v_dot2_f32_bf16 v137, v44, v123, v137
    v_dot2_f32_bf16 v138, v45, v103, v138
    v_dot2_f32_bf16 v139, v45, v123, v139
    v_dot2_f32_bf16 v140, v46, v103, v140
    v_dot2_f32_bf16 v141, v46, v123, v141
    v_dot2_f32_bf16 v142, v47, v103, v142
    v_dot2_f32_bf16 v143, v47, v123, v143
    v_dot2_f32_bf16 v136, v48, v104, v136
    v_dot2_f32_bf16 v137, v48, v124, v137
    v_dot2_f32_bf16 v138, v49, v104, v138
    v_dot2_f32_bf16 v139, v49, v124, v139
    v_dot2_f32_bf16 v140, v50, v104, v140
    v_dot2_f32_bf16 v141, v50, v124, v141
    v_dot2_f32_bf16 v142, v51, v104, v142
    v_dot2_f32_bf16 v143, v51, v124, v143
    v_dot2_f32_bf16 v136, v52, v105, v136
    v_dot2_f32_bf16 v137, v52, v125, v137
    v_dot2_f32_bf16 v138, v53, v105, v138
    v_dot2_f32_bf16 v139, v53, v125, v139
    v_dot2_f32_bf16 v140, v54, v105, v140
    v_dot2_f32_bf16 v141, v54, v125, v141
    v_dot2_f32_bf16 v142, v55, v105, v142
    v_dot2_f32_bf16 v143, v55, v125, v143
    s_cmp_lt_u32 s2, 40
    s_cbranch_scc1 Lred
    v_dot2_f32_bf16 v136, v56, v106, v136
    v_dot2_f32_bf16 v137, v56, v126, v137
    v_dot2_f32_bf16 v138, v57, v106, v138
    v_dot2_f32_bf16 v139, v57, v126, v139
    v_dot2_f32_bf16 v140, v58, v106, v140
    v_dot2_f32_bf16 v141, v58, v126, v141
    v_dot2_f32_bf16 v142, v59, v106, v142
    v_dot2_f32_bf16 v143, v59, v126, v143
    v_dot2_f32_bf16 v136, v60, v107, v136
    v_dot2_f32_bf16 v137, v60, v127, v137
    v_dot2_f32_bf16 v138, v61, v107, v138
    v_dot2_f32_bf16 v139, v61, v127, v139
    v_dot2_f32_bf16 v140, v62, v107, v140
    v_dot2_f32_bf16 v141, v62, v127, v141
    v_dot2_f32_bf16 v142, v63, v107, v142
    v_dot2_f32_bf16 v143, v63, v127, v143
    v_dot2_f32_bf16 v136, v64, v108, v136
    v_dot2_f32_bf16 v137, v64, v128, v137
    v_dot2_f32_bf16 v138, v65, v108, v138
    v_dot2_f32_bf16 v139, v65, v128, v139
    v_dot2_f32_bf16 v140, v66, v108, v140
    v_dot2_f32_bf16 v141, v66, v128, v141
    v_dot2_f32_bf16 v142, v67, v108, v142
    v_dot2_f32_bf16 v143, v67, v128, v143
    v_dot2_f32_bf16 v136, v68, v109, v136
    v_dot2_f32_bf16 v137, v68, v129, v137
    v_dot2_f32_bf16 v138, v69, v109, v138
    v_dot2_f32_bf16 v139, v69, v129, v139
    v_dot2_f32_bf16 v140, v70, v109, v140
    v_dot2_f32_bf16 v141, v70, v129, v141
    v_dot2_f32_bf16 v142, v71, v109, v142
    v_dot2_f32_bf16 v143, v71, v129, v143
    v_dot2_f32_bf16 v136, v72, v110, v136
    v_dot2_f32_bf16 v137, v72, v130, v137
    v_dot2_f32_bf16 v138, v73, v110, v138
    v_dot2_f32_bf16 v139, v73, v130, v139
    v_dot2_f32_bf16 v140, v74, v110, v140
    v_dot2_f32_bf16 v141, v74, v130, v141
    v_dot2_f32_bf16 v142, v75, v110, v142
    v_dot2_f32_bf16 v143, v75, v130, v143
    v_dot2_f32_bf16 v136, v76, v111, v136
    v_dot2_f32_bf16 v137, v76, v131, v137
    v_dot2_f32_bf16 v138, v77, v111, v138
    v_dot2_f32_bf16 v139, v77, v131, v139
    v_dot2_f32_bf16 v140, v78, v111, v140
    v_dot2_f32_bf16 v141, v78, v131, v141
    v_dot2_f32_bf16 v142, v79, v111, v142
    v_dot2_f32_bf16 v143, v79, v131, v143
    v_dot2_f32_bf16 v136, v80, v112, v136
    v_dot2_f32_bf16 v137, v80, v132, v137
    v_dot2_f32_bf16 v138, v81, v112, v138
    v_dot2_f32_bf16 v139, v81, v132, v139
    v_dot2_f32_bf16 v140, v82, v112, v140
    v_dot2_f32_bf16 v141, v82, v132, v141
    v_dot2_f32_bf16 v142, v83, v112, v142
    v_dot2_f32_bf16 v143, v83, v132, v143
    v_dot2_f32_bf16 v136, v84, v113, v136
    v_dot2_f32_bf16 v137, v84, v133, v137
    v_dot2_f32_bf16 v138, v85, v113, v138
    v_dot2_f32_bf16 v139, v85, v133, v139
    v_dot2_f32_bf16 v140, v86, v113, v140
    v_dot2_f32_bf16 v141, v86, v133, v141
    v_dot2_f32_bf16 v142, v87, v113, v142
    v_dot2_f32_bf16 v143, v87, v133, v143
    v_dot2_f32_bf16 v136, v88, v114, v136
    v_dot2_f32_bf16 v137, v88, v134, v137
    v_dot2_f32_bf16 v138, v89, v114, v138
    v_dot2_f32_bf16 v139, v89, v134, v139
    v_dot2_f32_bf16 v140, v90, v114, v140
    v_dot2_f32_bf16 v141, v90, v134, v141
    v_dot2_f32_bf16 v142, v91, v114, v142
    v_dot2_f32_bf16 v143, v91, v134, v143
    v_dot2_f32_bf16 v136, v92, v115, v136
    v_dot2_f32_bf16 v137, v92, v135, v137
    v_dot2_f32_bf16 v138, v93, v115, v138
    v_dot2_f32_bf16 v139, v93, v135, v139
    v_dot2_f32_bf16 v140, v94, v115, v140
    v_dot2_f32_bf16 v141, v94, v135, v141
    v_dot2_f32_bf16 v142, v95, v115, v142
    v_dot2_f32_bf16 v143, v95, v135, v143
Lred:
    s_nop 2
    v_add_f32_dpp v136, v136, v136 row_ror:8 row_mask:0xf bank_mask:0xf
    v_add_f32_dpp v137, v137, v137 row_ror:8 row_mask:0xf bank_mask:0xf
    v_add_f32_dpp v138, v138, v138 row_ror:8 row_mask:0xf bank_mask:0xf
    v_add_f32_dpp v139, v139, v139 row_ror:8 row_mask:0xf bank_mask:0xf
    v_add_f32_dpp v140, v140, v140 row_ror:8 row_mask:0xf bank_mask:0xf
    v_add_f32_dpp v141, v141, v141 row_ror:8 row_mask:0xf bank_mask:0xf
    v_add_f32_dpp v142, v142, v142 row_ror:8 row_mask:0xf bank_mask:0xf
    v_add_f32_dpp v143, v143, v143 row_ror:8 row_mask:0xf bank_mask:0xf
    v_permlane32_swap_b32 v136, v140
    v_permlane32_swap_b32 v137, v141
    v_permlane32_swap_b32 v138, v142
    v_permlane32_swap_b32 v139, v143
    v_add_f32 v136, v136, v140
    v_add_f32 v137, v137, v141
    v_add_f32 v138, v138, v142
    v_add_f32 v139, v139, v143
    s_nop 0
    v_permlane16_swap_b32 v136, v138
    v_permlane16_swap_b32 v137, v139
    v_add_f32 v136, v136, v138
    v_add_f32 v137, v137, v139
    v_lshlrev_b32 v11, 8, v2
    v_lshl_add_u32 v11, v12, 5, v11
    v_lshl_add_u32 v11, v4, 3, v11
    v_add_u32 v11, 147456, v11
    ds_write_b64 v11, v[136:137]
    v_lshlrev_b32 v10, 2, v1
    v_add_u32 v11, 147456, v10
Ln1:
    s_waitcnt vmcnt(0)
    v_readfirstlane_b32 s3, v14
    s_add_u32 s33, s33, 1
    s_cmp_gt_u32 s33, 0x10000
    s_cbranch_scc1 Ln1_ok
    s_cmp_eq_u32 s3, 0
    s_cbranch_scc1 Ln1_re
    s_sub_u32 s63, s62, s3
    s_cmp_lt_i32 s63, 4000
    s_cbranch_scc1 Ln1_ok
    s_cmp_gt_u32 s33, 0x1000
    s_cbranch_scc1 Ln1_ok
Ln1_re:
    buffer_load_dword v14, v15, s[36:39], 0 offen sc1
    s_branch Ln1
Ln1_ok:
    s_waitcnt lgkmcnt(0)
    s_barrier
    s_cmp_lg_u32 s28, 0
    s_cbranch_scc1 Lwq
    ds_read_b32 v16, v11 offset:0
    ds_read_b32 v17, v11 offset:256
    ds_read_b32 v18, v11 offset:512
    ds_read_b32 v19, v11 offset:768
    s_waitcnt lgkmcnt(0)
    v_add_f32 v16, v16, v17
    v_add_f32 v18, v18, v19
    v_add_f32 v16, v16, v18
    s_cmp_ge_u32 s2, 40
    s_cbranch_scc1 Lextra
    s_lshl_b32 s46, s31, 9
    s_mul_i32 s47, s30, 10240
    s_add_u32 s46, s46, s47
    s_add_u32 s46, s46, 2818048
    v_mov_b32 v17, s3
    v_lshlrev_b32 v10, 3, v1
    buffer_store_dwordx2 v[16:17], v10, s[52:55], s46 offen sc1
    s_branch Lwq
Lextra:
    v_cvt_pk_bf16_f32 v16, 0, v16
    v_add_f32 v17, 1.0, v16
    v_cvt_pk_bf16_f32 v17, 0, v17
    s_lshl_b32 s46, s31, 8
    s_add_u32 s46, s46, 2621440
    s_cmp_ge_u32 s31, 40
    s_cselect_b32 s30, 1, 0
    s_cmp_lt_u32 s31, 50
    s_cselect_b32 s30, s30, 0
    s_cmp_eq_u32 s30, 1
    s_cselect_b64 vcc, -1, 0
    v_cndmask_b32 v16, v16, v17, vcc
    buffer_store_dword v16, v10, s[52:55], s46 offen sc1
    s_cmp_lt_u32 s31, 30
    s_cbranch_scc1 Lpub
    s_cmp_ge_u32 s31, 50
    s_cbranch_scc1 Lpub
    s_sub_u32 s46, s31, 30
    s_sub_u32 s47, s31, 40
    s_cmp_eq_u32 s30, 1
    s_cselect_b32 s46, s47, s46
    s_cselect_b32 s47, 0, 16
    s_lshl_b32 s46, s46, 11
    s_add_u32 s46, s46, s47
    s_add_u32 s46, s46, 2637824
    v_lshrrev_b32 v12, 5, v0
    v_lshlrev_b32 v12, 10, v12
    v_lshl_add_u32 v12, v5, 8, v12
    v_bfe_u32 v13, v0, 4, 1
    v_lshl_add_u32 v12, v13, 3, v12
    v_lshl_add_u32 v12, v6, 1, v12
    buffer_store_short_d16_hi v16, v12, s[52:55], s46 offen sc1
Lpub:
    v_mov_b32 v14, s3
    s_waitcnt vmcnt(0)
    buffer_store_dword v14, v15, s[52:55], s35 offen sc1
    s_branch Lwq
Lidle:
    s_mov_b32 s50, Lwarm_end-adaLN_cond__gqa_block_cached__glu_gated_reglu__prompt_kernel-64
    s_mov_b32 s46, 8192
    s_mov_b32 s47, 40960
    buffer_load_dwordx2 v[18:19], v16, s[48:51], s46 offen offset:0
    buffer_load_dwordx2 v[18:19], v16, s[48:51], s47 offen offset:0
    buffer_load_dword v14, v15, s[36:39], 0 offen sc1
Ln2:
    s_waitcnt vmcnt(0)
    v_readfirstlane_b32 s3, v14
    s_add_u32 s33, s33, 1
    s_cmp_gt_u32 s33, 0x10000
    s_cbranch_scc1 Ln2_ok
    s_cmp_eq_u32 s3, 0
    s_cbranch_scc1 Ln2_re
    s_sub_u32 s63, s62, s3
    s_cmp_lt_i32 s63, 4000
    s_cbranch_scc1 Ln2_ok
    s_cmp_gt_u32 s33, 0x1000
    s_cbranch_scc1 Ln2_ok
Ln2_re:
    buffer_load_dword v14, v15, s[36:39], 0 offen sc1
    s_branch Ln2
Ln2_ok:
Lwq:
    s_add_u32 m0, s29, 0
    s_mov_b32 s47, 0
    buffer_load_dwordx4 v238, s[16:19], s47 offen offset:0 nt lds
    buffer_load_dwordx4 v239, s[16:19], s47 offen offset:1024 nt lds
    buffer_load_dwordx4 v240, s[16:19], s47 offen offset:2048 nt lds
    buffer_load_dwordx4 v241, s[16:19], s47 offen offset:3072 nt lds
    s_add_u32 m0, s29, 16384
    s_mov_b32 s47, 524288
    buffer_load_dwordx4 v238, s[16:19], s47 offen offset:0 nt lds
    buffer_load_dwordx4 v239, s[16:19], s47 offen offset:1024 nt lds
    buffer_load_dwordx4 v240, s[16:19], s47 offen offset:2048 nt lds
    buffer_load_dwordx4 v241, s[16:19], s47 offen offset:3072 nt lds
    s_add_u32 m0, s29, 32768
    s_mov_b32 s47, 1048576
    buffer_load_dwordx4 v238, s[16:19], s47 offen offset:0 nt lds
    buffer_load_dwordx4 v239, s[16:19], s47 offen offset:1024 nt lds
    buffer_load_dwordx4 v240, s[16:19], s47 offen offset:2048 nt lds
    buffer_load_dwordx4 v241, s[16:19], s47 offen offset:3072 nt lds
    s_add_u32 m0, s29, 49152
    s_mov_b32 s47, 1572864
    buffer_load_dwordx4 v238, s[16:19], s47 offen offset:0 nt lds
    buffer_load_dwordx4 v239, s[16:19], s47 offen offset:1024 nt lds
    buffer_load_dwordx4 v240, s[16:19], s47 offen offset:2048 nt lds
    buffer_load_dwordx4 v241, s[16:19], s47 offen offset:3072 nt lds
    s_add_u32 m0, s29, 65536
    s_mov_b32 s47, 2097152
    buffer_load_dwordx4 v238, s[16:19], s47 offen offset:0 nt lds
    buffer_load_dwordx4 v239, s[16:19], s47 offen offset:1024 nt lds
    buffer_load_dwordx4 v240, s[16:19], s47 offen offset:2048 nt lds
    buffer_load_dwordx4 v241, s[16:19], s47 offen offset:3072 nt lds
    s_add_u32 m0, s29, 81920
    s_mov_b32 s47, 2621440
    buffer_load_dwordx4 v238, s[16:19], s47 offen offset:0 nt lds
    buffer_load_dwordx4 v239, s[16:19], s47 offen offset:1024 nt lds
    buffer_load_dwordx4 v240, s[16:19], s47 offen offset:2048 nt lds
    buffer_load_dwordx4 v241, s[16:19], s47 offen offset:3072 nt lds
    s_add_u32 m0, s29, 98304
    s_mov_b32 s47, 3145728
    buffer_load_dwordx4 v238, s[16:19], s47 offen offset:0 nt lds
    buffer_load_dwordx4 v239, s[16:19], s47 offen offset:1024 nt lds
    buffer_load_dwordx4 v240, s[16:19], s47 offen offset:2048 nt lds
    buffer_load_dwordx4 v241, s[16:19], s47 offen offset:3072 nt lds
    s_add_u32 m0, s29, 114688
    s_mov_b32 s47, 3670016
    buffer_load_dwordx4 v238, s[16:19], s47 offen offset:0 nt lds
    buffer_load_dwordx4 v239, s[16:19], s47 offen offset:1024 nt lds
    buffer_load_dwordx4 v240, s[16:19], s47 offen offset:2048 nt lds
    buffer_load_dwordx4 v241, s[16:19], s47 offen offset:3072 nt lds
    s_add_u32 m0, s29, 131072
    s_mov_b32 s47, 4194304
    buffer_load_dwordx4 v238, s[16:19], s47 offen offset:0 nt lds
    buffer_load_dwordx4 v239, s[16:19], s47 offen offset:1024 nt lds
    buffer_load_dwordx4 v240, s[16:19], s47 offen offset:2048 nt lds
    buffer_load_dwordx4 v241, s[16:19], s47 offen offset:3072 nt lds
    s_branch Ljoin
Lcons:
    s_mov_b32 s20, s4
    s_mov_b32 s21, s5
    s_mov_b32 s22, 2621440
    s_mov_b32 s23, 0x20000
    s_sub_u32 s31, s2, 128
    s_mul_i32 s31, s31, 20480
    v_mul_u32_u24 v11, 1280, v3
    v_mul_u32_u24 v10, 320, v2
    v_add_u32 v11, v11, v10
    v_lshl_add_u32 v11, v4, 4, v11
    buffer_load_dwordx4 v[16:19], v11, s[20:23], s31 offen offset:0 nt
    buffer_load_dwordx4 v[20:23], v11, s[20:23], s31 offen offset:64 nt
    buffer_load_dwordx4 v[24:27], v11, s[20:23], s31 offen offset:128 nt
    buffer_load_dwordx4 v[28:31], v11, s[20:23], s31 offen offset:192 nt
    buffer_load_dwordx4 v[32:35], v11, s[20:23], s31 offen offset:256 nt
    v_mov_b32 v13, 0x3f803f80
    s_waitcnt vmcnt(0)
    buffer_load_dword v14, v15, s[36:39], 0 offen sc1
    v_dot2_f32_bf16 v12, v16, v13, 0
    v_dot2_f32_bf16 v10, v16, v16, 0
    v_dot2_f32_bf16 v12, v17, v13, v12
    v_dot2_f32_bf16 v10, v17, v17, v10
    v_dot2_f32_bf16 v12, v18, v13, v12
    v_dot2_f32_bf16 v10, v18, v18, v10
    v_dot2_f32_bf16 v12, v19, v13, v12
    v_dot2_f32_bf16 v10, v19, v19, v10
    v_dot2_f32_bf16 v12, v20, v13, v12
    v_dot2_f32_bf16 v10, v20, v20, v10
    v_dot2_f32_bf16 v12, v21, v13, v12
    v_dot2_f32_bf16 v10, v21, v21, v10
    v_dot2_f32_bf16 v12, v22, v13, v12
    v_dot2_f32_bf16 v10, v22, v22, v10
    v_dot2_f32_bf16 v12, v23, v13, v12
    v_dot2_f32_bf16 v10, v23, v23, v10
    v_dot2_f32_bf16 v12, v24, v13, v12
    v_dot2_f32_bf16 v10, v24, v24, v10
    v_dot2_f32_bf16 v12, v25, v13, v12
    v_dot2_f32_bf16 v10, v25, v25, v10
    v_dot2_f32_bf16 v12, v26, v13, v12
    v_dot2_f32_bf16 v10, v26, v26, v10
    v_dot2_f32_bf16 v12, v27, v13, v12
    v_dot2_f32_bf16 v10, v27, v27, v10
    v_dot2_f32_bf16 v12, v28, v13, v12
    v_dot2_f32_bf16 v10, v28, v28, v10
    v_dot2_f32_bf16 v12, v29, v13, v12
    v_dot2_f32_bf16 v10, v29, v29, v10
    v_dot2_f32_bf16 v12, v30, v13, v12
    v_dot2_f32_bf16 v10, v30, v30, v10
    v_dot2_f32_bf16 v12, v31, v13, v12
    v_dot2_f32_bf16 v10, v31, v31, v10
    v_dot2_f32_bf16 v12, v32, v13, v12
    v_dot2_f32_bf16 v10, v32, v32, v10
    v_dot2_f32_bf16 v12, v33, v13, v12
    v_dot2_f32_bf16 v10, v33, v33, v10
    v_dot2_f32_bf16 v12, v34, v13, v12
    v_dot2_f32_bf16 v10, v34, v34, v10
    v_dot2_f32_bf16 v12, v35, v13, v12
    v_dot2_f32_bf16 v10, v35, v35, v10
    s_nop 2
    v_permlane32_swap_b32 v12, v10
    v_add_f32 v12, v12, v10
    v_mov_b32 v10, v12
    s_nop 1
    v_permlane16_swap_b32 v12, v10
    v_add_f32 v12, v12, v10
    v_lshlrev_b32 v11, 7, v2
    v_lshl_add_u32 v11, v3, 3, v11
    v_lshrrev_b32 v10, 5, v1
    v_lshl_add_u32 v11, v10, 2, v11
    v_add_u32 v11, 147456, v11
    ds_write_b32 v11, v12
    v_lshlrev_b32 v36, 16, v16
    v_and_b32 v37, 0xffff0000, v16
    v_lshlrev_b32 v38, 16, v17
    v_and_b32 v39, 0xffff0000, v17
    v_lshlrev_b32 v40, 16, v18
    v_and_b32 v41, 0xffff0000, v18
    v_lshlrev_b32 v42, 16, v19
    v_and_b32 v43, 0xffff0000, v19
    v_lshlrev_b32 v44, 16, v20
    v_and_b32 v45, 0xffff0000, v20
    v_lshlrev_b32 v46, 16, v21
    v_and_b32 v47, 0xffff0000, v21
    v_lshlrev_b32 v48, 16, v22
    v_and_b32 v49, 0xffff0000, v22
    v_lshlrev_b32 v50, 16, v23
    v_and_b32 v51, 0xffff0000, v23
    v_lshlrev_b32 v52, 16, v24
    v_and_b32 v53, 0xffff0000, v24
    v_lshlrev_b32 v54, 16, v25
    v_and_b32 v55, 0xffff0000, v25
    v_lshlrev_b32 v56, 16, v26
    v_and_b32 v57, 0xffff0000, v26
    v_lshlrev_b32 v58, 16, v27
    v_and_b32 v59, 0xffff0000, v27
    v_lshlrev_b32 v60, 16, v28
    v_and_b32 v61, 0xffff0000, v28
    v_lshlrev_b32 v62, 16, v29
    v_and_b32 v63, 0xffff0000, v29
    v_lshlrev_b32 v64, 16, v30
    v_and_b32 v65, 0xffff0000, v30
    v_lshlrev_b32 v66, 16, v31
    v_and_b32 v67, 0xffff0000, v31
    v_lshlrev_b32 v68, 16, v32
    v_and_b32 v69, 0xffff0000, v32
    v_lshlrev_b32 v70, 16, v33
    v_and_b32 v71, 0xffff0000, v33
    v_lshlrev_b32 v72, 16, v34
    v_and_b32 v73, 0xffff0000, v34
    v_lshlrev_b32 v74, 16, v35
    v_and_b32 v75, 0xffff0000, v35
    s_waitcnt lgkmcnt(0)
    s_barrier
    v_lshlrev_b32 v11, 3, v3
    v_add_u32 v11, 147456, v11
    ds_read_b64 v[80:81], v11 offset:0
    ds_read_b64 v[82:83], v11 offset:128
    ds_read_b64 v[84:85], v11 offset:256
    ds_read_b64 v[86:87], v11 offset:384
    s_waitcnt lgkmcnt(0)
    v_pk_add_f32 v[80:81], v[80:81], v[82:83]
    v_pk_add_f32 v[84:85], v[84:85], v[86:87]
    v_pk_add_f32 v[80:81], v[80:81], v[84:85]
    v_mul_f32 v80, 0x3acccccd, v80
    v_mul_f32 v81, 0x3acccccd, v81
    v_fma_f32 v81, -v80, v80, v81
    v_max_f32 v81, 0, v81
    v_add_f32 v81, 0x3727c5ac, v81
    v_rsq_f32 v82, v81
    s_nop 0
    v_mul_f32 v80, v80, v82
    v_sub_f32 v80, 0, v80
    v_pk_fma_f32 v[36:37], v[36:37], v[82:83], v[80:81] op_sel_hi:[1,0,0]
    v_pk_fma_f32 v[38:39], v[38:39], v[82:83], v[80:81] op_sel_hi:[1,0,0]
    v_pk_fma_f32 v[40:41], v[40:41], v[82:83], v[80:81] op_sel_hi:[1,0,0]
    v_pk_fma_f32 v[42:43], v[42:43], v[82:83], v[80:81] op_sel_hi:[1,0,0]
    v_pk_fma_f32 v[44:45], v[44:45], v[82:83], v[80:81] op_sel_hi:[1,0,0]
    v_pk_fma_f32 v[46:47], v[46:47], v[82:83], v[80:81] op_sel_hi:[1,0,0]
    v_pk_fma_f32 v[48:49], v[48:49], v[82:83], v[80:81] op_sel_hi:[1,0,0]
    v_pk_fma_f32 v[50:51], v[50:51], v[82:83], v[80:81] op_sel_hi:[1,0,0]
    v_pk_fma_f32 v[52:53], v[52:53], v[82:83], v[80:81] op_sel_hi:[1,0,0]
    v_pk_fma_f32 v[54:55], v[54:55], v[82:83], v[80:81] op_sel_hi:[1,0,0]
    v_pk_fma_f32 v[56:57], v[56:57], v[82:83], v[80:81] op_sel_hi:[1,0,0]
    v_pk_fma_f32 v[58:59], v[58:59], v[82:83], v[80:81] op_sel_hi:[1,0,0]
    v_pk_fma_f32 v[60:61], v[60:61], v[82:83], v[80:81] op_sel_hi:[1,0,0]
    v_pk_fma_f32 v[62:63], v[62:63], v[82:83], v[80:81] op_sel_hi:[1,0,0]
    v_pk_fma_f32 v[64:65], v[64:65], v[82:83], v[80:81] op_sel_hi:[1,0,0]
    v_pk_fma_f32 v[66:67], v[66:67], v[82:83], v[80:81] op_sel_hi:[1,0,0]
    v_pk_fma_f32 v[68:69], v[68:69], v[82:83], v[80:81] op_sel_hi:[1,0,0]
    v_pk_fma_f32 v[70:71], v[70:71], v[82:83], v[80:81] op_sel_hi:[1,0,0]
    v_pk_fma_f32 v[72:73], v[72:73], v[82:83], v[80:81] op_sel_hi:[1,0,0]
    v_pk_fma_f32 v[74:75], v[74:75], v[82:83], v[80:81] op_sel_hi:[1,0,0]
Ln3:
    s_waitcnt vmcnt(0)
    v_readfirstlane_b32 s3, v14
    s_add_u32 s33, s33, 1
    s_cmp_gt_u32 s33, 0x10000
    s_cbranch_scc1 Ln3_ok
    s_cmp_eq_u32 s3, 0
    s_cbranch_scc1 Ln3_re
    s_sub_u32 s63, s62, s3
    s_cmp_lt_i32 s63, 4000
    s_cbranch_scc1 Ln3_ok
    s_cmp_gt_u32 s33, 0x1000
    s_cbranch_scc1 Ln3_ok
Ln3_re:
    buffer_load_dword v14, v15, s[36:39], 0 offen sc1
    s_branch Ln3
Ln3_ok:
    s_add_u32 m0, s29, 0
    s_mov_b32 s47, 0
    buffer_load_dwordx4 v238, s[16:19], s47 offen offset:0 nt lds
    buffer_load_dwordx4 v239, s[16:19], s47 offen offset:1024 nt lds
    buffer_load_dwordx4 v240, s[16:19], s47 offen offset:2048 nt lds
    buffer_load_dwordx4 v241, s[16:19], s47 offen offset:3072 nt lds
    s_add_u32 m0, s29, 16384
    s_mov_b32 s47, 524288
    buffer_load_dwordx4 v238, s[16:19], s47 offen offset:0 nt lds
    buffer_load_dwordx4 v239, s[16:19], s47 offen offset:1024 nt lds
    buffer_load_dwordx4 v240, s[16:19], s47 offen offset:2048 nt lds
    buffer_load_dwordx4 v241, s[16:19], s47 offen offset:3072 nt lds
    s_add_u32 m0, s29, 32768
    s_mov_b32 s47, 1048576
    buffer_load_dwordx4 v238, s[16:19], s47 offen offset:0 nt lds
    buffer_load_dwordx4 v239, s[16:19], s47 offen offset:1024 nt lds
    buffer_load_dwordx4 v240, s[16:19], s47 offen offset:2048 nt lds
    buffer_load_dwordx4 v241, s[16:19], s47 offen offset:3072 nt lds
    s_add_u32 m0, s29, 49152
    s_mov_b32 s47, 1572864
    buffer_load_dwordx4 v238, s[16:19], s47 offen offset:0 nt lds
    buffer_load_dwordx4 v239, s[16:19], s47 offen offset:1024 nt lds
    buffer_load_dwordx4 v240, s[16:19], s47 offen offset:2048 nt lds
    buffer_load_dwordx4 v241, s[16:19], s47 offen offset:3072 nt lds
    s_add_u32 m0, s29, 65536
    s_mov_b32 s47, 2097152
    buffer_load_dwordx4 v238, s[16:19], s47 offen offset:0 nt lds
    buffer_load_dwordx4 v239, s[16:19], s47 offen offset:1024 nt lds
    buffer_load_dwordx4 v240, s[16:19], s47 offen offset:2048 nt lds
    buffer_load_dwordx4 v241, s[16:19], s47 offen offset:3072 nt lds
    v_min_u32 v10, 39, v1
    v_mul_u32_u24 v11, 1280, v2
    v_lshl_add_u32 v11, v10, 5, v11
    s_mov_b32 s20, 2818048
    s_mov_b32 s21, 2823168
    s_mov_b32 s22, 2828288
    s_mov_b32 s23, 2833408
    v_mul_u32_u24 v12, 1280, v2
    v_add_u32 v12, 148480, v12
    v_lshl_add_u32 v13, v4, 5, v12
    v_lshl_add_u32 v12, v10, 4, v12
    s_mov_b32 s33, 0
Lpa:
    buffer_load_dwordx4 v[128:131], v11, s[52:55], s20 offen sc1
    buffer_load_dwordx4 v[132:135], v11, s[52:55], s20 offen offset:16 sc1
    buffer_load_dwordx4 v[136:139], v11, s[52:55], s21 offen sc1
    buffer_load_dwordx4 v[140:143], v11, s[52:55], s21 offen offset:16 sc1
    buffer_load_dwordx4 v[144:147], v11, s[52:55], s22 offen sc1
    buffer_load_dwordx4 v[148:151], v11, s[52:55], s22 offen offset:16 sc1
    buffer_load_dwordx4 v[152:155], v11, s[52:55], s23 offen sc1
    buffer_load_dwordx4 v[156:159], v11, s[52:55], s23 offen offset:16 sc1
    s_add_u32 s33, s33, 1
    s_waitcnt vmcnt(0)
    v_xor_b32 v129, s3, v129
    v_xor_b32 v131, s3, v131
    v_xor_b32 v133, s3, v133
    v_xor_b32 v135, s3, v135
    v_xor_b32 v137, s3, v137
    v_xor_b32 v139, s3, v139
    v_xor_b32 v141, s3, v141
    v_xor_b32 v143, s3, v143
    v_xor_b32 v145, s3, v145
    v_xor_b32 v147, s3, v147
    v_xor_b32 v149, s3, v149
    v_xor_b32 v151, s3, v151
    v_xor_b32 v153, s3, v153
    v_xor_b32 v155, s3, v155
    v_xor_b32 v157, s3, v157
    v_xor_b32 v159, s3, v159
    v_or_b32 v129, v129, v131
    v_or_b32 v129, v129, v133
    v_or_b32 v129, v129, v135
    v_or_b32 v129, v129, v137
    v_or_b32 v129, v129, v139
    v_or_b32 v129, v129, v141
    v_or_b32 v129, v129, v143
    v_or_b32 v129, v129, v145
    v_or_b32 v129, v129, v147
    v_or_b32 v129, v129, v149
    v_or_b32 v129, v129, v151
    v_or_b32 v129, v129, v153
    v_or_b32 v129, v129, v155
    v_or_b32 v129, v129, v157
    v_or_b32 v129, v129, v159
    v_cmp_ne_u32 vcc, 0, v129
    s_nop 1
    s_cbranch_vccz Lpa_ok
    s_cmp_gt_u32 s33, 0x10000
    s_cbranch_scc1 Lpa_ok
    s_branch Lpa
Lpa_ok:
    v_add_f32 v80, v128, v144
    v_add_f32 v88, v136, v152
    v_cvt_pk_bf16_f32 v80, 0, v80
    v_cvt_pk_bf16_f32 v88, 0, v88
    v_add_f32 v88, 1.0, v88
    v_mul_f32 v80, 0x3e0293ee, v80
    v_cvt_pk_bf16_f32 v88, 0, v88
    v_mul_f32 v88, 0x3e0293ee, v88
    v_add_f32 v81, v130, v146
    v_add_f32 v89, v138, v154
    v_cvt_pk_bf16_f32 v81, 0, v81
    v_cvt_pk_bf16_f32 v89, 0, v89
    v_add_f32 v89, 1.0, v89
    v_mul_f32 v81, 0x3e0293ee, v81
    v_cvt_pk_bf16_f32 v89, 0, v89
    v_mul_f32 v89, 0x3e0293ee, v89
    v_add_f32 v82, v132, v148
    v_add_f32 v90, v140, v156
    v_cvt_pk_bf16_f32 v82, 0, v82
    v_cvt_pk_bf16_f32 v90, 0, v90
    v_add_f32 v90, 1.0, v90
    v_mul_f32 v82, 0x3e0293ee, v82
    v_cvt_pk_bf16_f32 v90, 0, v90
    v_mul_f32 v90, 0x3e0293ee, v90
    v_add_f32 v83, v134, v150
    v_add_f32 v91, v142, v158
    v_cvt_pk_bf16_f32 v83, 0, v83
    v_cvt_pk_bf16_f32 v91, 0, v91
    v_add_f32 v91, 1.0, v91
    v_mul_f32 v83, 0x3e0293ee, v83
    v_cvt_pk_bf16_f32 v91, 0, v91
    v_mul_f32 v91, 0x3e0293ee, v91
    ds_write_b128 v12, v[80:83]
    ds_write_b128 v12, v[88:91] offset:640
    s_waitcnt lgkmcnt(0)
    ds_read_b128 v[80:83], v13 offset:0
    ds_read_b128 v[120:123], v13 offset:640
    ds_read_b128 v[84:87], v13 offset:16
    ds_read_b128 v[124:127], v13 offset:656
    ds_read_b128 v[88:91], v13 offset:128
    ds_read_b128 v[128:131], v13 offset:768
    ds_read_b128 v[92:95], v13 offset:144
    ds_read_b128 v[132:135], v13 offset:784
    ds_read_b128 v[96:99], v13 offset:256
    ds_read_b128 v[136:139], v13 offset:896
    ds_read_b128 v[100:103], v13 offset:272
    ds_read_b128 v[140:143], v13 offset:912
    ds_read_b128 v[104:107], v13 offset:384
    ds_read_b128 v[144:147], v13 offset:1024
    ds_read_b128 v[108:111], v13 offset:400
    ds_read_b128 v[148:151], v13 offset:1040
    ds_read_b128 v[112:115], v13 offset:512
    ds_read_b128 v[152:155], v13 offset:1152
    ds_read_b128 v[116:119], v13 offset:528
    ds_read_b128 v[156:159], v13 offset:1168
    v_mul_u32_u24 v11, 5120, v2
    v_lshl_add_u32 v11, v1, 4, v11
    s_add_u32 s31, s31, 0
    s_add_u32 s30, s31, 4096
    s_waitcnt lgkmcnt(15)
    v_pk_fma_f32 v[36:37], v[36:37], v[120:121], v[80:81]
    v_pk_fma_f32 v[38:39], v[38:39], v[122:123], v[82:83]
    v_pk_fma_f32 v[40:41], v[40:41], v[124:125], v[84:85]
    v_pk_fma_f32 v[42:43], v[42:43], v[126:127], v[86:87]
    v_cvt_pk_bf16_f32 v16, v36, v37
    v_cvt_pk_bf16_f32 v17, v38, v39
    v_cvt_pk_bf16_f32 v18, v40, v41
    v_cvt_pk_bf16_f32 v19, v42, v43
    buffer_store_dwordx4 v[16:19], v11, s[52:55], s31 offen offset:0 sc1
    s_waitcnt lgkmcnt(12)
    v_pk_fma_f32 v[44:45], v[44:45], v[128:129], v[88:89]
    v_pk_fma_f32 v[46:47], v[46:47], v[130:131], v[90:91]
    v_pk_fma_f32 v[48:49], v[48:49], v[132:133], v[92:93]
    v_pk_fma_f32 v[50:51], v[50:51], v[134:135], v[94:95]
    v_cvt_pk_bf16_f32 v20, v44, v45
    v_cvt_pk_bf16_f32 v21, v46, v47
    v_cvt_pk_bf16_f32 v22, v48, v49
    v_cvt_pk_bf16_f32 v23, v50, v51
    buffer_store_dwordx4 v[20:23], v11, s[52:55], s31 offen offset:1024 sc1
    s_waitcnt lgkmcnt(8)
    v_pk_fma_f32 v[52:53], v[52:53], v[136:137], v[96:97]
    v_pk_fma_f32 v[54:55], v[54:55], v[138:139], v[98:99]
    v_pk_fma_f32 v[56:57], v[56:57], v[140:141], v[100:101]
    v_pk_fma_f32 v[58:59], v[58:59], v[142:143], v[102:103]
    v_cvt_pk_bf16_f32 v24, v52, v53
    v_cvt_pk_bf16_f32 v25, v54, v55
    v_cvt_pk_bf16_f32 v26, v56, v57
    v_cvt_pk_bf16_f32 v27, v58, v59
    buffer_store_dwordx4 v[24:27], v11, s[52:55], s31 offen offset:2048 sc1
    s_waitcnt lgkmcnt(4)
    v_pk_fma_f32 v[60:61], v[60:61], v[144:145], v[104:105]
    v_pk_fma_f32 v[62:63], v[62:63], v[146:147], v[106:107]
    v_pk_fma_f32 v[64:65], v[64:65], v[148:149], v[108:109]
    v_pk_fma_f32 v[66:67], v[66:67], v[150:151], v[110:111]
    v_cvt_pk_bf16_f32 v28, v60, v61
    v_cvt_pk_bf16_f32 v29, v62, v63
    v_cvt_pk_bf16_f32 v30, v64, v65
    v_cvt_pk_bf16_f32 v31, v66, v67
    buffer_store_dwordx4 v[28:31], v11, s[52:55], s31 offen offset:3072 sc1
    s_waitcnt lgkmcnt(0)
    v_pk_fma_f32 v[68:69], v[68:69], v[152:153], v[112:113]
    v_pk_fma_f32 v[70:71], v[70:71], v[154:155], v[114:115]
    v_pk_fma_f32 v[72:73], v[72:73], v[156:157], v[116:117]
    v_pk_fma_f32 v[74:75], v[74:75], v[158:159], v[118:119]
    v_cvt_pk_bf16_f32 v32, v68, v69
    v_cvt_pk_bf16_f32 v33, v70, v71
    v_cvt_pk_bf16_f32 v34, v72, v73
    v_cvt_pk_bf16_f32 v35, v74, v75
    buffer_store_dwordx4 v[32:35], v11, s[52:55], s30 offen offset:0 sc1
    s_sub_u32 s35, s2, 128
    s_lshl_b32 s35, s35, 2
    s_add_u32 s35, s35, s28
    s_lshl_b32 s35, s35, 7
    s_add_u32 s35, s35, 48889856
    v_mov_b32 v14, s3
    v_and_b32 v13, 31, v1
    v_lshlrev_b32 v13, 2, v13
    s_waitcnt vmcnt(0)
    buffer_store_dword v14, v13, s[52:55], s35 offen sc1
    s_add_u32 m0, s29, 81920
    s_mov_b32 s47, 2621440
    buffer_load_dwordx4 v238, s[16:19], s47 offen offset:0 nt lds
    buffer_load_dwordx4 v239, s[16:19], s47 offen offset:1024 nt lds
    buffer_load_dwordx4 v240, s[16:19], s47 offen offset:2048 nt lds
    buffer_load_dwordx4 v241, s[16:19], s47 offen offset:3072 nt lds
    s_add_u32 m0, s29, 98304
    s_mov_b32 s47, 3145728
    buffer_load_dwordx4 v238, s[16:19], s47 offen offset:0 nt lds
    buffer_load_dwordx4 v239, s[16:19], s47 offen offset:1024 nt lds
    buffer_load_dwordx4 v240, s[16:19], s47 offen offset:2048 nt lds
    buffer_load_dwordx4 v241, s[16:19], s47 offen offset:3072 nt lds
    s_add_u32 m0, s29, 114688
    s_mov_b32 s47, 3670016
    buffer_load_dwordx4 v238, s[16:19], s47 offen offset:0 nt lds
    buffer_load_dwordx4 v239, s[16:19], s47 offen offset:1024 nt lds
    buffer_load_dwordx4 v240, s[16:19], s47 offen offset:2048 nt lds
    buffer_load_dwordx4 v241, s[16:19], s47 offen offset:3072 nt lds
    s_add_u32 m0, s29, 131072
    s_mov_b32 s47, 4194304
    buffer_load_dwordx4 v238, s[16:19], s47 offen offset:0 nt lds
    buffer_load_dwordx4 v239, s[16:19], s47 offen offset:1024 nt lds
    buffer_load_dwordx4 v240, s[16:19], s47 offen offset:2048 nt lds
    buffer_load_dwordx4 v241, s[16:19], s47 offen offset:3072 nt lds
Ljoin:
    s_mov_b32 s36, 4096
    s_mov_b32 s37, 8192
    s_mov_b32 s38, 12288
    s_mov_b32 s39, 16384
    s_mov_b32 s32, 0x3d000000
    v_mul_u32_u24 v11, 81920, v2
    v_lshl_add_u32 v11, v1, 4, v11
    v_add_u32 v242, 0, v11
    v_add_u32 v243, 20480, v11
    v_add_u32 v244, 40960, v11
    v_add_u32 v245, 61440, v11
    s_lshl_b32 s46, s44, 19
    s_add_u32 s12, s8, s46
    s_addc_u32 s13, s9, 0
    s_mov_b32 s14, 0x80000
    s_mov_b32 s15, 0x20000
    s_add_u32 s8, s6, s46
    s_addc_u32 s9, s7, 0
    s_mov_b32 s10, 0x80000
    s_mov_b32 s11, 0x20000
    s_mul_i32 s46, s45, 327680
    s_add_u32 s46, s46, 0
    s_add_u32 s20, s42, s46
    s_addc_u32 s21, s43, 0
    s_mov_b32 s22, 327680
    s_mov_b32 s23, 0x20000
    s_lshl_b32 s46, s45, 21
    s_add_u32 s46, s46, 16777216
    s_add_u32 s24, s42, s46
    s_addc_u32 s25, s43, 0
    s_mov_b32 s26, 0x200000
    s_mov_b32 s27, 0x20000
    v_and_b32 v7, 7, v3
    v_lshlrev_b32 v7, 1, v7
    v_xor_b32 v7, v4, v7
    v_lshlrev_b32 v8, 8, v3
    v_xor_b32 v9, 0, v7
    v_lshl_add_u32 v212, v9, 4, v8
    v_xor_b32 v9, 4, v7
    v_lshl_add_u32 v213, v9, 4, v8
    v_xor_b32 v9, 8, v7
    v_lshl_add_u32 v214, v9, 4, v8
    v_xor_b32 v9, 12, v7
    v_lshl_add_u32 v215, v9, 4, v8
    v_lshl_add_u32 v7, v4, 2, v5
    v_and_b32 v8, 7, v7
    v_lshlrev_b32 v7, 8, v7
    v_lshl_add_u32 v9, v6, 3, v7
    v_add_u32 v9, 65536, v9
    v_xor_b32 v10, 0, v8
    v_lshl_add_u32 v216, v10, 5, v9
    v_xor_b32 v10, 1, v8
    v_lshl_add_u32 v217, v10, 5, v9
    v_xor_b32 v10, 2, v8
    v_lshl_add_u32 v218, v10, 5, v9
    v_xor_b32 v10, 3, v8
    v_lshl_add_u32 v219, v10, 5, v9
    v_xor_b32 v10, 4, v8
    v_lshl_add_u32 v220, v10, 5, v9
    v_xor_b32 v10, 5, v8
    v_lshl_add_u32 v221, v10, 5, v9
    v_xor_b32 v10, 6, v8
    v_lshl_add_u32 v222, v10, 5, v9
    v_xor_b32 v10, 7, v8
    v_lshl_add_u32 v223, v10, 5, v9
    v_lshlrev_b32 v8, 1, v8
    v_xor_b32 v8, v6, v8
    v_lshl_add_u32 v7, v4, 10, v7
    v_xor_b32 v10, 0, v8
    v_lshl_add_u32 v226, v10, 4, v7
    v_add_u32 v230, 0x10000, v226
    v_add_u32 v234, 0x20000, v226
    v_xor_b32 v10, 4, v8
    v_lshl_add_u32 v227, v10, 4, v7
    v_add_u32 v231, 0x10000, v227
    v_add_u32 v235, 0x20000, v227
    v_xor_b32 v10, 8, v8
    v_lshl_add_u32 v228, v10, 4, v7
    v_add_u32 v232, 0x10000, v228
    v_add_u32 v236, 0x20000, v228
    v_xor_b32 v10, 12, v8
    v_lshl_add_u32 v229, v10, 4, v7
    v_add_u32 v233, 0x10000, v229
    v_add_u32 v237, 0x20000, v229
    v_lshlrev_b32 v7, 19, v2
    v_lshl_add_u32 v7, v1, 4, v7
    s_lshl_b32 s46, s44, 12
    v_add_u32 v246, s46, v7
    v_xor_b32 v9, v5, v6
    v_lshrrev_b32 v7, 1, v9
    v_lshrrev_b32 v8, 1, v4
    v_cmp_eq_u32 vcc, v7, v8
    v_mov_b32 v7, 0x3f803f80
    s_nop 0
    v_cndmask_b32 v208, 0, v7, vcc
    v_cndmask_b32 v209, 0, v7, vcc
    v_cndmask_b32 v210, 0, v7, vcc
    v_cndmask_b32 v211, 0, v7, vcc
    v_and_b32 v7, 1, v9
    v_mul_u32_u24 v7, 0xaaaa, v7
    v_add_u32 v255, 0x4444, v7
    s_lshr_b32 s46, s2, 3
    s_and_b32 s47, s2, 7
    s_mul_i32 s60, s47, 27
    s_add_u32 s60, s60, s46
    s_add_u32 s61, s60, 4
    s_cmp_ge_u32 s60, 108
    s_cselect_b32 s61, s61, s60
    s_lshr_b32 s62, s47, 2
    s_mul_i32 s62, s62, 112
    s_and_b32 s47, s47, 3
    s_add_u32 s62, s62, s47
    s_add_u32 s62, s62, 108
    s_cmp_ge_u32 s46, 27
    s_cselect_b32 s62, s62, s61
    s_cselect_b32 s60, 1048576, s60
    s_sub_u32 s61, s62, 112
    s_cmp_ge_u32 s62, 112
    s_cselect_b32 s61, s61, s62
    s_cselect_b32 s48, s58, s56
    s_cselect_b32 s49, s59, s57
    s_cselect_b32 s57, 1, 0
    s_mov_b32 s50, 2211840
    s_mov_b32 s51, 0x20000
    s_mul_i32 s58, s61, 9363
    s_lshr_b32 s58, s58, 16
    s_mul_i32 s59, s58, 7
    s_sub_u32 s59, s61, s59
    s_and_b32 s46, s58, 1
    s_sub_u32 s59, s59, s46
    s_cselect_b32 s59, 6, s59
    s_cmp_ge_u32 s59, 4
    s_cselect_b32 s46, 3, 4
    s_cselect_b32 s47, 76, 0
    s_mul_i32 s57, s57, s46
    s_add_u32 s57, s57, s59
    s_add_u32 s57, s57, s47
    s_lshl_b32 s57, s57, 11
    s_lshl_b32 s33, s46, 12
    s_mul_i32 s58, s58, 286720
    s_add_u32 s57, s57, s58
    s_mul_i32 s58, s28, 5
    s_lshr_b32 s59, s58, 1
    s_mul_i32 s59, s59, s33
    s_add_u32 s57, s57, s59
    s_and_b32 s58, s58, 1
    s_lshl_b32 s59, s58, 10
    s_add_u32 s57, s57, s59
    s_add_u32 s57, s57, 42991616
    s_sub_u32 s95, s33, 1024
    s_cmp_eq_u32 s58, 0
    s_cselect_b32 s95, 1024, s95
    s_mov_b32 s87, s33
    s_lshl_b32 s56, s61, 5
    s_mul_i32 s58, s28, 552960
    s_add_u32 s56, s56, s58
    s_cmp_ge_u32 s2, 224
    s_cselect_b32 s56, 67108864, s56
    s_cselect_b32 s57, 67108864, s57
    s_mul_i32 s58, s28, 5120
    s_add_u32 s58, s58, 2637824
    s_mov_b32 s59, 3456
    s_mov_b32 s94, 110592
    s_mov_b32 s96, s90
    s_mov_b32 s97, s91
    s_mov_b32 s98, 5242880
    s_mov_b32 s99, 0x20000
    s_lshr_b32 s46, s2, 1
    s_and_b32 s47, s2, 1
    s_lshl_b32 s47, s47, 2
    s_add_u32 s47, s47, s28
    s_mul_i32 s61, s46, 40960
    s_mul_i32 s63, s47, 160
    s_add_u32 s61, s61, s63
    s_and_b32 s6, s28, 1
    s_lshl_b32 s63, s6, 5
    s_add_u32 s61, s61, s63
    s_mul_i32 s6, s6, 160
    s_mul_i32 s63, s47, 655360
    s_mul_i32 s46, s46, 5120
    s_add_u32 s63, s63, s46
    s_add_u32 s63, s63, 33554432
    s_mul_i32 s46, s2, 6554
    s_lshr_b32 s46, s46, 16
    s_mul_i32 s47, s46, 10
    s_sub_u32 s47, s2, s47
    s_lshl_b32 s47, s47, 2
    s_add_u32 s47, s47, s28
    s_mul_i32 s46, s46, 40960
    s_lshl_b32 s90, s47, 5
    s_add_u32 s90, s90, s46
    s_lshl_b32 s91, s47, 10
    s_add_u32 s91, s91, s46
    s_add_u32 s91, s91, 39845888
    s_cmp_ge_u32 s2, 180
    s_cselect_b32 s90, 67108864, s90
    s_cselect_b32 s91, 67108864, s91
    s_lshr_b32 s101, s2, 1
    s_lshl_b32 s101, s101, 2
    s_and_b32 s46, s2, 1
    s_lshl_b32 s46, s46, 11
    s_add_u32 s101, s101, s46
    s_add_u32 s101, s101, 48234496
    s_cmp_eq_u32 s28, 0
    s_cselect_b32 s101, s101, 67108864
    s_mov_b32 s100, 67108864
    s_lshl_b32 s62, s28, 11
    s_add_u32 s62, s62, 0x20000
    v_lshrrev_b32 v249, 1, v1
    v_and_b32 v250, 1, v1
    v_lshlrev_b32 v250, 4, v250
    v_mul_u32_u24 v248, 1280, v249
    v_add_u32 v248, v248, v250
    v_lshlrev_b32 v252, 4, v1
    v_mov_b32 v253, 0
    v_mov_b32 v254, s3
    v_lshl_add_u32 v7, v4, 2, v5
    v_lshlrev_b32 v7, 5, v7
    v_lshl_add_u32 v7, v6, 3, v7
    v_add_u32 v251, s62, v7
    v_lshlrev_b32 v7, 7, v3
    s_lshl_b32 s46, s45, 2
    s_add_u32 s46, s46, s28
    s_lshl_b32 s46, s46, 11
    s_add_u32 s46, s46, 48889856
    v_min_u32 v12, 39, v1
    v_lshlrev_b32 v12, 4, v12
    buffer_load_dword v8, v7, s[52:55], s46 offen sc1
    s_waitcnt vmcnt(1)
    s_barrier
    ds_read_b64_tr_b16 a[128:129], v226 offset:0
    ds_read_b64_tr_b16 a[130:131], v226 offset:1024
    ds_read_b64_tr_b16 a[160:161], v226 offset:8192
    ds_read_b64_tr_b16 a[162:163], v226 offset:9216
    ds_read_b64_tr_b16 a[132:133], v226 offset:8
    ds_read_b64_tr_b16 a[134:135], v226 offset:1032
    ds_read_b64_tr_b16 a[164:165], v226 offset:8200
    ds_read_b64_tr_b16 a[166:167], v226 offset:9224
    ds_read_b64_tr_b16 a[136:137], v227 offset:0
    ds_read_b64_tr_b16 a[138:139], v227 offset:1024
    ds_read_b64_tr_b16 a[168:169], v227 offset:8192
    ds_read_b64_tr_b16 a[170:171], v227 offset:9216
    ds_read_b64_tr_b16 a[140:141], v227 offset:8
    ds_read_b64_tr_b16 a[142:143], v227 offset:1032
    ds_read_b64_tr_b16 a[172:173], v227 offset:8200
    ds_read_b64_tr_b16 a[174:175], v227 offset:9224
    ds_read_b64_tr_b16 a[144:145], v228 offset:0
    ds_read_b64_tr_b16 a[146:147], v228 offset:1024
    ds_read_b64_tr_b16 a[176:177], v228 offset:8192
    ds_read_b64_tr_b16 a[178:179], v228 offset:9216
    ds_read_b64_tr_b16 a[148:149], v228 offset:8
    ds_read_b64_tr_b16 a[150:151], v228 offset:1032
    ds_read_b64_tr_b16 a[180:181], v228 offset:8200
    ds_read_b64_tr_b16 a[182:183], v228 offset:9224
    ds_read_b64_tr_b16 a[152:153], v229 offset:0
    ds_read_b64_tr_b16 a[154:155], v229 offset:1024
    ds_read_b64_tr_b16 a[184:185], v229 offset:8192
    ds_read_b64_tr_b16 a[186:187], v229 offset:9216
    ds_read_b64_tr_b16 a[156:157], v229 offset:8
    ds_read_b64_tr_b16 a[158:159], v229 offset:1032
    ds_read_b64_tr_b16 a[188:189], v229 offset:8200
    ds_read_b64_tr_b16 a[190:191], v229 offset:9224
    s_waitcnt vmcnt(0)
    v_cmp_ne_u32 vcc, s3, v8
    s_nop 1
    s_cbranch_vccz Lpb_ok
    s_mov_b32 s33, 0
Lpb:
    buffer_load_dword v8, v7, s[52:55], s46 offen sc1
    s_add_u32 s33, s33, 1
    s_waitcnt vmcnt(0)
    v_cmp_ne_u32 vcc, s3, v8
    s_nop 1
    s_cbranch_vccz Lpb_ok
    s_cmp_gt_u32 s33, 0x10000
    s_cbranch_scc1 Lpb_ok
    s_branch Lpb
Lpb_ok:
    buffer_load_dwordx4 a[0:3], v242, s[20:23], 0 offen offset:0 sc1
    buffer_load_dwordx4 a[16:19], v242, s[20:23], 0 offen offset:1024 sc1
    buffer_load_dwordx4 a[4:7], v243, s[20:23], 0 offen offset:0 sc1
    buffer_load_dwordx4 a[20:23], v243, s[20:23], 0 offen offset:1024 sc1
    buffer_load_dwordx4 a[8:11], v244, s[20:23], 0 offen offset:0 sc1
    buffer_load_dwordx4 a[24:27], v244, s[20:23], 0 offen offset:1024 sc1
    buffer_load_dwordx4 a[12:15], v245, s[20:23], 0 offen offset:0 sc1
    buffer_load_dwordx4 a[28:31], v245, s[20:23], 0 offen offset:1024 sc1
    buffer_load_dwordx4 a[32:35], v242, s[20:23], 0 offen offset:2048 sc1
    buffer_load_dwordx4 a[48:51], v242, s[20:23], 0 offen offset:3072 sc1
    buffer_load_dwordx4 a[36:39], v243, s[20:23], 0 offen offset:2048 sc1
    buffer_load_dwordx4 a[52:55], v243, s[20:23], 0 offen offset:3072 sc1
    buffer_load_dwordx4 a[40:43], v244, s[20:23], 0 offen offset:2048 sc1
    buffer_load_dwordx4 a[56:59], v244, s[20:23], 0 offen offset:3072 sc1
    buffer_load_dwordx4 a[44:47], v245, s[20:23], 0 offen offset:2048 sc1
    buffer_load_dwordx4 a[60:63], v245, s[20:23], 0 offen offset:3072 sc1
    buffer_load_dwordx4 a[64:67], v242, s[20:23], s36 offen offset:0 sc1
    buffer_load_dwordx4 a[80:83], v242, s[20:23], s36 offen offset:1024 sc1
    buffer_load_dwordx4 a[68:71], v243, s[20:23], s36 offen offset:0 sc1
    buffer_load_dwordx4 a[84:87], v243, s[20:23], s36 offen offset:1024 sc1
    buffer_load_dwordx4 a[72:75], v244, s[20:23], s36 offen offset:0 sc1
    buffer_load_dwordx4 a[88:91], v244, s[20:23], s36 offen offset:1024 sc1
    buffer_load_dwordx4 a[76:79], v245, s[20:23], s36 offen offset:0 sc1
    buffer_load_dwordx4 a[92:95], v245, s[20:23], s36 offen offset:1024 sc1
    s_waitcnt vmcnt(22) lgkmcnt(0)
    v_mfma_f32_16x16x32_bf16 v[80:83], a[128:131], a[0:3], 0
    ds_read_b64_tr_b16 a[192:193], v226 offset:16384
    v_mfma_f32_16x16x32_bf16 v[80:83], a[160:163], a[16:19], v[80:83]
    buffer_load_dwordx4 a[96:99], v242, s[20:23], s36 offen offset:2048 sc1
    v_mfma_f32_16x16x32_bf16 v[84:87], a[132:135], a[0:3], 0
    ds_read_b64_tr_b16 a[194:195], v226 offset:17408
    v_mfma_f32_16x16x32_bf16 v[84:87], a[164:167], a[16:19], v[84:87]
    ds_read_b64_tr_b16 a[224:225], v226 offset:24576
    v_mfma_f32_16x16x32_bf16 v[88:91], a[136:139], a[0:3], 0
    ds_read_b64_tr_b16 a[226:227], v226 offset:25600
    v_mfma_f32_16x16x32_bf16 v[88:91], a[168:171], a[16:19], v[88:91]
    ds_read_b64_tr_b16 a[196:197], v226 offset:16392
    v_mfma_f32_16x16x32_bf16 v[92:95], a[140:143], a[0:3], 0
    ds_read_b64_tr_b16 a[198:199], v226 offset:17416
    v_mfma_f32_16x16x32_bf16 v[92:95], a[172:175], a[16:19], v[92:95]
    ds_read_b64_tr_b16 a[228:229], v226 offset:24584
    v_mfma_f32_16x16x32_bf16 v[96:99], a[144:147], a[0:3], 0
    ds_read_b64_tr_b16 a[230:231], v226 offset:25608
    v_mfma_f32_16x16x32_bf16 v[96:99], a[176:179], a[16:19], v[96:99]
    buffer_load_dwordx4 a[112:115], v242, s[20:23], s36 offen offset:3072 sc1
    v_mfma_f32_16x16x32_bf16 v[100:103], a[148:151], a[0:3], 0
    ds_read_b64_tr_b16 a[200:201], v227 offset:16384
    v_mfma_f32_16x16x32_bf16 v[100:103], a[180:183], a[16:19], v[100:103]
    ds_read_b64_tr_b16 a[202:203], v227 offset:17408
    v_mfma_f32_16x16x32_bf16 v[104:107], a[152:155], a[0:3], 0
    ds_read_b64_tr_b16 a[232:233], v227 offset:24576
    v_mfma_f32_16x16x32_bf16 v[104:107], a[184:187], a[16:19], v[104:107]
    ds_read_b64_tr_b16 a[234:235], v227 offset:25600
    v_mfma_f32_16x16x32_bf16 v[108:111], a[156:159], a[0:3], 0
    ds_read_b64_tr_b16 a[204:205], v227 offset:16392
    v_mfma_f32_16x16x32_bf16 v[108:111], a[188:191], a[16:19], v[108:111]
    s_waitcnt vmcnt(22)
    ds_read_b64_tr_b16 a[206:207], v227 offset:17416
    v_mfma_f32_16x16x32_bf16 v[112:115], a[128:131], a[4:7], 0
    ds_read_b64_tr_b16 a[236:237], v227 offset:24584
    v_mfma_f32_16x16x32_bf16 v[112:115], a[160:163], a[20:23], v[112:115]
    buffer_load_dwordx4 a[100:103], v243, s[20:23], s36 offen offset:2048 sc1
    v_mfma_f32_16x16x32_bf16 v[116:119], a[132:135], a[4:7], 0
    ds_read_b64_tr_b16 a[238:239], v227 offset:25608
    v_mfma_f32_16x16x32_bf16 v[116:119], a[164:167], a[20:23], v[116:119]
    ds_read_b64_tr_b16 a[208:209], v228 offset:16384
    v_mfma_f32_16x16x32_bf16 v[120:123], a[136:139], a[4:7], 0
    ds_read_b64_tr_b16 a[210:211], v228 offset:17408
    v_mfma_f32_16x16x32_bf16 v[120:123], a[168:171], a[20:23], v[120:123]
    ds_read_b64_tr_b16 a[240:241], v228 offset:24576
    v_mfma_f32_16x16x32_bf16 v[124:127], a[140:143], a[4:7], 0
    ds_read_b64_tr_b16 a[242:243], v228 offset:25600
    v_mfma_f32_16x16x32_bf16 v[124:127], a[172:175], a[20:23], v[124:127]
    ds_read_b64_tr_b16 a[212:213], v228 offset:16392
    v_mfma_f32_16x16x32_bf16 v[128:131], a[144:147], a[4:7], 0
    ds_read_b64_tr_b16 a[214:215], v228 offset:17416
    v_mfma_f32_16x16x32_bf16 v[128:131], a[176:179], a[20:23], v[128:131]
    buffer_load_dwordx4 a[116:119], v243, s[20:23], s36 offen offset:3072 sc1
    v_mfma_f32_16x16x32_bf16 v[132:135], a[148:151], a[4:7], 0
    ds_read_b64_tr_b16 a[244:245], v228 offset:24584
    v_mfma_f32_16x16x32_bf16 v[132:135], a[180:183], a[20:23], v[132:135]
    ds_read_b64_tr_b16 a[246:247], v228 offset:25608
    v_mfma_f32_16x16x32_bf16 v[136:139], a[152:155], a[4:7], 0
    ds_read_b64_tr_b16 a[216:217], v229 offset:16384
    v_mfma_f32_16x16x32_bf16 v[136:139], a[184:187], a[20:23], v[136:139]
    ds_read_b64_tr_b16 a[218:219], v229 offset:17408
    v_mfma_f32_16x16x32_bf16 v[140:143], a[156:159], a[4:7], 0
    ds_read_b64_tr_b16 a[248:249], v229 offset:24576
    v_mfma_f32_16x16x32_bf16 v[140:143], a[188:191], a[20:23], v[140:143]
    s_waitcnt vmcnt(22)
    ds_read_b64_tr_b16 a[250:251], v229 offset:25600
    v_mfma_f32_16x16x32_bf16 v[144:147], a[128:131], a[8:11], 0
    ds_read_b64_tr_b16 a[220:221], v229 offset:16392
    v_mfma_f32_16x16x32_bf16 v[144:147], a[160:163], a[24:27], v[144:147]
    buffer_load_dwordx4 a[104:107], v244, s[20:23], s36 offen offset:2048 sc1
    v_mfma_f32_16x16x32_bf16 v[148:151], a[132:135], a[8:11], 0
    ds_read_b64_tr_b16 a[222:223], v229 offset:17416
    v_mfma_f32_16x16x32_bf16 v[148:151], a[164:167], a[24:27], v[148:151]
    ds_read_b64_tr_b16 a[252:253], v229 offset:24584
    v_mfma_f32_16x16x32_bf16 v[152:155], a[136:139], a[8:11], 0
    ds_read_b64_tr_b16 a[254:255], v229 offset:25608
    v_mfma_f32_16x16x32_bf16 v[152:155], a[168:171], a[24:27], v[152:155]
    v_mfma_f32_16x16x32_bf16 v[156:159], a[140:143], a[8:11], 0
    v_mfma_f32_16x16x32_bf16 v[156:159], a[172:175], a[24:27], v[156:159]
    v_mfma_f32_16x16x32_bf16 v[160:163], a[144:147], a[8:11], 0
    v_mfma_f32_16x16x32_bf16 v[160:163], a[176:179], a[24:27], v[160:163]
    buffer_load_dwordx4 a[120:123], v244, s[20:23], s36 offen offset:3072 sc1
    v_mfma_f32_16x16x32_bf16 v[164:167], a[148:151], a[8:11], 0
    v_mfma_f32_16x16x32_bf16 v[164:167], a[180:183], a[24:27], v[164:167]
    v_mfma_f32_16x16x32_bf16 v[168:171], a[152:155], a[8:11], 0
    v_mfma_f32_16x16x32_bf16 v[168:171], a[184:187], a[24:27], v[168:171]
    v_mfma_f32_16x16x32_bf16 v[172:175], a[156:159], a[8:11], 0
    v_mfma_f32_16x16x32_bf16 v[172:175], a[188:191], a[24:27], v[172:175]
    s_waitcnt vmcnt(22)
    v_mfma_f32_16x16x32_bf16 v[176:179], a[128:131], a[12:15], 0
    v_mfma_f32_16x16x32_bf16 v[176:179], a[160:163], a[28:31], v[176:179]
    buffer_load_dwordx4 a[108:111], v245, s[20:23], s36 offen offset:2048 sc1
    v_mfma_f32_16x16x32_bf16 v[180:183], a[132:135], a[12:15], 0
    v_mfma_f32_16x16x32_bf16 v[180:183], a[164:167], a[28:31], v[180:183]
    v_mfma_f32_16x16x32_bf16 v[184:187], a[136:139], a[12:15], 0
    v_mfma_f32_16x16x32_bf16 v[184:187], a[168:171], a[28:31], v[184:187]
    v_mfma_f32_16x16x32_bf16 v[188:191], a[140:143], a[12:15], 0
    v_mfma_f32_16x16x32_bf16 v[188:191], a[172:175], a[28:31], v[188:191]
    v_mfma_f32_16x16x32_bf16 v[192:195], a[144:147], a[12:15], 0
    v_mfma_f32_16x16x32_bf16 v[192:195], a[176:179], a[28:31], v[192:195]
    buffer_load_dwordx4 a[124:127], v245, s[20:23], s36 offen offset:3072 sc1
    v_mfma_f32_16x16x32_bf16 v[196:199], a[148:151], a[12:15], 0
    v_mfma_f32_16x16x32_bf16 v[196:199], a[180:183], a[28:31], v[196:199]
    v_mfma_f32_16x16x32_bf16 v[200:203], a[152:155], a[12:15], 0
    v_mfma_f32_16x16x32_bf16 v[200:203], a[184:187], a[28:31], v[200:203]
    v_mfma_f32_16x16x32_bf16 v[204:207], a[156:159], a[12:15], 0
    v_mfma_f32_16x16x32_bf16 v[204:207], a[188:191], a[28:31], v[204:207]
    s_waitcnt vmcnt(22) lgkmcnt(0)
    v_mfma_f32_16x16x32_bf16 v[80:83], a[192:195], a[32:35], v[80:83]
    ds_read_b64_tr_b16 a[128:129], v226 offset:32768
    v_mfma_f32_16x16x32_bf16 v[80:83], a[224:227], a[48:51], v[80:83]
    buffer_load_dwordx4 a[0:3], v242, s[20:23], s37 offen offset:0 sc1
    v_mfma_f32_16x16x32_bf16 v[84:87], a[196:199], a[32:35], v[84:87]
    ds_read_b64_tr_b16 a[130:131], v226 offset:33792
    v_mfma_f32_16x16x32_bf16 v[84:87], a[228:231], a[48:51], v[84:87]
    ds_read_b64_tr_b16 a[160:161], v226 offset:40960
    v_mfma_f32_16x16x32_bf16 v[88:91], a[200:203], a[32:35], v[88:91]
    ds_read_b64_tr_b16 a[162:163], v226 offset:41984
    v_mfma_f32_16x16x32_bf16 v[88:91], a[232:235], a[48:51], v[88:91]
    ds_read_b64_tr_b16 a[132:133], v226 offset:32776
    v_mfma_f32_16x16x32_bf16 v[92:95], a[204:207], a[32:35], v[92:95]
    ds_read_b64_tr_b16 a[134:135], v226 offset:33800
    v_mfma_f32_16x16x32_bf16 v[92:95], a[236:239], a[48:51], v[92:95]
    ds_read_b64_tr_b16 a[164:165], v226 offset:40968
    v_mfma_f32_16x16x32_bf16 v[96:99], a[208:211], a[32:35], v[96:99]
    ds_read_b64_tr_b16 a[166:167], v226 offset:41992
    v_mfma_f32_16x16x32_bf16 v[96:99], a[240:243], a[48:51], v[96:99]
    buffer_load_dwordx4 a[16:19], v242, s[20:23], s37 offen offset:1024 sc1
    v_mfma_f32_16x16x32_bf16 v[100:103], a[212:215], a[32:35], v[100:103]
    ds_read_b64_tr_b16 a[136:137], v227 offset:32768
    v_mfma_f32_16x16x32_bf16 v[100:103], a[244:247], a[48:51], v[100:103]
    ds_read_b64_tr_b16 a[138:139], v227 offset:33792
    v_mfma_f32_16x16x32_bf16 v[104:107], a[216:219], a[32:35], v[104:107]
    ds_read_b64_tr_b16 a[168:169], v227 offset:40960
    v_mfma_f32_16x16x32_bf16 v[104:107], a[248:251], a[48:51], v[104:107]
    ds_read_b64_tr_b16 a[170:171], v227 offset:41984
    v_mfma_f32_16x16x32_bf16 v[108:111], a[220:223], a[32:35], v[108:111]
    ds_read_b64_tr_b16 a[140:141], v227 offset:32776
    v_mfma_f32_16x16x32_bf16 v[108:111], a[252:255], a[48:51], v[108:111]
    s_waitcnt vmcnt(22)
    ds_read_b64_tr_b16 a[142:143], v227 offset:33800
    v_mfma_f32_16x16x32_bf16 v[112:115], a[192:195], a[36:39], v[112:115]
    ds_read_b64_tr_b16 a[172:173], v227 offset:40968
    v_mfma_f32_16x16x32_bf16 v[112:115], a[224:227], a[52:55], v[112:115]
    buffer_load_dwordx4 a[4:7], v243, s[20:23], s37 offen offset:0 sc1
    v_mfma_f32_16x16x32_bf16 v[116:119], a[196:199], a[36:39], v[116:119]
    ds_read_b64_tr_b16 a[174:175], v227 offset:41992
    v_mfma_f32_16x16x32_bf16 v[116:119], a[228:231], a[52:55], v[116:119]
    ds_read_b64_tr_b16 a[144:145], v228 offset:32768
    v_mfma_f32_16x16x32_bf16 v[120:123], a[200:203], a[36:39], v[120:123]
    ds_read_b64_tr_b16 a[146:147], v228 offset:33792
    v_mfma_f32_16x16x32_bf16 v[120:123], a[232:235], a[52:55], v[120:123]
    ds_read_b64_tr_b16 a[176:177], v228 offset:40960
    v_mfma_f32_16x16x32_bf16 v[124:127], a[204:207], a[36:39], v[124:127]
    ds_read_b64_tr_b16 a[178:179], v228 offset:41984
    v_mfma_f32_16x16x32_bf16 v[124:127], a[236:239], a[52:55], v[124:127]
    ds_read_b64_tr_b16 a[148:149], v228 offset:32776
    v_mfma_f32_16x16x32_bf16 v[128:131], a[208:211], a[36:39], v[128:131]
    ds_read_b64_tr_b16 a[150:151], v228 offset:33800
    v_mfma_f32_16x16x32_bf16 v[128:131], a[240:243], a[52:55], v[128:131]
    buffer_load_dwordx4 a[20:23], v243, s[20:23], s37 offen offset:1024 sc1
    v_mfma_f32_16x16x32_bf16 v[132:135], a[212:215], a[36:39], v[132:135]
    ds_read_b64_tr_b16 a[180:181], v228 offset:40968
    v_mfma_f32_16x16x32_bf16 v[132:135], a[244:247], a[52:55], v[132:135]
    ds_read_b64_tr_b16 a[182:183], v228 offset:41992
    v_mfma_f32_16x16x32_bf16 v[136:139], a[216:219], a[36:39], v[136:139]
    ds_read_b64_tr_b16 a[152:153], v229 offset:32768
    v_mfma_f32_16x16x32_bf16 v[136:139], a[248:251], a[52:55], v[136:139]
    ds_read_b64_tr_b16 a[154:155], v229 offset:33792
    v_mfma_f32_16x16x32_bf16 v[140:143], a[220:223], a[36:39], v[140:143]
    ds_read_b64_tr_b16 a[184:185], v229 offset:40960
    v_mfma_f32_16x16x32_bf16 v[140:143], a[252:255], a[52:55], v[140:143]
    s_waitcnt vmcnt(22)
    ds_read_b64_tr_b16 a[186:187], v229 offset:41984
    v_mfma_f32_16x16x32_bf16 v[144:147], a[192:195], a[40:43], v[144:147]
    ds_read_b64_tr_b16 a[156:157], v229 offset:32776
    v_mfma_f32_16x16x32_bf16 v[144:147], a[224:227], a[56:59], v[144:147]
    buffer_load_dwordx4 a[8:11], v244, s[20:23], s37 offen offset:0 sc1
    v_mfma_f32_16x16x32_bf16 v[148:151], a[196:199], a[40:43], v[148:151]
    s_add_u32 m0, s29, 147456
    ds_read_b64_tr_b16 a[158:159], v229 offset:33800
    v_mfma_f32_16x16x32_bf16 v[148:151], a[228:231], a[56:59], v[148:151]
    s_mov_b32 s47, 4718592
    ds_read_b64_tr_b16 a[188:189], v229 offset:40968
    v_mfma_f32_16x16x32_bf16 v[152:155], a[200:203], a[40:43], v[152:155]
    ds_read_b64_tr_b16 a[190:191], v229 offset:41992
    v_mfma_f32_16x16x32_bf16 v[152:155], a[232:235], a[56:59], v[152:155]
    buffer_load_dwordx4 v238, s[16:19], s47 offen offset:0 nt lds
    v_mfma_f32_16x16x32_bf16 v[156:159], a[204:207], a[40:43], v[156:159]
    v_mfma_f32_16x16x32_bf16 v[156:159], a[236:239], a[56:59], v[156:159]
    v_mfma_f32_16x16x32_bf16 v[160:163], a[208:211], a[40:43], v[160:163]
    v_mfma_f32_16x16x32_bf16 v[160:163], a[240:243], a[56:59], v[160:163]
    buffer_load_dwordx4 a[24:27], v244, s[20:23], s37 offen offset:1024 sc1
    v_mfma_f32_16x16x32_bf16 v[164:167], a[212:215], a[40:43], v[164:167]
    v_mfma_f32_16x16x32_bf16 v[164:167], a[244:247], a[56:59], v[164:167]
    v_mfma_f32_16x16x32_bf16 v[168:171], a[216:219], a[40:43], v[168:171]
    v_mfma_f32_16x16x32_bf16 v[168:171], a[248:251], a[56:59], v[168:171]
    buffer_load_dwordx4 v239, s[16:19], s47 offen offset:1024 nt lds
    v_mfma_f32_16x16x32_bf16 v[172:175], a[220:223], a[40:43], v[172:175]
    v_mfma_f32_16x16x32_bf16 v[172:175], a[252:255], a[56:59], v[172:175]
    s_waitcnt vmcnt(24)
    v_mfma_f32_16x16x32_bf16 v[176:179], a[192:195], a[44:47], v[176:179]
    v_mfma_f32_16x16x32_bf16 v[176:179], a[224:227], a[60:63], v[176:179]
    buffer_load_dwordx4 a[12:15], v245, s[20:23], s37 offen offset:0 sc1
    v_mfma_f32_16x16x32_bf16 v[180:183], a[196:199], a[44:47], v[180:183]
    v_mfma_f32_16x16x32_bf16 v[180:183], a[228:231], a[60:63], v[180:183]
    v_mfma_f32_16x16x32_bf16 v[184:187], a[200:203], a[44:47], v[184:187]
    v_mfma_f32_16x16x32_bf16 v[184:187], a[232:235], a[60:63], v[184:187]
    buffer_load_dwordx4 v240, s[16:19], s47 offen offset:2048 nt lds
    v_mfma_f32_16x16x32_bf16 v[188:191], a[204:207], a[44:47], v[188:191]
    v_mfma_f32_16x16x32_bf16 v[188:191], a[236:239], a[60:63], v[188:191]
    v_mfma_f32_16x16x32_bf16 v[192:195], a[208:211], a[44:47], v[192:195]
    v_mfma_f32_16x16x32_bf16 v[192:195], a[240:243], a[60:63], v[192:195]
    buffer_load_dwordx4 a[28:31], v245, s[20:23], s37 offen offset:1024 sc1
    v_mfma_f32_16x16x32_bf16 v[196:199], a[212:215], a[44:47], v[196:199]
    v_mfma_f32_16x16x32_bf16 v[196:199], a[244:247], a[60:63], v[196:199]
    v_mfma_f32_16x16x32_bf16 v[200:203], a[216:219], a[44:47], v[200:203]
    v_mfma_f32_16x16x32_bf16 v[200:203], a[248:251], a[60:63], v[200:203]
    buffer_load_dwordx4 v241, s[16:19], s47 offen offset:3072 nt lds
    v_mfma_f32_16x16x32_bf16 v[204:207], a[220:223], a[44:47], v[204:207]
    v_mfma_f32_16x16x32_bf16 v[204:207], a[252:255], a[60:63], v[204:207]
    s_waitcnt vmcnt(26) lgkmcnt(0)
    v_mfma_f32_16x16x32_bf16 v[80:83], a[128:131], a[64:67], v[80:83]
    ds_read_b64_tr_b16 a[192:193], v226 offset:49152
    v_mfma_f32_16x16x32_bf16 v[80:83], a[160:163], a[80:83], v[80:83]
    buffer_load_dwordx4 a[32:35], v242, s[20:23], s37 offen offset:2048 sc1
    v_mfma_f32_16x16x32_bf16 v[84:87], a[132:135], a[64:67], v[84:87]
    ds_read_b64_tr_b16 a[194:195], v226 offset:50176
    v_mfma_f32_16x16x32_bf16 v[84:87], a[164:167], a[80:83], v[84:87]
    ds_read_b64_tr_b16 a[224:225], v226 offset:57344
    v_mfma_f32_16x16x32_bf16 v[88:91], a[136:139], a[64:67], v[88:91]
    ds_read_b64_tr_b16 a[226:227], v226 offset:58368
    v_mfma_f32_16x16x32_bf16 v[88:91], a[168:171], a[80:83], v[88:91]
    ds_read_b64_tr_b16 a[196:197], v226 offset:49160
    v_mfma_f32_16x16x32_bf16 v[92:95], a[140:143], a[64:67], v[92:95]
    ds_read_b64_tr_b16 a[198:199], v226 offset:50184
    v_mfma_f32_16x16x32_bf16 v[92:95], a[172:175], a[80:83], v[92:95]
    ds_read_b64_tr_b16 a[228:229], v226 offset:57352
    v_mfma_f32_16x16x32_bf16 v[96:99], a[144:147], a[64:67], v[96:99]
    ds_read_b64_tr_b16 a[230:231], v226 offset:58376
    v_mfma_f32_16x16x32_bf16 v[96:99], a[176:179], a[80:83], v[96:99]
    buffer_load_dwordx4 a[48:51], v242, s[20:23], s37 offen offset:3072 sc1
    v_mfma_f32_16x16x32_bf16 v[100:103], a[148:151], a[64:67], v[100:103]
    ds_read_b64_tr_b16 a[200:201], v227 offset:49152
    v_mfma_f32_16x16x32_bf16 v[100:103], a[180:183], a[80:83], v[100:103]
    ds_read_b64_tr_b16 a[202:203], v227 offset:50176
    v_mfma_f32_16x16x32_bf16 v[104:107], a[152:155], a[64:67], v[104:107]
    ds_read_b64_tr_b16 a[232:233], v227 offset:57344
    v_mfma_f32_16x16x32_bf16 v[104:107], a[184:187], a[80:83], v[104:107]
    ds_read_b64_tr_b16 a[234:235], v227 offset:58368
    v_mfma_f32_16x16x32_bf16 v[108:111], a[156:159], a[64:67], v[108:111]
    ds_read_b64_tr_b16 a[204:205], v227 offset:49160
    v_mfma_f32_16x16x32_bf16 v[108:111], a[188:191], a[80:83], v[108:111]
    s_waitcnt vmcnt(26)
    ds_read_b64_tr_b16 a[206:207], v227 offset:50184
    v_mfma_f32_16x16x32_bf16 v[112:115], a[128:131], a[68:71], v[112:115]
    ds_read_b64_tr_b16 a[236:237], v227 offset:57352
    v_mfma_f32_16x16x32_bf16 v[112:115], a[160:163], a[84:87], v[112:115]
    buffer_load_dwordx4 a[36:39], v243, s[20:23], s37 offen offset:2048 sc1
    v_mfma_f32_16x16x32_bf16 v[116:119], a[132:135], a[68:71], v[116:119]
    ds_read_b64_tr_b16 a[238:239], v227 offset:58376
    v_mfma_f32_16x16x32_bf16 v[116:119], a[164:167], a[84:87], v[116:119]
    ds_read_b64_tr_b16 a[208:209], v228 offset:49152
    v_mfma_f32_16x16x32_bf16 v[120:123], a[136:139], a[68:71], v[120:123]
    ds_read_b64_tr_b16 a[210:211], v228 offset:50176
    v_mfma_f32_16x16x32_bf16 v[120:123], a[168:171], a[84:87], v[120:123]
    ds_read_b64_tr_b16 a[240:241], v228 offset:57344
    v_mfma_f32_16x16x32_bf16 v[124:127], a[140:143], a[68:71], v[124:127]
    ds_read_b64_tr_b16 a[242:243], v228 offset:58368
    v_mfma_f32_16x16x32_bf16 v[124:127], a[172:175], a[84:87], v[124:127]
    ds_read_b64_tr_b16 a[212:213], v228 offset:49160
    v_mfma_f32_16x16x32_bf16 v[128:131], a[144:147], a[68:71], v[128:131]
    ds_read_b64_tr_b16 a[214:215], v228 offset:50184
    v_mfma_f32_16x16x32_bf16 v[128:131], a[176:179], a[84:87], v[128:131]
    buffer_load_dwordx4 a[52:55], v243, s[20:23], s37 offen offset:3072 sc1
    v_mfma_f32_16x16x32_bf16 v[132:135], a[148:151], a[68:71], v[132:135]
    ds_read_b64_tr_b16 a[244:245], v228 offset:57352
    v_mfma_f32_16x16x32_bf16 v[132:135], a[180:183], a[84:87], v[132:135]
    ds_read_b64_tr_b16 a[246:247], v228 offset:58376
    v_mfma_f32_16x16x32_bf16 v[136:139], a[152:155], a[68:71], v[136:139]
    ds_read_b64_tr_b16 a[216:217], v229 offset:49152
    v_mfma_f32_16x16x32_bf16 v[136:139], a[184:187], a[84:87], v[136:139]
    ds_read_b64_tr_b16 a[218:219], v229 offset:50176
    v_mfma_f32_16x16x32_bf16 v[140:143], a[156:159], a[68:71], v[140:143]
    ds_read_b64_tr_b16 a[248:249], v229 offset:57344
    v_mfma_f32_16x16x32_bf16 v[140:143], a[188:191], a[84:87], v[140:143]
    s_waitcnt vmcnt(26)
    ds_read_b64_tr_b16 a[250:251], v229 offset:58368
    v_mfma_f32_16x16x32_bf16 v[144:147], a[128:131], a[72:75], v[144:147]
    ds_read_b64_tr_b16 a[220:221], v229 offset:49160
    v_mfma_f32_16x16x32_bf16 v[144:147], a[160:163], a[88:91], v[144:147]
    buffer_load_dwordx4 a[40:43], v244, s[20:23], s37 offen offset:2048 sc1
    v_mfma_f32_16x16x32_bf16 v[148:151], a[132:135], a[72:75], v[148:151]
    ds_read_b64_tr_b16 a[222:223], v229 offset:50184
    v_mfma_f32_16x16x32_bf16 v[148:151], a[164:167], a[88:91], v[148:151]
    ds_read_b64_tr_b16 a[252:253], v229 offset:57352
    v_mfma_f32_16x16x32_bf16 v[152:155], a[136:139], a[72:75], v[152:155]
    ds_read_b64_tr_b16 a[254:255], v229 offset:58376
    v_mfma_f32_16x16x32_bf16 v[152:155], a[168:171], a[88:91], v[152:155]
    v_mfma_f32_16x16x32_bf16 v[156:159], a[140:143], a[72:75], v[156:159]
    v_mfma_f32_16x16x32_bf16 v[156:159], a[172:175], a[88:91], v[156:159]
    v_mfma_f32_16x16x32_bf16 v[160:163], a[144:147], a[72:75], v[160:163]
    v_mfma_f32_16x16x32_bf16 v[160:163], a[176:179], a[88:91], v[160:163]
    buffer_load_dwordx4 a[56:59], v244, s[20:23], s37 offen offset:3072 sc1
    v_mfma_f32_16x16x32_bf16 v[164:167], a[148:151], a[72:75], v[164:167]
    v_mfma_f32_16x16x32_bf16 v[164:167], a[180:183], a[88:91], v[164:167]
    v_mfma_f32_16x16x32_bf16 v[168:171], a[152:155], a[72:75], v[168:171]
    v_mfma_f32_16x16x32_bf16 v[168:171], a[184:187], a[88:91], v[168:171]
    v_mfma_f32_16x16x32_bf16 v[172:175], a[156:159], a[72:75], v[172:175]
    v_mfma_f32_16x16x32_bf16 v[172:175], a[188:191], a[88:91], v[172:175]
    s_waitcnt vmcnt(26)
    v_mfma_f32_16x16x32_bf16 v[176:179], a[128:131], a[76:79], v[176:179]
    v_mfma_f32_16x16x32_bf16 v[176:179], a[160:163], a[92:95], v[176:179]
    buffer_load_dwordx4 a[44:47], v245, s[20:23], s37 offen offset:2048 sc1
    v_mfma_f32_16x16x32_bf16 v[180:183], a[132:135], a[76:79], v[180:183]
    v_mfma_f32_16x16x32_bf16 v[180:183], a[164:167], a[92:95], v[180:183]
    v_mfma_f32_16x16x32_bf16 v[184:187], a[136:139], a[76:79], v[184:187]
    v_mfma_f32_16x16x32_bf16 v[184:187], a[168:171], a[92:95], v[184:187]
    v_mfma_f32_16x16x32_bf16 v[188:191], a[140:143], a[76:79], v[188:191]
    v_mfma_f32_16x16x32_bf16 v[188:191], a[172:175], a[92:95], v[188:191]
    v_mfma_f32_16x16x32_bf16 v[192:195], a[144:147], a[76:79], v[192:195]
    v_mfma_f32_16x16x32_bf16 v[192:195], a[176:179], a[92:95], v[192:195]
    buffer_load_dwordx4 a[60:63], v245, s[20:23], s37 offen offset:3072 sc1
    v_mfma_f32_16x16x32_bf16 v[196:199], a[148:151], a[76:79], v[196:199]
    v_mfma_f32_16x16x32_bf16 v[196:199], a[180:183], a[92:95], v[196:199]
    v_mfma_f32_16x16x32_bf16 v[200:203], a[152:155], a[76:79], v[200:203]
    v_mfma_f32_16x16x32_bf16 v[200:203], a[184:187], a[92:95], v[200:203]
    v_mfma_f32_16x16x32_bf16 v[204:207], a[156:159], a[76:79], v[204:207]
    v_mfma_f32_16x16x32_bf16 v[204:207], a[188:191], a[92:95], v[204:207]
    s_waitcnt vmcnt(26) lgkmcnt(0)
    v_mfma_f32_16x16x32_bf16 v[80:83], a[192:195], a[96:99], v[80:83]
    ds_read_b64_tr_b16 a[128:129], v230 offset:0
    v_mfma_f32_16x16x32_bf16 v[80:83], a[224:227], a[112:115], v[80:83]
    buffer_load_dwordx4 a[64:67], v242, s[20:23], s38 offen offset:0 sc1
    v_mfma_f32_16x16x32_bf16 v[84:87], a[196:199], a[96:99], v[84:87]
    ds_read_b64_tr_b16 a[130:131], v230 offset:1024
    v_mfma_f32_16x16x32_bf16 v[84:87], a[228:231], a[112:115], v[84:87]
    ds_read_b64_tr_b16 a[160:161], v230 offset:8192
    v_mfma_f32_16x16x32_bf16 v[88:91], a[200:203], a[96:99], v[88:91]
    ds_read_b64_tr_b16 a[162:163], v230 offset:9216
    v_mfma_f32_16x16x32_bf16 v[88:91], a[232:235], a[112:115], v[88:91]
    ds_read_b64_tr_b16 a[132:133], v230 offset:8
    v_mfma_f32_16x16x32_bf16 v[92:95], a[204:207], a[96:99], v[92:95]
    ds_read_b64_tr_b16 a[134:135], v230 offset:1032
    v_mfma_f32_16x16x32_bf16 v[92:95], a[236:239], a[112:115], v[92:95]
    ds_read_b64_tr_b16 a[164:165], v230 offset:8200
    v_mfma_f32_16x16x32_bf16 v[96:99], a[208:211], a[96:99], v[96:99]
    ds_read_b64_tr_b16 a[166:167], v230 offset:9224
    v_mfma_f32_16x16x32_bf16 v[96:99], a[240:243], a[112:115], v[96:99]
    buffer_load_dwordx4 a[80:83], v242, s[20:23], s38 offen offset:1024 sc1
    v_mfma_f32_16x16x32_bf16 v[100:103], a[212:215], a[96:99], v[100:103]
    ds_read_b64_tr_b16 a[136:137], v231 offset:0
    v_mfma_f32_16x16x32_bf16 v[100:103], a[244:247], a[112:115], v[100:103]
    ds_read_b64_tr_b16 a[138:139], v231 offset:1024
    v_mfma_f32_16x16x32_bf16 v[104:107], a[216:219], a[96:99], v[104:107]
    ds_read_b64_tr_b16 a[168:169], v231 offset:8192
    v_mfma_f32_16x16x32_bf16 v[104:107], a[248:251], a[112:115], v[104:107]
    ds_read_b64_tr_b16 a[170:171], v231 offset:9216
    v_mfma_f32_16x16x32_bf16 v[108:111], a[220:223], a[96:99], v[108:111]
    ds_read_b64_tr_b16 a[140:141], v231 offset:8
    v_mfma_f32_16x16x32_bf16 v[108:111], a[252:255], a[112:115], v[108:111]
    s_waitcnt vmcnt(26)
    ds_read_b64_tr_b16 a[142:143], v231 offset:1032
    v_mfma_f32_16x16x32_bf16 v[112:115], a[192:195], a[100:103], v[112:115]
    ds_read_b64_tr_b16 a[172:173], v231 offset:8200
    v_mfma_f32_16x16x32_bf16 v[112:115], a[224:227], a[116:119], v[112:115]
    buffer_load_dwordx4 a[68:71], v243, s[20:23], s38 offen offset:0 sc1
    v_mfma_f32_16x16x32_bf16 v[116:119], a[196:199], a[100:103], v[116:119]
    ds_read_b64_tr_b16 a[174:175], v231 offset:9224
    v_mfma_f32_16x16x32_bf16 v[116:119], a[228:231], a[116:119], v[116:119]
    ds_read_b64_tr_b16 a[144:145], v232 offset:0
    v_mfma_f32_16x16x32_bf16 v[120:123], a[200:203], a[100:103], v[120:123]
    ds_read_b64_tr_b16 a[146:147], v232 offset:1024
    v_mfma_f32_16x16x32_bf16 v[120:123], a[232:235], a[116:119], v[120:123]
    ds_read_b64_tr_b16 a[176:177], v232 offset:8192
    v_mfma_f32_16x16x32_bf16 v[124:127], a[204:207], a[100:103], v[124:127]
    ds_read_b64_tr_b16 a[178:179], v232 offset:9216
    v_mfma_f32_16x16x32_bf16 v[124:127], a[236:239], a[116:119], v[124:127]
    ds_read_b64_tr_b16 a[148:149], v232 offset:8
    v_mfma_f32_16x16x32_bf16 v[128:131], a[208:211], a[100:103], v[128:131]
    ds_read_b64_tr_b16 a[150:151], v232 offset:1032
    v_mfma_f32_16x16x32_bf16 v[128:131], a[240:243], a[116:119], v[128:131]
    buffer_load_dwordx4 a[84:87], v243, s[20:23], s38 offen offset:1024 sc1
    v_mfma_f32_16x16x32_bf16 v[132:135], a[212:215], a[100:103], v[132:135]
    ds_read_b64_tr_b16 a[180:181], v232 offset:8200
    v_mfma_f32_16x16x32_bf16 v[132:135], a[244:247], a[116:119], v[132:135]
    ds_read_b64_tr_b16 a[182:183], v232 offset:9224
    v_mfma_f32_16x16x32_bf16 v[136:139], a[216:219], a[100:103], v[136:139]
    ds_read_b64_tr_b16 a[152:153], v233 offset:0
    v_mfma_f32_16x16x32_bf16 v[136:139], a[248:251], a[116:119], v[136:139]
    ds_read_b64_tr_b16 a[154:155], v233 offset:1024
    v_mfma_f32_16x16x32_bf16 v[140:143], a[220:223], a[100:103], v[140:143]
    ds_read_b64_tr_b16 a[184:185], v233 offset:8192
    v_mfma_f32_16x16x32_bf16 v[140:143], a[252:255], a[116:119], v[140:143]
    s_waitcnt vmcnt(26)
    ds_read_b64_tr_b16 a[186:187], v233 offset:9216
    v_mfma_f32_16x16x32_bf16 v[144:147], a[192:195], a[104:107], v[144:147]
    ds_read_b64_tr_b16 a[156:157], v233 offset:8
    v_mfma_f32_16x16x32_bf16 v[144:147], a[224:227], a[120:123], v[144:147]
    buffer_load_dwordx4 a[72:75], v244, s[20:23], s38 offen offset:0 sc1
    v_mfma_f32_16x16x32_bf16 v[148:151], a[196:199], a[104:107], v[148:151]
    ds_read_b64_tr_b16 a[158:159], v233 offset:1032
    v_mfma_f32_16x16x32_bf16 v[148:151], a[228:231], a[120:123], v[148:151]
    ds_read_b64_tr_b16 a[188:189], v233 offset:8200
    v_mfma_f32_16x16x32_bf16 v[152:155], a[200:203], a[104:107], v[152:155]
    ds_read_b64_tr_b16 a[190:191], v233 offset:9224
    v_mfma_f32_16x16x32_bf16 v[152:155], a[232:235], a[120:123], v[152:155]
    v_mfma_f32_16x16x32_bf16 v[156:159], a[204:207], a[104:107], v[156:159]
    v_mfma_f32_16x16x32_bf16 v[156:159], a[236:239], a[120:123], v[156:159]
    v_mfma_f32_16x16x32_bf16 v[160:163], a[208:211], a[104:107], v[160:163]
    v_mfma_f32_16x16x32_bf16 v[160:163], a[240:243], a[120:123], v[160:163]
    buffer_load_dwordx4 a[88:91], v244, s[20:23], s38 offen offset:1024 sc1
    v_mfma_f32_16x16x32_bf16 v[164:167], a[212:215], a[104:107], v[164:167]
    v_mfma_f32_16x16x32_bf16 v[164:167], a[244:247], a[120:123], v[164:167]
    v_mfma_f32_16x16x32_bf16 v[168:171], a[216:219], a[104:107], v[168:171]
    v_mfma_f32_16x16x32_bf16 v[168:171], a[248:251], a[120:123], v[168:171]
    v_mfma_f32_16x16x32_bf16 v[172:175], a[220:223], a[104:107], v[172:175]
    v_mfma_f32_16x16x32_bf16 v[172:175], a[252:255], a[120:123], v[172:175]
    s_waitcnt vmcnt(26)
    v_mfma_f32_16x16x32_bf16 v[176:179], a[192:195], a[108:111], v[176:179]
    v_mfma_f32_16x16x32_bf16 v[176:179], a[224:227], a[124:127], v[176:179]
    buffer_load_dwordx4 a[76:79], v245, s[20:23], s38 offen offset:0 sc1
    v_mfma_f32_16x16x32_bf16 v[180:183], a[196:199], a[108:111], v[180:183]
    v_mfma_f32_16x16x32_bf16 v[180:183], a[228:231], a[124:127], v[180:183]
    v_mfma_f32_16x16x32_bf16 v[184:187], a[200:203], a[108:111], v[184:187]
    v_mfma_f32_16x16x32_bf16 v[184:187], a[232:235], a[124:127], v[184:187]
    v_mfma_f32_16x16x32_bf16 v[188:191], a[204:207], a[108:111], v[188:191]
    v_mfma_f32_16x16x32_bf16 v[188:191], a[236:239], a[124:127], v[188:191]
    v_mfma_f32_16x16x32_bf16 v[192:195], a[208:211], a[108:111], v[192:195]
    v_mfma_f32_16x16x32_bf16 v[192:195], a[240:243], a[124:127], v[192:195]
    buffer_load_dwordx4 a[92:95], v245, s[20:23], s38 offen offset:1024 sc1
    v_mfma_f32_16x16x32_bf16 v[196:199], a[212:215], a[108:111], v[196:199]
    v_mfma_f32_16x16x32_bf16 v[196:199], a[244:247], a[124:127], v[196:199]
    v_mfma_f32_16x16x32_bf16 v[200:203], a[216:219], a[108:111], v[200:203]
    v_mfma_f32_16x16x32_bf16 v[200:203], a[248:251], a[124:127], v[200:203]
    v_mfma_f32_16x16x32_bf16 v[204:207], a[220:223], a[108:111], v[204:207]
    s_waitcnt vmcnt(26) lgkmcnt(0)
    v_mfma_f32_16x16x32_bf16 v[204:207], a[252:255], a[124:127], v[204:207]
    s_barrier
    v_mfma_f32_16x16x32_bf16 v[80:83], a[128:131], a[0:3], v[80:83]
    ds_read_b64_tr_b16 a[192:193], v230 offset:16384
    v_mfma_f32_16x16x32_bf16 v[80:83], a[160:163], a[16:19], v[80:83]
    buffer_load_dwordx4 a[96:99], v242, s[20:23], s38 offen offset:2048 sc1
    v_mfma_f32_16x16x32_bf16 v[84:87], a[132:135], a[0:3], v[84:87]
    s_add_u32 m0, s29, 0
    ds_read_b64_tr_b16 a[194:195], v230 offset:17408
    v_mfma_f32_16x16x32_bf16 v[84:87], a[164:167], a[16:19], v[84:87]
    s_mov_b32 s47, 0
    ds_read_b64_tr_b16 a[224:225], v230 offset:24576
    v_mfma_f32_16x16x32_bf16 v[88:91], a[136:139], a[0:3], v[88:91]
    ds_read_b64_tr_b16 a[226:227], v230 offset:25600
    v_mfma_f32_16x16x32_bf16 v[88:91], a[168:171], a[16:19], v[88:91]
    buffer_load_dwordx4 v224, s[8:11], s47 offen offset:0 sc1 nt lds
    v_mfma_f32_16x16x32_bf16 v[92:95], a[140:143], a[0:3], v[92:95]
    ds_read_b64_tr_b16 a[196:197], v230 offset:16392
    v_mfma_f32_16x16x32_bf16 v[92:95], a[172:175], a[16:19], v[92:95]
    ds_read_b64_tr_b16 a[198:199], v230 offset:17416
    v_mfma_f32_16x16x32_bf16 v[96:99], a[144:147], a[0:3], v[96:99]
    ds_read_b64_tr_b16 a[228:229], v230 offset:24584
    v_mfma_f32_16x16x32_bf16 v[96:99], a[176:179], a[16:19], v[96:99]
    buffer_load_dwordx4 a[112:115], v242, s[20:23], s38 offen offset:3072 sc1
    v_mfma_f32_16x16x32_bf16 v[100:103], a[148:151], a[0:3], v[100:103]
    ds_read_b64_tr_b16 a[230:231], v230 offset:25608
    v_mfma_f32_16x16x32_bf16 v[100:103], a[180:183], a[16:19], v[100:103]
    ds_read_b64_tr_b16 a[200:201], v231 offset:16384
    v_mfma_f32_16x16x32_bf16 v[104:107], a[152:155], a[0:3], v[104:107]
    ds_read_b64_tr_b16 a[202:203], v231 offset:17408
    v_mfma_f32_16x16x32_bf16 v[104:107], a[184:187], a[16:19], v[104:107]
    buffer_load_dwordx4 v225, s[8:11], s47 offen offset:1024 sc1 nt lds
    v_mfma_f32_16x16x32_bf16 v[108:111], a[156:159], a[0:3], v[108:111]
    ds_read_b64_tr_b16 a[232:233], v231 offset:24576
    v_mfma_f32_16x16x32_bf16 v[108:111], a[188:191], a[16:19], v[108:111]
    s_waitcnt vmcnt(28)
    ds_read_b64_tr_b16 a[234:235], v231 offset:25600
    v_mfma_f32_16x16x32_bf16 v[112:115], a[128:131], a[4:7], v[112:115]
    ds_read_b64_tr_b16 a[204:205], v231 offset:16392
    v_mfma_f32_16x16x32_bf16 v[112:115], a[160:163], a[20:23], v[112:115]
    buffer_load_dwordx4 a[100:103], v243, s[20:23], s38 offen offset:2048 sc1
    v_mfma_f32_16x16x32_bf16 v[116:119], a[132:135], a[4:7], v[116:119]
    ds_read_b64_tr_b16 a[206:207], v231 offset:17416
    v_mfma_f32_16x16x32_bf16 v[116:119], a[164:167], a[20:23], v[116:119]
    ds_read_b64_tr_b16 a[236:237], v231 offset:24584
    v_mfma_f32_16x16x32_bf16 v[120:123], a[136:139], a[4:7], v[120:123]
    ds_read_b64_tr_b16 a[238:239], v231 offset:25608
    v_mfma_f32_16x16x32_bf16 v[120:123], a[168:171], a[20:23], v[120:123]
    buffer_load_dwordx4 v224, s[8:11], s47 offen offset:2048 sc1 nt lds
    v_mfma_f32_16x16x32_bf16 v[124:127], a[140:143], a[4:7], v[124:127]
    ds_read_b64_tr_b16 a[208:209], v232 offset:16384
    v_mfma_f32_16x16x32_bf16 v[124:127], a[172:175], a[20:23], v[124:127]
    ds_read_b64_tr_b16 a[210:211], v232 offset:17408
    v_mfma_f32_16x16x32_bf16 v[128:131], a[144:147], a[4:7], v[128:131]
    ds_read_b64_tr_b16 a[240:241], v232 offset:24576
    v_mfma_f32_16x16x32_bf16 v[128:131], a[176:179], a[20:23], v[128:131]
    buffer_load_dwordx4 a[116:119], v243, s[20:23], s38 offen offset:3072 sc1
    v_mfma_f32_16x16x32_bf16 v[132:135], a[148:151], a[4:7], v[132:135]
    ds_read_b64_tr_b16 a[242:243], v232 offset:25600
    v_mfma_f32_16x16x32_bf16 v[132:135], a[180:183], a[20:23], v[132:135]
    ds_read_b64_tr_b16 a[212:213], v232 offset:16392
    v_mfma_f32_16x16x32_bf16 v[136:139], a[152:155], a[4:7], v[136:139]
    ds_read_b64_tr_b16 a[214:215], v232 offset:17416
    v_mfma_f32_16x16x32_bf16 v[136:139], a[184:187], a[20:23], v[136:139]
    buffer_load_dwordx4 v225, s[8:11], s47 offen offset:3072 sc1 nt lds
    v_mfma_f32_16x16x32_bf16 v[140:143], a[156:159], a[4:7], v[140:143]
    ds_read_b64_tr_b16 a[244:245], v232 offset:24584
    v_mfma_f32_16x16x32_bf16 v[140:143], a[188:191], a[20:23], v[140:143]
    s_waitcnt vmcnt(29)
    ds_read_b64_tr_b16 a[246:247], v232 offset:25608
    v_mfma_f32_16x16x32_bf16 v[144:147], a[128:131], a[8:11], v[144:147]
    ds_read_b64_tr_b16 a[216:217], v233 offset:16384
    v_mfma_f32_16x16x32_bf16 v[144:147], a[160:163], a[24:27], v[144:147]
    buffer_load_dwordx4 a[104:107], v244, s[20:23], s38 offen offset:2048 sc1
    v_mfma_f32_16x16x32_bf16 v[148:151], a[132:135], a[8:11], v[148:151]
    ds_read_b64_tr_b16 a[218:219], v233 offset:17408
    v_mfma_f32_16x16x32_bf16 v[148:151], a[164:167], a[24:27], v[148:151]
    ds_read_b64_tr_b16 a[248:249], v233 offset:24576
    v_mfma_f32_16x16x32_bf16 v[152:155], a[136:139], a[8:11], v[152:155]
    ds_read_b64_tr_b16 a[250:251], v233 offset:25600
    v_mfma_f32_16x16x32_bf16 v[152:155], a[168:171], a[24:27], v[152:155]
    ds_read_b64_tr_b16 a[220:221], v233 offset:16392
    v_mfma_f32_16x16x32_bf16 v[156:159], a[140:143], a[8:11], v[156:159]
    ds_read_b64_tr_b16 a[222:223], v233 offset:17416
    v_mfma_f32_16x16x32_bf16 v[156:159], a[172:175], a[24:27], v[156:159]
    ds_read_b64_tr_b16 a[252:253], v233 offset:24584
    v_mfma_f32_16x16x32_bf16 v[160:163], a[144:147], a[8:11], v[160:163]
    ds_read_b64_tr_b16 a[254:255], v233 offset:25608
    v_mfma_f32_16x16x32_bf16 v[160:163], a[176:179], a[24:27], v[160:163]
    buffer_load_dwordx4 a[120:123], v244, s[20:23], s38 offen offset:3072 sc1
    v_mfma_f32_16x16x32_bf16 v[164:167], a[148:151], a[8:11], v[164:167]
    v_mfma_f32_16x16x32_bf16 v[164:167], a[180:183], a[24:27], v[164:167]
    v_mfma_f32_16x16x32_bf16 v[168:171], a[152:155], a[8:11], v[168:171]
    v_mfma_f32_16x16x32_bf16 v[168:171], a[184:187], a[24:27], v[168:171]
    v_mfma_f32_16x16x32_bf16 v[172:175], a[156:159], a[8:11], v[172:175]
    v_mfma_f32_16x16x32_bf16 v[172:175], a[188:191], a[24:27], v[172:175]
    s_waitcnt vmcnt(27)
    v_mfma_f32_16x16x32_bf16 v[176:179], a[128:131], a[12:15], v[176:179]
    v_mfma_f32_16x16x32_bf16 v[176:179], a[160:163], a[28:31], v[176:179]
    buffer_load_dwordx4 a[108:111], v245, s[20:23], s38 offen offset:2048 sc1
    v_mfma_f32_16x16x32_bf16 v[180:183], a[132:135], a[12:15], v[180:183]
    v_mfma_f32_16x16x32_bf16 v[180:183], a[164:167], a[28:31], v[180:183]
    v_mfma_f32_16x16x32_bf16 v[184:187], a[136:139], a[12:15], v[184:187]
    v_mfma_f32_16x16x32_bf16 v[184:187], a[168:171], a[28:31], v[184:187]
    v_mfma_f32_16x16x32_bf16 v[188:191], a[140:143], a[12:15], v[188:191]
    v_mfma_f32_16x16x32_bf16 v[188:191], a[172:175], a[28:31], v[188:191]
    v_mfma_f32_16x16x32_bf16 v[192:195], a[144:147], a[12:15], v[192:195]
    v_mfma_f32_16x16x32_bf16 v[192:195], a[176:179], a[28:31], v[192:195]
    buffer_load_dwordx4 a[124:127], v245, s[20:23], s38 offen offset:3072 sc1
    v_mfma_f32_16x16x32_bf16 v[196:199], a[148:151], a[12:15], v[196:199]
    v_mfma_f32_16x16x32_bf16 v[196:199], a[180:183], a[28:31], v[196:199]
    v_mfma_f32_16x16x32_bf16 v[200:203], a[152:155], a[12:15], v[200:203]
    v_mfma_f32_16x16x32_bf16 v[200:203], a[184:187], a[28:31], v[200:203]
    v_mfma_f32_16x16x32_bf16 v[204:207], a[156:159], a[12:15], v[204:207]
    v_mfma_f32_16x16x32_bf16 v[204:207], a[188:191], a[28:31], v[204:207]
    s_waitcnt vmcnt(26) lgkmcnt(0)
    v_mfma_f32_16x16x32_bf16 v[80:83], a[192:195], a[32:35], v[80:83]
    ds_read_b64_tr_b16 a[128:129], v230 offset:32768
    v_mfma_f32_16x16x32_bf16 v[80:83], a[224:227], a[48:51], v[80:83]
    buffer_load_dwordx4 a[0:3], v242, s[20:23], s39 offen offset:0 sc1
    v_mfma_f32_16x16x32_bf16 v[84:87], a[196:199], a[32:35], v[84:87]
    s_add_u32 m0, s29, 65536
    ds_read_b64_tr_b16 a[130:131], v230 offset:33792
    v_mfma_f32_16x16x32_bf16 v[84:87], a[228:231], a[48:51], v[84:87]
    s_mov_b32 s47, 0
    ds_read_b64_tr_b16 a[160:161], v230 offset:40960
    v_mfma_f32_16x16x32_bf16 v[88:91], a[200:203], a[32:35], v[88:91]
    ds_read_b64_tr_b16 a[162:163], v230 offset:41984
    v_mfma_f32_16x16x32_bf16 v[88:91], a[232:235], a[48:51], v[88:91]
    buffer_load_dwordx4 v224, s[12:15], s47 offen offset:0 sc1 nt lds
    v_mfma_f32_16x16x32_bf16 v[92:95], a[204:207], a[32:35], v[92:95]
    ds_read_b64_tr_b16 a[132:133], v230 offset:32776
    v_mfma_f32_16x16x32_bf16 v[92:95], a[236:239], a[48:51], v[92:95]
    ds_read_b64_tr_b16 a[134:135], v230 offset:33800
    v_mfma_f32_16x16x32_bf16 v[96:99], a[208:211], a[32:35], v[96:99]
    ds_read_b64_tr_b16 a[164:165], v230 offset:40968
    v_mfma_f32_16x16x32_bf16 v[96:99], a[240:243], a[48:51], v[96:99]
    buffer_load_dwordx4 a[16:19], v242, s[20:23], s39 offen offset:1024 sc1
    v_mfma_f32_16x16x32_bf16 v[100:103], a[212:215], a[32:35], v[100:103]
    ds_read_b64_tr_b16 a[166:167], v230 offset:41992
    v_mfma_f32_16x16x32_bf16 v[100:103], a[244:247], a[48:51], v[100:103]
    ds_read_b64_tr_b16 a[136:137], v231 offset:32768
    v_mfma_f32_16x16x32_bf16 v[104:107], a[216:219], a[32:35], v[104:107]
    ds_read_b64_tr_b16 a[138:139], v231 offset:33792
    v_mfma_f32_16x16x32_bf16 v[104:107], a[248:251], a[48:51], v[104:107]
    buffer_load_dwordx4 v225, s[12:15], s47 offen offset:1024 sc1 nt lds
    v_mfma_f32_16x16x32_bf16 v[108:111], a[220:223], a[32:35], v[108:111]
    ds_read_b64_tr_b16 a[168:169], v231 offset:40960
    v_mfma_f32_16x16x32_bf16 v[108:111], a[252:255], a[48:51], v[108:111]
    s_waitcnt vmcnt(28)
    ds_read_b64_tr_b16 a[170:171], v231 offset:41984
    v_mfma_f32_16x16x32_bf16 v[112:115], a[192:195], a[36:39], v[112:115]
    ds_read_b64_tr_b16 a[140:141], v231 offset:32776
    v_mfma_f32_16x16x32_bf16 v[112:115], a[224:227], a[52:55], v[112:115]
    buffer_load_dwordx4 a[4:7], v243, s[20:23], s39 offen offset:0 sc1
    v_mfma_f32_16x16x32_bf16 v[116:119], a[196:199], a[36:39], v[116:119]
    ds_read_b64_tr_b16 a[142:143], v231 offset:33800
    v_mfma_f32_16x16x32_bf16 v[116:119], a[228:231], a[52:55], v[116:119]
    ds_read_b64_tr_b16 a[172:173], v231 offset:40968
    v_mfma_f32_16x16x32_bf16 v[120:123], a[200:203], a[36:39], v[120:123]
    ds_read_b64_tr_b16 a[174:175], v231 offset:41992
    v_mfma_f32_16x16x32_bf16 v[120:123], a[232:235], a[52:55], v[120:123]
    buffer_load_dwordx4 v224, s[12:15], s47 offen offset:2048 sc1 nt lds
    v_mfma_f32_16x16x32_bf16 v[124:127], a[204:207], a[36:39], v[124:127]
    ds_read_b64_tr_b16 a[144:145], v232 offset:32768
    v_mfma_f32_16x16x32_bf16 v[124:127], a[236:239], a[52:55], v[124:127]
    ds_read_b64_tr_b16 a[146:147], v232 offset:33792
    v_mfma_f32_16x16x32_bf16 v[128:131], a[208:211], a[36:39], v[128:131]
    ds_read_b64_tr_b16 a[176:177], v232 offset:40960
    v_mfma_f32_16x16x32_bf16 v[128:131], a[240:243], a[52:55], v[128:131]
    buffer_load_dwordx4 a[20:23], v243, s[20:23], s39 offen offset:1024 sc1
    v_mfma_f32_16x16x32_bf16 v[132:135], a[212:215], a[36:39], v[132:135]
    ds_read_b64_tr_b16 a[178:179], v232 offset:41984
    v_mfma_f32_16x16x32_bf16 v[132:135], a[244:247], a[52:55], v[132:135]
    ds_read_b64_tr_b16 a[148:149], v232 offset:32776
    v_mfma_f32_16x16x32_bf16 v[136:139], a[216:219], a[36:39], v[136:139]
    ds_read_b64_tr_b16 a[150:151], v232 offset:33800
    v_mfma_f32_16x16x32_bf16 v[136:139], a[248:251], a[52:55], v[136:139]
    buffer_load_dwordx4 v225, s[12:15], s47 offen offset:3072 sc1 nt lds
    v_mfma_f32_16x16x32_bf16 v[140:143], a[220:223], a[36:39], v[140:143]
    ds_read_b64_tr_b16 a[180:181], v232 offset:40968
    v_mfma_f32_16x16x32_bf16 v[140:143], a[252:255], a[52:55], v[140:143]
    s_waitcnt vmcnt(30)
    ds_read_b64_tr_b16 a[182:183], v232 offset:41992
    v_mfma_f32_16x16x32_bf16 v[144:147], a[192:195], a[40:43], v[144:147]
    ds_read_b64_tr_b16 a[152:153], v233 offset:32768
    v_mfma_f32_16x16x32_bf16 v[144:147], a[224:227], a[56:59], v[144:147]
    buffer_load_dwordx4 a[8:11], v244, s[20:23], s39 offen offset:0 sc1
    v_mfma_f32_16x16x32_bf16 v[148:151], a[196:199], a[40:43], v[148:151]
    ds_read_b64_tr_b16 a[154:155], v233 offset:33792
    v_mfma_f32_16x16x32_bf16 v[148:151], a[228:231], a[56:59], v[148:151]
    ds_read_b64_tr_b16 a[184:185], v233 offset:40960
    v_mfma_f32_16x16x32_bf16 v[152:155], a[200:203], a[40:43], v[152:155]
    ds_read_b64_tr_b16 a[186:187], v233 offset:41984
    v_mfma_f32_16x16x32_bf16 v[152:155], a[232:235], a[56:59], v[152:155]
    ds_read_b64_tr_b16 a[156:157], v233 offset:32776
    v_mfma_f32_16x16x32_bf16 v[156:159], a[204:207], a[40:43], v[156:159]
    ds_read_b64_tr_b16 a[158:159], v233 offset:33800
    v_mfma_f32_16x16x32_bf16 v[156:159], a[236:239], a[56:59], v[156:159]
    ds_read_b64_tr_b16 a[188:189], v233 offset:40968
    v_mfma_f32_16x16x32_bf16 v[160:163], a[208:211], a[40:43], v[160:163]
    ds_read_b64_tr_b16 a[190:191], v233 offset:41992
    v_mfma_f32_16x16x32_bf16 v[160:163], a[240:243], a[56:59], v[160:163]
    buffer_load_dwordx4 a[24:27], v244, s[20:23], s39 offen offset:1024 sc1
    v_mfma_f32_16x16x32_bf16 v[164:167], a[212:215], a[40:43], v[164:167]
    v_mfma_f32_16x16x32_bf16 v[164:167], a[244:247], a[56:59], v[164:167]
    v_mfma_f32_16x16x32_bf16 v[168:171], a[216:219], a[40:43], v[168:171]
    v_mfma_f32_16x16x32_bf16 v[168:171], a[248:251], a[56:59], v[168:171]
    v_mfma_f32_16x16x32_bf16 v[172:175], a[220:223], a[40:43], v[172:175]
    v_mfma_f32_16x16x32_bf16 v[172:175], a[252:255], a[56:59], v[172:175]
    s_waitcnt vmcnt(30)
    v_mfma_f32_16x16x32_bf16 v[176:179], a[192:195], a[44:47], v[176:179]
    v_mfma_f32_16x16x32_bf16 v[176:179], a[224:227], a[60:63], v[176:179]
    buffer_load_dwordx4 a[12:15], v245, s[20:23], s39 offen offset:0 sc1
    v_mfma_f32_16x16x32_bf16 v[180:183], a[196:199], a[44:47], v[180:183]
    v_mfma_f32_16x16x32_bf16 v[180:183], a[228:231], a[60:63], v[180:183]
    v_mfma_f32_16x16x32_bf16 v[184:187], a[200:203], a[44:47], v[184:187]
    v_mfma_f32_16x16x32_bf16 v[184:187], a[232:235], a[60:63], v[184:187]
    v_mfma_f32_16x16x32_bf16 v[188:191], a[204:207], a[44:47], v[188:191]
    v_mfma_f32_16x16x32_bf16 v[188:191], a[236:239], a[60:63], v[188:191]
    v_mfma_f32_16x16x32_bf16 v[192:195], a[208:211], a[44:47], v[192:195]
    v_mfma_f32_16x16x32_bf16 v[192:195], a[240:243], a[60:63], v[192:195]
    buffer_load_dwordx4 a[28:31], v245, s[20:23], s39 offen offset:1024 sc1
    v_mfma_f32_16x16x32_bf16 v[196:199], a[212:215], a[44:47], v[196:199]
    v_mfma_f32_16x16x32_bf16 v[196:199], a[244:247], a[60:63], v[196:199]
    v_mfma_f32_16x16x32_bf16 v[200:203], a[216:219], a[44:47], v[200:203]
    v_mfma_f32_16x16x32_bf16 v[200:203], a[248:251], a[60:63], v[200:203]
    v_mfma_f32_16x16x32_bf16 v[204:207], a[220:223], a[44:47], v[204:207]
    s_waitcnt vmcnt(30) lgkmcnt(0)
    v_mfma_f32_16x16x32_bf16 v[204:207], a[252:255], a[60:63], v[204:207]
    s_barrier
    v_mfma_f32_16x16x32_bf16 v[80:83], a[128:131], a[64:67], v[80:83]
    ds_read_b64_tr_b16 a[192:193], v230 offset:49152
    v_mfma_f32_16x16x32_bf16 v[80:83], a[160:163], a[80:83], v[80:83]
    buffer_load_dwordx4 a[32:35], v242, s[20:23], s39 offen offset:2048 sc1
    v_mfma_f32_16x16x32_bf16 v[84:87], a[132:135], a[64:67], v[84:87]
    ds_read_b64_tr_b16 a[194:195], v230 offset:50176
    v_mfma_f32_16x16x32_bf16 v[84:87], a[164:167], a[80:83], v[84:87]
    ds_read_b64_tr_b16 a[224:225], v230 offset:57344
    v_mfma_f32_16x16x32_bf16 v[88:91], a[136:139], a[64:67], v[88:91]
    ds_read_b64_tr_b16 a[226:227], v230 offset:58368
    v_mfma_f32_16x16x32_bf16 v[88:91], a[168:171], a[80:83], v[88:91]
    ds_read_b64_tr_b16 a[196:197], v230 offset:49160
    v_mfma_f32_16x16x32_bf16 v[92:95], a[140:143], a[64:67], v[92:95]
    ds_read_b64_tr_b16 a[198:199], v230 offset:50184
    v_mfma_f32_16x16x32_bf16 v[92:95], a[172:175], a[80:83], v[92:95]
    ds_read_b64_tr_b16 a[228:229], v230 offset:57352
    v_mfma_f32_16x16x32_bf16 v[96:99], a[144:147], a[64:67], v[96:99]
    ds_read_b64_tr_b16 a[230:231], v230 offset:58376
    v_mfma_f32_16x16x32_bf16 v[96:99], a[176:179], a[80:83], v[96:99]
    buffer_load_dwordx4 a[48:51], v242, s[20:23], s39 offen offset:3072 sc1
    v_mfma_f32_16x16x32_bf16 v[100:103], a[148:151], a[64:67], v[100:103]
    ds_read_b64_tr_b16 a[200:201], v231 offset:49152
    v_mfma_f32_16x16x32_bf16 v[100:103], a[180:183], a[80:83], v[100:103]
    ds_read_b64_tr_b16 a[202:203], v231 offset:50176
    v_mfma_f32_16x16x32_bf16 v[104:107], a[152:155], a[64:67], v[104:107]
    ds_read_b64_tr_b16 a[232:233], v231 offset:57344
    v_mfma_f32_16x16x32_bf16 v[104:107], a[184:187], a[80:83], v[104:107]
    ds_read_b64_tr_b16 a[234:235], v231 offset:58368
    v_mfma_f32_16x16x32_bf16 v[108:111], a[156:159], a[64:67], v[108:111]
    ds_read_b64_tr_b16 a[204:205], v231 offset:49160
    v_mfma_f32_16x16x32_bf16 v[108:111], a[188:191], a[80:83], v[108:111]
    s_waitcnt vmcnt(30)
    ds_read_b64_tr_b16 a[206:207], v231 offset:50184
    v_accvgpr_write_b32 a64, 0
    v_mfma_f32_16x16x32_bf16 v[112:115], a[128:131], a[68:71], v[112:115]
    ds_read_b64_tr_b16 a[236:237], v231 offset:57352
    v_accvgpr_write_b32 a65, 0
    v_mfma_f32_16x16x32_bf16 v[112:115], a[160:163], a[84:87], v[112:115]
    buffer_load_dwordx4 a[36:39], v243, s[20:23], s39 offen offset:2048 sc1
    v_mfma_f32_16x16x32_bf16 v[116:119], a[132:135], a[68:71], v[116:119]
    ds_read_b64_tr_b16 a[238:239], v231 offset:58376
    v_accvgpr_write_b32 a66, 0
    v_mfma_f32_16x16x32_bf16 v[116:119], a[164:167], a[84:87], v[116:119]
    ds_read_b64_tr_b16 a[208:209], v232 offset:49152
    v_accvgpr_write_b32 a67, 0
    v_mfma_f32_16x16x32_bf16 v[120:123], a[136:139], a[68:71], v[120:123]
    ds_read_b64_tr_b16 a[210:211], v232 offset:50176
    v_accvgpr_write_b32 a80, 0
    v_mfma_f32_16x16x32_bf16 v[120:123], a[168:171], a[84:87], v[120:123]
    ds_read_b64_tr_b16 a[240:241], v232 offset:57344
    v_accvgpr_write_b32 a81, 0
    v_mfma_f32_16x16x32_bf16 v[124:127], a[140:143], a[68:71], v[124:127]
    ds_read_b64_tr_b16 a[242:243], v232 offset:58368
    v_accvgpr_write_b32 a82, 0
    v_mfma_f32_16x16x32_bf16 v[124:127], a[172:175], a[84:87], v[124:127]
    ds_read_b64_tr_b16 a[212:213], v232 offset:49160
    v_accvgpr_write_b32 a83, 0
    v_mfma_f32_16x16x32_bf16 v[128:131], a[144:147], a[68:71], v[128:131]
    ds_read_b64_tr_b16 a[214:215], v232 offset:50184
    v_mfma_f32_16x16x32_bf16 v[128:131], a[176:179], a[84:87], v[128:131]
    buffer_load_dwordx4 a[52:55], v243, s[20:23], s39 offen offset:3072 sc1
    v_mfma_f32_16x16x32_bf16 v[132:135], a[148:151], a[68:71], v[132:135]
    ds_read_b64_tr_b16 a[244:245], v232 offset:57352
    v_mfma_f32_16x16x32_bf16 v[132:135], a[180:183], a[84:87], v[132:135]
    ds_read_b64_tr_b16 a[246:247], v232 offset:58376
    v_mfma_f32_16x16x32_bf16 v[136:139], a[152:155], a[68:71], v[136:139]
    ds_read_b64_tr_b16 a[216:217], v233 offset:49152
    v_mfma_f32_16x16x32_bf16 v[136:139], a[184:187], a[84:87], v[136:139]
    ds_read_b64_tr_b16 a[218:219], v233 offset:50176
    v_mfma_f32_16x16x32_bf16 v[140:143], a[156:159], a[68:71], v[140:143]
    ds_read_b64_tr_b16 a[248:249], v233 offset:57344
    v_mfma_f32_16x16x32_bf16 v[140:143], a[188:191], a[84:87], v[140:143]
    s_waitcnt vmcnt(30)
    ds_read_b64_tr_b16 a[250:251], v233 offset:58368
    v_accvgpr_write_b32 a68, 0
    v_mfma_f32_16x16x32_bf16 v[144:147], a[128:131], a[72:75], v[144:147]
    ds_read_b64_tr_b16 a[220:221], v233 offset:49160
    v_accvgpr_write_b32 a69, 0
    v_mfma_f32_16x16x32_bf16 v[144:147], a[160:163], a[88:91], v[144:147]
    buffer_load_dwordx4 a[40:43], v244, s[20:23], s39 offen offset:2048 sc1
    v_mfma_f32_16x16x32_bf16 v[148:151], a[132:135], a[72:75], v[148:151]
    s_add_u32 m0, s29, 16384
    ds_read_b64_tr_b16 a[222:223], v233 offset:50184
    v_accvgpr_write_b32 a70, 0
    v_mfma_f32_16x16x32_bf16 v[148:151], a[164:167], a[88:91], v[148:151]
    s_mov_b32 s47, 16384
    ds_read_b64_tr_b16 a[252:253], v233 offset:57352
    v_accvgpr_write_b32 a71, 0
    v_mfma_f32_16x16x32_bf16 v[152:155], a[136:139], a[72:75], v[152:155]
    ds_read_b64_tr_b16 a[254:255], v233 offset:58376
    v_accvgpr_write_b32 a84, 0
    v_mfma_f32_16x16x32_bf16 v[152:155], a[168:171], a[88:91], v[152:155]
    buffer_load_dwordx4 v224, s[8:11], s47 offen offset:0 sc1 nt lds
    v_mfma_f32_16x16x32_bf16 v[156:159], a[140:143], a[72:75], v[156:159]
    v_accvgpr_write_b32 a85, 0
    v_accvgpr_write_b32 a86, 0
    v_mfma_f32_16x16x32_bf16 v[156:159], a[172:175], a[88:91], v[156:159]
    v_accvgpr_write_b32 a87, 0
    v_mfma_f32_16x16x32_bf16 v[160:163], a[144:147], a[72:75], v[160:163]
    v_mfma_f32_16x16x32_bf16 v[160:163], a[176:179], a[88:91], v[160:163]
    buffer_load_dwordx4 a[56:59], v244, s[20:23], s39 offen offset:3072 sc1
    v_mfma_f32_16x16x32_bf16 v[164:167], a[148:151], a[72:75], v[164:167]
    v_mfma_f32_16x16x32_bf16 v[164:167], a[180:183], a[88:91], v[164:167]
    v_mfma_f32_16x16x32_bf16 v[168:171], a[152:155], a[72:75], v[168:171]
    v_mfma_f32_16x16x32_bf16 v[168:171], a[184:187], a[88:91], v[168:171]
    buffer_load_dwordx4 v225, s[8:11], s47 offen offset:1024 sc1 nt lds
    v_mfma_f32_16x16x32_bf16 v[172:175], a[156:159], a[72:75], v[172:175]
    v_mfma_f32_16x16x32_bf16 v[172:175], a[188:191], a[88:91], v[172:175]
    s_waitcnt vmcnt(32)
    v_accvgpr_write_b32 a72, 0
    v_accvgpr_write_b32 a73, 0
    v_mfma_f32_16x16x32_bf16 v[176:179], a[128:131], a[76:79], v[176:179]
    v_accvgpr_write_b32 a74, 0
    v_accvgpr_write_b32 a75, 0
    v_mfma_f32_16x16x32_bf16 v[176:179], a[160:163], a[92:95], v[176:179]
    buffer_load_dwordx4 a[44:47], v245, s[20:23], s39 offen offset:2048 sc1
    v_mfma_f32_16x16x32_bf16 v[180:183], a[132:135], a[76:79], v[180:183]
    v_accvgpr_write_b32 a88, 0
    v_accvgpr_write_b32 a89, 0
    v_mfma_f32_16x16x32_bf16 v[180:183], a[164:167], a[92:95], v[180:183]
    v_accvgpr_write_b32 a90, 0
    v_accvgpr_write_b32 a91, 0
    v_mfma_f32_16x16x32_bf16 v[184:187], a[136:139], a[76:79], v[184:187]
    v_mfma_f32_16x16x32_bf16 v[184:187], a[168:171], a[92:95], v[184:187]
    buffer_load_dwordx4 v224, s[8:11], s47 offen offset:2048 sc1 nt lds
    v_mfma_f32_16x16x32_bf16 v[188:191], a[140:143], a[76:79], v[188:191]
    v_mfma_f32_16x16x32_bf16 v[188:191], a[172:175], a[92:95], v[188:191]
    v_mfma_f32_16x16x32_bf16 v[192:195], a[144:147], a[76:79], v[192:195]
    v_mfma_f32_16x16x32_bf16 v[192:195], a[176:179], a[92:95], v[192:195]
    buffer_load_dwordx4 a[60:63], v245, s[20:23], s39 offen offset:3072 sc1
    v_mfma_f32_16x16x32_bf16 v[196:199], a[148:151], a[76:79], v[196:199]
    v_mfma_f32_16x16x32_bf16 v[196:199], a[180:183], a[92:95], v[196:199]
    v_mfma_f32_16x16x32_bf16 v[200:203], a[152:155], a[76:79], v[200:203]
    v_mfma_f32_16x16x32_bf16 v[200:203], a[184:187], a[92:95], v[200:203]
    buffer_load_dwordx4 v225, s[8:11], s47 offen offset:3072 sc1 nt lds
    v_mfma_f32_16x16x32_bf16 v[204:207], a[156:159], a[76:79], v[204:207]
    v_mfma_f32_16x16x32_bf16 v[204:207], a[188:191], a[92:95], v[204:207]
    s_waitcnt vmcnt(33) lgkmcnt(0)
    v_accvgpr_write_b32 a76, 0
    v_accvgpr_write_b32 a77, 0
    v_mfma_f32_16x16x32_bf16 v[80:83], a[192:195], a[96:99], v[80:83]
    s_mov_b32 s30, 49152
    ds_read_b64_tr_b16 a[128:129], v234 offset:0
    v_mov_b32 v230, 0
    v_mfma_f32_16x16x32_bf16 v[80:83], a[224:227], a[112:115], v[80:83]
    s_mov_b32 s31, 0
    ds_read_b64_tr_b16 a[130:131], v234 offset:1024
    v_mov_b32 v231, 0
    v_mfma_f32_16x16x32_bf16 v[84:87], a[196:199], a[96:99], v[84:87]
    s_add_u32 m0, s29, 81920
    ds_read_b64_tr_b16 a[160:161], v234 offset:8192
    v_mov_b32 v232, 0
    v_mfma_f32_16x16x32_bf16 v[84:87], a[228:231], a[112:115], v[84:87]
    s_mov_b32 s47, 16384
    ds_read_b64_tr_b16 a[162:163], v234 offset:9216
    v_mov_b32 v233, 0
    v_mfma_f32_16x16x32_bf16 v[88:91], a[200:203], a[96:99], v[88:91]
    s_and_b32 s20, s2, 1
    ds_read_b64_tr_b16 a[132:133], v234 offset:8
    v_accvgpr_write_b32 a78, 0
    v_mfma_f32_16x16x32_bf16 v[88:91], a[232:235], a[112:115], v[88:91]
    s_mul_i32 s21, s20, 2621440
    buffer_load_dwordx4 v224, s[12:15], s47 offen offset:0 sc1 nt lds
    v_mfma_f32_16x16x32_bf16 v[92:95], a[204:207], a[96:99], v[92:95]
    s_bfe_u32 s7, s2, 0x20003
    ds_read_b64_tr_b16 a[134:135], v234 offset:1032
    v_accvgpr_write_b32 a79, 0
    v_mfma_f32_16x16x32_bf16 v[92:95], a[236:239], a[112:115], v[92:95]
    s_mul_i32 s7, s7, 655360
    ds_read_b64_tr_b16 a[164:165], v234 offset:8200
    v_accvgpr_write_b32 a92, 0
    v_mfma_f32_16x16x32_bf16 v[96:99], a[208:211], a[96:99], v[96:99]
    s_mov_b32 s46, 48349824
    ds_read_b64_tr_b16 a[166:167], v234 offset:9224
    v_accvgpr_write_b32 a93, 0
    v_mfma_f32_16x16x32_bf16 v[96:99], a[240:243], a[112:115], v[96:99]
    s_add_u32 s7, s7, s21
    ds_read_b64_tr_b16 a[136:137], v235 offset:0
    v_accvgpr_write_b32 a94, 0
    v_mfma_f32_16x16x32_bf16 v[100:103], a[212:215], a[96:99], v[100:103]
    s_mul_i32 s22, s28, 81920
    ds_read_b64_tr_b16 a[138:139], v235 offset:1024
    v_accvgpr_write_b32 a95, 0
    v_mfma_f32_16x16x32_bf16 v[100:103], a[244:247], a[112:115], v[100:103]
    s_add_u32 s7, s7, s22
    buffer_load_dword v13, v12, s[52:55], s46 offen sc1
    v_mfma_f32_16x16x32_bf16 v[104:107], a[216:219], a[96:99], v[104:107]
    s_bfe_u32 s22, s2, 0x10005
    ds_read_b64_tr_b16 a[168:169], v235 offset:8192
    v_mfma_f32_16x16x32_bf16 v[104:107], a[248:251], a[112:115], v[104:107]
    s_mul_i32 s22, s22, 327680
    buffer_load_dwordx4 v225, s[12:15], s47 offen offset:1024 sc1 nt lds
    v_mfma_f32_16x16x32_bf16 v[108:111], a[220:223], a[96:99], v[108:111]
    s_add_u32 s7, s7, s22
    ds_read_b64_tr_b16 a[170:171], v235 offset:9216
    v_mfma_f32_16x16x32_bf16 v[108:111], a[252:255], a[112:115], v[108:111]
    s_waitcnt vmcnt(32)
    ds_read_b64_tr_b16 a[140:141], v235 offset:8
    v_accvgpr_write_b32 a96, 0
    v_mfma_f32_16x16x32_bf16 v[112:115], a[192:195], a[100:103], v[112:115]
    s_add_u32 s7, s7, 33554432
    ds_read_b64_tr_b16 a[142:143], v235 offset:1032
    v_accvgpr_write_b32 a97, 0
    v_mfma_f32_16x16x32_bf16 v[112:115], a[224:227], a[116:119], v[112:115]
    s_sub_u32 s22, s7, s29
    ds_read_b64_tr_b16 a[172:173], v235 offset:8200
    v_accvgpr_write_b32 a98, 0
    v_mfma_f32_16x16x32_bf16 v[116:119], a[196:199], a[100:103], v[116:119]
    s_add_u32 s22, s22, 57344
    ds_read_b64_tr_b16 a[174:175], v235 offset:9224
    v_accvgpr_write_b32 a99, 0
    v_mfma_f32_16x16x32_bf16 v[116:119], a[228:231], a[116:119], v[116:119]
    s_add_u32 s38, s42, s22
    s_addc_u32 s39, s43, 0
    ds_read_b64_tr_b16 a[144:145], v236 offset:0
    v_accvgpr_write_b32 a112, 0
    v_mfma_f32_16x16x32_bf16 v[120:123], a[200:203], a[100:103], v[120:123]
    s_add_u32 s40, s38, 4096
    s_addc_u32 s41, s39, 0
    ds_read_b64_tr_b16 a[146:147], v236 offset:1024
    v_accvgpr_write_b32 a113, 0
    v_mfma_f32_16x16x32_bf16 v[120:123], a[232:235], a[116:119], v[120:123]
    s_lshl_b32 s36, s20, 11
    buffer_load_dwordx4 v224, s[12:15], s47 offen offset:2048 sc1 nt lds
    v_mfma_f32_16x16x32_bf16 v[124:127], a[204:207], a[100:103], v[124:127]
    s_add_u32 s36, s36, 48234496
    ds_read_b64_tr_b16 a[176:177], v236 offset:8192
    v_accvgpr_write_b32 a114, 0
    v_mfma_f32_16x16x32_bf16 v[124:127], a[236:239], a[116:119], v[124:127]
    s_mov_b32 s22, 16384
    ds_read_b64_tr_b16 a[178:179], v236 offset:9216
    v_accvgpr_write_b32 a115, 0
    v_mfma_f32_16x16x32_bf16 v[128:131], a[208:211], a[100:103], v[128:131]
    s_mov_b32 s23, 0
    ds_read_b64_tr_b16 a[148:149], v236 offset:8
    v_mfma_f32_16x16x32_bf16 v[128:131], a[240:243], a[116:119], v[128:131]
    ds_read_b64_tr_b16 a[150:151], v236 offset:1032
    v_lshlrev_b32 v7, 3, v1
    v_mfma_f32_16x16x32_bf16 v[132:135], a[212:215], a[100:103], v[132:135]
    ds_read_b64_tr_b16 a[180:181], v236 offset:8200
    v_lshlrev_b32 v11, 7, v0
    v_mfma_f32_16x16x32_bf16 v[132:135], a[244:247], a[116:119], v[132:135]
    s_mov_b32 s45, 99
    ds_read_b64_tr_b16 a[182:183], v236 offset:9224
    v_mfma_f32_16x16x32_bf16 v[136:139], a[216:219], a[100:103], v[136:139]
    s_mov_b32 s16, s4
    ds_read_b64_tr_b16 a[152:153], v237 offset:0
    v_mfma_f32_16x16x32_bf16 v[136:139], a[248:251], a[116:119], v[136:139]
    s_mov_b32 s17, s5
    buffer_load_dwordx4 v225, s[12:15], s47 offen offset:3072 sc1 nt lds
    v_mfma_f32_16x16x32_bf16 v[140:143], a[220:223], a[100:103], v[140:143]
    s_mov_b32 s18, 2621440
    ds_read_b64_tr_b16 a[154:155], v237 offset:1024
    v_mfma_f32_16x16x32_bf16 v[140:143], a[252:255], a[116:119], v[140:143]
    s_waitcnt vmcnt(31)
    ds_read_b64_tr_b16 a[184:185], v237 offset:8192
    v_accvgpr_write_b32 a100, 0
    v_mfma_f32_16x16x32_bf16 v[144:147], a[192:195], a[104:107], v[144:147]
    s_bfe_u32 s33, s2, 0x20001
    ds_read_b64_tr_b16 a[186:187], v237 offset:9216
    v_accvgpr_write_b32 a101, 0
    v_mfma_f32_16x16x32_bf16 v[144:147], a[224:227], a[120:123], v[144:147]
    s_lshl_b32 s33, s33, 3
    ds_read_b64_tr_b16 a[156:157], v237 offset:8
    v_accvgpr_write_b32 a102, 0
    v_mfma_f32_16x16x32_bf16 v[148:151], a[196:199], a[104:107], v[148:151]
    s_add_u32 m0, s29, 32768
    ds_read_b64_tr_b16 a[158:159], v237 offset:1032
    v_accvgpr_write_b32 a103, 0
    v_mfma_f32_16x16x32_bf16 v[148:151], a[228:231], a[120:123], v[148:151]
    s_mov_b32 s47, 32768
    ds_read_b64_tr_b16 a[188:189], v237 offset:8200
    v_accvgpr_write_b32 a116, 0
    v_mfma_f32_16x16x32_bf16 v[152:155], a[200:203], a[104:107], v[152:155]
    s_lshr_b32 s34, s2, 5
    ds_read_b64_tr_b16 a[190:191], v237 offset:9224
    v_accvgpr_write_b32 a117, 0
    v_mfma_f32_16x16x32_bf16 v[152:155], a[232:235], a[120:123], v[152:155]
    s_add_u32 s33, s33, s34
    buffer_load_dwordx4 v224, s[8:11], s47 offen offset:0 sc1 nt lds
    v_mfma_f32_16x16x32_bf16 v[156:159], a[204:207], a[104:107], v[156:159]
    s_mul_i32 s33, s33, 81920
    v_accvgpr_write_b32 a118, 0
    v_accvgpr_write_b32 a119, 0
    v_mfma_f32_16x16x32_bf16 v[156:159], a[236:239], a[120:123], v[156:159]
    s_bfe_u32 s34, s2, 0x20003
    v_mfma_f32_16x16x32_bf16 v[160:163], a[208:211], a[104:107], v[160:163]
    s_lshl_b32 s35, s20, 2
    v_mfma_f32_16x16x32_bf16 v[160:163], a[240:243], a[120:123], v[160:163]
    s_add_u32 s35, s35, s34
    v_mfma_f32_16x16x32_bf16 v[164:167], a[212:215], a[104:107], v[164:167]
    s_mul_i32 s35, s35, 160
    v_mfma_f32_16x16x32_bf16 v[164:167], a[244:247], a[120:123], v[164:167]
    s_add_u32 s33, s33, s35
    v_mfma_f32_16x16x32_bf16 v[168:171], a[216:219], a[104:107], v[168:171]
    s_and_b32 s34, s34, 1
    s_cselect_b32 s35, 0, 128
    v_mfma_f32_16x16x32_bf16 v[168:171], a[248:251], a[120:123], v[168:171]
    s_lshl_b32 s34, s34, 5
    buffer_load_dwordx4 v225, s[8:11], s47 offen offset:1024 sc1 nt lds
    v_mfma_f32_16x16x32_bf16 v[172:175], a[220:223], a[104:107], v[172:175]
    s_add_u32 s34, s34, s33
    v_mfma_f32_16x16x32_bf16 v[172:175], a[252:255], a[120:123], v[172:175]
    s_waitcnt vmcnt(31)
    v_accvgpr_write_b32 a104, 0
    v_accvgpr_write_b32 a105, 0
    v_mfma_f32_16x16x32_bf16 v[176:179], a[192:195], a[108:111], v[176:179]
    s_add_u32 s35, s35, s33
    v_accvgpr_write_b32 a106, 0
    v_accvgpr_write_b32 a107, 0
    v_mfma_f32_16x16x32_bf16 v[176:179], a[224:227], a[124:127], v[176:179]
    v_lshl_add_u32 v8, v2, 4, v3
    v_accvgpr_write_b32 a120, 0
    v_mfma_f32_16x16x32_bf16 v[180:183], a[196:199], a[108:111], v[180:183]
    v_mul_u32_u24 v8, 1280, v8
    v_accvgpr_write_b32 a121, 0
    v_mfma_f32_16x16x32_bf16 v[180:183], a[228:231], a[124:127], v[180:183]
    v_lshl_add_u32 v8, v4, 3, v8
    v_accvgpr_write_b32 a122, 0
    v_mfma_f32_16x16x32_bf16 v[184:187], a[200:203], a[108:111], v[184:187]
    v_accvgpr_write_b32 a123, 0
    v_mfma_f32_16x16x32_bf16 v[184:187], a[232:235], a[124:127], v[184:187]
    buffer_load_dwordx4 v224, s[8:11], s47 offen offset:2048 sc1 nt lds
    v_mfma_f32_16x16x32_bf16 v[188:191], a[204:207], a[108:111], v[188:191]
    v_mfma_f32_16x16x32_bf16 v[188:191], a[236:239], a[124:127], v[188:191]
    v_mfma_f32_16x16x32_bf16 v[192:195], a[208:211], a[108:111], v[192:195]
    v_mfma_f32_16x16x32_bf16 v[192:195], a[240:243], a[124:127], v[192:195]
    v_mfma_f32_16x16x32_bf16 v[196:199], a[212:215], a[108:111], v[196:199]
    v_mfma_f32_16x16x32_bf16 v[196:199], a[244:247], a[124:127], v[196:199]
    v_mfma_f32_16x16x32_bf16 v[200:203], a[216:219], a[108:111], v[200:203]
    v_mfma_f32_16x16x32_bf16 v[200:203], a[248:251], a[124:127], v[200:203]
    buffer_load_dwordx4 v225, s[8:11], s47 offen offset:3072 sc1 nt lds
    v_mfma_f32_16x16x32_bf16 v[204:207], a[220:223], a[108:111], v[204:207]
    s_waitcnt vmcnt(25) lgkmcnt(0)
    v_mfma_f32_16x16x32_bf16 v[204:207], a[252:255], a[124:127], v[204:207]
    s_barrier
    v_accvgpr_write_b32 a108, 0
    v_accvgpr_write_b32 a109, 0
    v_mfma_f32_16x16x32_bf16 v[80:83], a[128:131], a[0:3], v[80:83]
    ds_read_b64_tr_b16 a[192:193], v234 offset:16384
    v_accvgpr_write_b32 a110, 0
    v_mfma_f32_16x16x32_bf16 v[80:83], a[160:163], a[16:19], v[80:83]
    ds_read_b64_tr_b16 a[194:195], v234 offset:17408
    v_accvgpr_write_b32 a111, 0
    v_mfma_f32_16x16x32_bf16 v[84:87], a[132:135], a[0:3], v[84:87]
    s_add_u32 m0, s29, 98304
    ds_read_b64_tr_b16 a[224:225], v234 offset:24576
    v_accvgpr_write_b32 a124, 0
    v_mfma_f32_16x16x32_bf16 v[84:87], a[164:167], a[16:19], v[84:87]
    s_mov_b32 s47, 32768
    ds_read_b64_tr_b16 a[226:227], v234 offset:25600
    v_accvgpr_write_b32 a125, 0
    v_mfma_f32_16x16x32_bf16 v[88:91], a[136:139], a[0:3], v[88:91]
    ds_read_b64_tr_b16 a[196:197], v234 offset:16392
    v_accvgpr_write_b32 a126, 0
    v_mfma_f32_16x16x32_bf16 v[88:91], a[168:171], a[16:19], v[88:91]
    buffer_load_dwordx4 v224, s[12:15], s47 offen offset:0 sc1 nt lds
    v_mfma_f32_16x16x32_bf16 v[92:95], a[140:143], a[0:3], v[92:95]
    ds_read_b64_tr_b16 a[198:199], v234 offset:17416
    v_accvgpr_write_b32 a127, 0
    v_mfma_f32_16x16x32_bf16 v[92:95], a[172:175], a[16:19], v[92:95]
    ds_read_b64_tr_b16 a[228:229], v234 offset:24584
    v_mfma_f32_16x16x32_bf16 v[96:99], a[144:147], a[0:3], v[96:99]
    ds_read_b64_tr_b16 a[230:231], v234 offset:25608
    v_mfma_f32_16x16x32_bf16 v[96:99], a[176:179], a[16:19], v[96:99]
    ds_read_b64_tr_b16 a[200:201], v235 offset:16384
    v_mfma_f32_16x16x32_bf16 v[100:103], a[148:151], a[0:3], v[100:103]
    ds_read_b64_tr_b16 a[202:203], v235 offset:17408
    v_mfma_f32_16x16x32_bf16 v[100:103], a[180:183], a[16:19], v[100:103]
    ds_read_b64_tr_b16 a[232:233], v235 offset:24576
    v_mfma_f32_16x16x32_bf16 v[104:107], a[152:155], a[0:3], v[104:107]
    ds_read_b64_tr_b16 a[234:235], v235 offset:25600
    v_mfma_f32_16x16x32_bf16 v[104:107], a[184:187], a[16:19], v[104:107]
    buffer_load_dwordx4 v225, s[12:15], s47 offen offset:1024 sc1 nt lds
    v_mfma_f32_16x16x32_bf16 v[108:111], a[156:159], a[0:3], v[108:111]
    ds_read_b64_tr_b16 a[204:205], v235 offset:16392
    v_mfma_f32_16x16x32_bf16 v[108:111], a[188:191], a[16:19], v[108:111]
    s_waitcnt vmcnt(28)
    ds_read_b64_tr_b16 a[206:207], v235 offset:17416
    v_accvgpr_write_b32 a0, 0
    v_mfma_f32_16x16x32_bf16 v[112:115], a[128:131], a[4:7], v[112:115]
    ds_read_b64_tr_b16 a[236:237], v235 offset:24584
    v_accvgpr_write_b32 a1, 0
    v_mfma_f32_16x16x32_bf16 v[112:115], a[160:163], a[20:23], v[112:115]
    ds_read_b64_tr_b16 a[238:239], v235 offset:25608
    v_accvgpr_write_b32 a2, 0
    v_mfma_f32_16x16x32_bf16 v[116:119], a[132:135], a[4:7], v[116:119]
    ds_read_b64_tr_b16 a[208:209], v236 offset:16384
    v_accvgpr_write_b32 a3, 0
    v_mfma_f32_16x16x32_bf16 v[116:119], a[164:167], a[20:23], v[116:119]
    ds_read_b64_tr_b16 a[210:211], v236 offset:17408
    v_accvgpr_write_b32 a16, 0
    v_mfma_f32_16x16x32_bf16 v[120:123], a[136:139], a[4:7], v[120:123]
    ds_read_b64_tr_b16 a[240:241], v236 offset:24576
    v_accvgpr_write_b32 a17, 0
    v_mfma_f32_16x16x32_bf16 v[120:123], a[168:171], a[20:23], v[120:123]
    buffer_load_dwordx4 v224, s[12:15], s47 offen offset:2048 sc1 nt lds
    v_mfma_f32_16x16x32_bf16 v[124:127], a[140:143], a[4:7], v[124:127]
    ds_read_b64_tr_b16 a[242:243], v236 offset:25600
    v_accvgpr_write_b32 a18, 0
    v_mfma_f32_16x16x32_bf16 v[124:127], a[172:175], a[20:23], v[124:127]
    ds_read_b64_tr_b16 a[212:213], v236 offset:16392
    v_accvgpr_write_b32 a19, 0
    v_mfma_f32_16x16x32_bf16 v[128:131], a[144:147], a[4:7], v[128:131]
    ds_read_b64_tr_b16 a[214:215], v236 offset:17416
    v_mfma_f32_16x16x32_bf16 v[128:131], a[176:179], a[20:23], v[128:131]
    ds_read_b64_tr_b16 a[244:245], v236 offset:24584
    v_mfma_f32_16x16x32_bf16 v[132:135], a[148:151], a[4:7], v[132:135]
    ds_read_b64_tr_b16 a[246:247], v236 offset:25608
    v_mfma_f32_16x16x32_bf16 v[132:135], a[180:183], a[20:23], v[132:135]
    ds_read_b64_tr_b16 a[216:217], v237 offset:16384
    v_mfma_f32_16x16x32_bf16 v[136:139], a[152:155], a[4:7], v[136:139]
    ds_read_b64_tr_b16 a[218:219], v237 offset:17408
    v_mfma_f32_16x16x32_bf16 v[136:139], a[184:187], a[20:23], v[136:139]
    buffer_load_dwordx4 v225, s[12:15], s47 offen offset:3072 sc1 nt lds
    v_mfma_f32_16x16x32_bf16 v[140:143], a[156:159], a[4:7], v[140:143]
    ds_read_b64_tr_b16 a[248:249], v237 offset:24576
    v_mfma_f32_16x16x32_bf16 v[140:143], a[188:191], a[20:23], v[140:143]
    s_waitcnt vmcnt(27)
    ds_read_b64_tr_b16 a[250:251], v237 offset:25600
    v_accvgpr_write_b32 a4, 0
    v_mfma_f32_16x16x32_bf16 v[144:147], a[128:131], a[8:11], v[144:147]
    ds_read_b64_tr_b16 a[220:221], v237 offset:16392
    v_accvgpr_write_b32 a5, 0
    v_mfma_f32_16x16x32_bf16 v[144:147], a[160:163], a[24:27], v[144:147]
    ds_read_b64_tr_b16 a[222:223], v237 offset:17416
    v_accvgpr_write_b32 a6, 0
    v_mfma_f32_16x16x32_bf16 v[148:151], a[132:135], a[8:11], v[148:151]
    s_add_u32 m0, s29, 49152
    ds_read_b64_tr_b16 a[252:253], v237 offset:24584
    v_accvgpr_write_b32 a7, 0
    v_mfma_f32_16x16x32_bf16 v[148:151], a[164:167], a[24:27], v[148:151]
    s_mov_b32 s47, 49152
    ds_read_b64_tr_b16 a[254:255], v237 offset:25608
    v_accvgpr_write_b32 a20, 0
    v_mfma_f32_16x16x32_bf16 v[152:155], a[136:139], a[8:11], v[152:155]
    v_accvgpr_write_b32 a21, 0
    v_accvgpr_write_b32 a22, 0
    v_mfma_f32_16x16x32_bf16 v[152:155], a[168:171], a[24:27], v[152:155]
    buffer_load_dwordx4 v224, s[8:11], s47 offen offset:0 sc1 nt lds
    v_mfma_f32_16x16x32_bf16 v[156:159], a[140:143], a[8:11], v[156:159]
    v_accvgpr_write_b32 a23, 0
    v_mfma_f32_16x16x32_bf16 v[156:159], a[172:175], a[24:27], v[156:159]
    v_mfma_f32_16x16x32_bf16 v[160:163], a[144:147], a[8:11], v[160:163]
    v_mfma_f32_16x16x32_bf16 v[160:163], a[176:179], a[24:27], v[160:163]
    v_mfma_f32_16x16x32_bf16 v[164:167], a[148:151], a[8:11], v[164:167]
    v_mfma_f32_16x16x32_bf16 v[164:167], a[180:183], a[24:27], v[164:167]
    v_mfma_f32_16x16x32_bf16 v[168:171], a[152:155], a[8:11], v[168:171]
    v_mfma_f32_16x16x32_bf16 v[168:171], a[184:187], a[24:27], v[168:171]
    buffer_load_dwordx4 v225, s[8:11], s47 offen offset:1024 sc1 nt lds
    v_mfma_f32_16x16x32_bf16 v[172:175], a[156:159], a[8:11], v[172:175]
    v_mfma_f32_16x16x32_bf16 v[172:175], a[188:191], a[24:27], v[172:175]
    s_waitcnt vmcnt(27)
    v_accvgpr_write_b32 a8, 0
    v_accvgpr_write_b32 a9, 0
    v_mfma_f32_16x16x32_bf16 v[176:179], a[128:131], a[12:15], v[176:179]
    v_accvgpr_write_b32 a10, 0
    v_accvgpr_write_b32 a11, 0
    v_mfma_f32_16x16x32_bf16 v[176:179], a[160:163], a[28:31], v[176:179]
    v_accvgpr_write_b32 a24, 0
    v_accvgpr_write_b32 a25, 0
    v_mfma_f32_16x16x32_bf16 v[180:183], a[132:135], a[12:15], v[180:183]
    v_accvgpr_write_b32 a26, 0
    v_accvgpr_write_b32 a27, 0
    v_mfma_f32_16x16x32_bf16 v[180:183], a[164:167], a[28:31], v[180:183]
    v_mfma_f32_16x16x32_bf16 v[184:187], a[136:139], a[12:15], v[184:187]
    v_mfma_f32_16x16x32_bf16 v[184:187], a[168:171], a[28:31], v[184:187]
    buffer_load_dwordx4 v224, s[8:11], s47 offen offset:2048 sc1 nt lds
    v_mfma_f32_16x16x32_bf16 v[188:191], a[140:143], a[12:15], v[188:191]
    v_mfma_f32_16x16x32_bf16 v[188:191], a[172:175], a[28:31], v[188:191]
    v_mfma_f32_16x16x32_bf16 v[192:195], a[144:147], a[12:15], v[192:195]
    v_mfma_f32_16x16x32_bf16 v[192:195], a[176:179], a[28:31], v[192:195]
    v_mfma_f32_16x16x32_bf16 v[196:199], a[148:151], a[12:15], v[196:199]
    v_mfma_f32_16x16x32_bf16 v[196:199], a[180:183], a[28:31], v[196:199]
    v_mfma_f32_16x16x32_bf16 v[200:203], a[152:155], a[12:15], v[200:203]
    v_mfma_f32_16x16x32_bf16 v[200:203], a[184:187], a[28:31], v[200:203]
    buffer_load_dwordx4 v225, s[8:11], s47 offen offset:3072 sc1 nt lds
    v_mfma_f32_16x16x32_bf16 v[204:207], a[156:159], a[12:15], v[204:207]
    v_mfma_f32_16x16x32_bf16 v[204:207], a[188:191], a[28:31], v[204:207]
    s_waitcnt vmcnt(27) lgkmcnt(0)
    v_accvgpr_write_b32 a12, 0
    v_accvgpr_write_b32 a13, 0
    v_mfma_f32_16x16x32_bf16 v[80:83], a[192:195], a[32:35], v[80:83]
    ds_read_b128 a[128:131], v212 offset:0
    v_accvgpr_write_b32 a14, 0
    v_mfma_f32_16x16x32_bf16 v[80:83], a[224:227], a[48:51], v[80:83]
    buffer_load_dwordx2 v[234:235], v8, s[16:19], s34 offen offset:0
    v_mfma_f32_16x16x32_bf16 v[84:87], a[196:199], a[32:35], v[84:87]
    ds_read_b128 a[132:135], v213 offset:0
    v_accvgpr_write_b32 a15, 0
    v_mfma_f32_16x16x32_bf16 v[84:87], a[228:231], a[48:51], v[84:87]
    ds_read_b128 a[136:139], v214 offset:0
    v_accvgpr_write_b32 a28, 0
    v_mfma_f32_16x16x32_bf16 v[88:91], a[200:203], a[32:35], v[88:91]
    buffer_load_dwordx2 v[236:237], v8, s[16:19], s34 offen offset:32
    v_mfma_f32_16x16x32_bf16 v[88:91], a[232:235], a[48:51], v[88:91]
    ds_read_b128 a[140:143], v215 offset:0
    v_accvgpr_write_b32 a29, 0
    v_mfma_f32_16x16x32_bf16 v[92:95], a[204:207], a[32:35], v[92:95]
    ds_read_b128 a[144:147], v212 offset:4096
    v_accvgpr_write_b32 a30, 0
    v_mfma_f32_16x16x32_bf16 v[92:95], a[236:239], a[48:51], v[92:95]
    buffer_load_dwordx2 v[238:239], v8, s[16:19], s34 offen offset:64
    v_mfma_f32_16x16x32_bf16 v[96:99], a[208:211], a[32:35], v[96:99]
    ds_read_b128 a[148:151], v213 offset:4096
    v_cvt_pk_bf16_f32 v16, v80, v81
    v_mfma_f32_16x16x32_bf16 v[96:99], a[240:243], a[48:51], v[96:99]
    ds_read_b128 a[152:155], v214 offset:4096
    v_cvt_pk_bf16_f32 v17, v82, v83
    v_mfma_f32_16x16x32_bf16 v[100:103], a[212:215], a[32:35], v[100:103]
    buffer_load_dwordx2 v[240:241], v8, s[16:19], s34 offen offset:96
    v_mfma_f32_16x16x32_bf16 v[100:103], a[244:247], a[48:51], v[100:103]
    ds_read_b128 a[156:159], v215 offset:4096
    v_cvt_pk_bf16_f32 v18, v84, v85
    v_mfma_f32_16x16x32_bf16 v[104:107], a[216:219], a[32:35], v[104:107]
    ds_read_b128 a[160:163], v212 offset:8192
    v_cvt_pk_bf16_f32 v19, v86, v87
    v_mfma_f32_16x16x32_bf16 v[104:107], a[248:251], a[48:51], v[104:107]
    buffer_load_dwordx2 v[242:243], v8, s[16:19], s35 offen offset:0
    v_mfma_f32_16x16x32_bf16 v[108:111], a[220:223], a[32:35], v[108:111]
    s_mov_b32 s16, 1280
    ds_read_b128 a[164:167], v213 offset:8192
    v_cvt_pk_bf16_f32 v20, v88, v89
    v_mfma_f32_16x16x32_bf16 v[108:111], a[252:255], a[48:51], v[108:111]
    s_waitcnt vmcnt(30)
    ds_read_b128 a[168:171], v214 offset:8192
    v_cvt_pk_bf16_f32 v21, v90, v91
    v_mfma_f32_16x16x32_bf16 v[112:115], a[192:195], a[36:39], v[112:115]
    s_mov_b32 s17, 1
    ds_read_b128 a[172:175], v215 offset:8192
    v_cvt_pk_bf16_f32 v22, v92, v93
    v_mfma_f32_16x16x32_bf16 v[112:115], a[224:227], a[52:55], v[112:115]
    s_mov_b32 s18, 32
    ds_read_b128 a[176:179], v212 offset:12288
    v_cvt_pk_bf16_f32 v23, v94, v95
    v_mfma_f32_16x16x32_bf16 v[116:119], a[196:199], a[36:39], v[116:119]
    s_lshr_b32 s19, s2, 3
    ds_read_b128 a[180:183], v213 offset:12288
    v_cvt_pk_bf16_f32 v24, v96, v97
    v_mfma_f32_16x16x32_bf16 v[116:119], a[228:231], a[52:55], v[116:119]
    s_lshl_b32 s19, s19, 2
    ds_read_b128 a[184:187], v214 offset:12288
    v_cvt_pk_bf16_f32 v25, v98, v99
    v_mfma_f32_16x16x32_bf16 v[120:123], a[200:203], a[36:39], v[120:123]
    s_add_u32 s19, s19, s28
    ds_read_b128 a[188:191], v215 offset:12288
    v_cvt_pk_bf16_f32 v26, v100, v101
    v_mfma_f32_16x16x32_bf16 v[120:123], a[232:235], a[52:55], v[120:123]
    s_mul_i32 s19, s19, 20480
    v_cvt_pk_bf16_f32 v27, v102, v103
    v_cvt_pk_bf16_f32 v28, v104, v105
    v_mfma_f32_16x16x32_bf16 v[124:127], a[204:207], a[36:39], v[124:127]
    s_add_u32 s19, s19, s21
    v_cvt_pk_bf16_f32 v29, v106, v107
    v_cvt_pk_bf16_f32 v30, v108, v109
    v_mfma_f32_16x16x32_bf16 v[124:127], a[236:239], a[52:55], v[124:127]
    s_add_u32 s19, s19, 33554432
    v_cvt_pk_bf16_f32 v31, v110, v111
    v_cvt_pk_bf16_f32 v32, v112, v113
    v_mfma_f32_16x16x32_bf16 v[128:131], a[208:211], a[36:39], v[128:131]
    v_cvt_pk_bf16_f32 v33, v114, v115
    v_accvgpr_write_b32 a31, 0
    v_mfma_f32_16x16x32_bf16 v[128:131], a[240:243], a[52:55], v[128:131]
    v_cvt_pk_bf16_f32 v34, v116, v117
    v_cvt_pk_bf16_f32 v35, v118, v119
    v_mfma_f32_16x16x32_bf16 v[132:135], a[212:215], a[36:39], v[132:135]
    v_accvgpr_write_b32 a32, 0
    v_accvgpr_write_b32 a33, 0
    v_mfma_f32_16x16x32_bf16 v[132:135], a[244:247], a[52:55], v[132:135]
    v_cvt_pk_bf16_f32 v36, v120, v121
    v_cvt_pk_bf16_f32 v37, v122, v123
    v_mfma_f32_16x16x32_bf16 v[136:139], a[216:219], a[36:39], v[136:139]
    v_accvgpr_write_b32 a34, 0
    v_accvgpr_write_b32 a35, 0
    v_mfma_f32_16x16x32_bf16 v[136:139], a[248:251], a[52:55], v[136:139]
    v_cvt_pk_bf16_f32 v38, v124, v125
    v_cvt_pk_bf16_f32 v39, v126, v127
    v_mfma_f32_16x16x32_bf16 v[140:143], a[220:223], a[36:39], v[140:143]
    v_accvgpr_write_b32 a48, 0
    v_accvgpr_write_b32 a49, 0
    v_mfma_f32_16x16x32_bf16 v[140:143], a[252:255], a[52:55], v[140:143]
    s_waitcnt lgkmcnt(0)
    v_cvt_pk_bf16_f32 v40, v128, v129
    v_cvt_pk_bf16_f32 v41, v130, v131
    v_mfma_f32_16x16x32_bf16 v[80:83], a[128:131], v[16:19], 0
    v_accvgpr_write_b32 a50, 0
    v_accvgpr_write_b32 a51, 0
    v_mfma_f32_16x16x32_bf16 v[80:83], a[132:135], v[20:23], v[80:83]
    v_cvt_pk_bf16_f32 v42, v132, v133
    v_cvt_pk_bf16_f32 v43, v134, v135
    v_mfma_f32_16x16x32_bf16 v[80:83], a[136:139], v[24:27], v[80:83]
    v_accvgpr_write_b32 a36, 0
    v_accvgpr_write_b32 a37, 0
    v_mfma_f32_16x16x32_bf16 v[80:83], a[140:143], v[28:31], v[80:83]
    v_cvt_pk_bf16_f32 v44, v136, v137
    v_cvt_pk_bf16_f32 v45, v138, v139
    v_mfma_f32_16x16x32_bf16 v[84:87], a[144:147], v[16:19], 0
    v_accvgpr_write_b32 a38, 0
    v_accvgpr_write_b32 a39, 0
    v_mfma_f32_16x16x32_bf16 v[84:87], a[148:151], v[20:23], v[84:87]
    v_cvt_pk_bf16_f32 v46, v140, v141
    v_cvt_pk_bf16_f32 v47, v142, v143
    v_mfma_f32_16x16x32_bf16 v[84:87], a[152:155], v[24:27], v[84:87]
    v_accvgpr_write_b32 a52, 0
    v_accvgpr_write_b32 a53, 0
    v_mfma_f32_16x16x32_bf16 v[84:87], a[156:159], v[28:31], v[84:87]
    s_waitcnt vmcnt(27)
    v_accvgpr_write_b32 a54, 0
    v_accvgpr_write_b32 a55, 0
    v_mfma_f32_16x16x32_bf16 v[144:147], a[192:195], a[40:43], v[144:147]
    v_mfma_f32_16x16x32_bf16 v[144:147], a[224:227], a[56:59], v[144:147]
    v_mfma_f32_16x16x32_bf16 v[148:151], a[196:199], a[40:43], v[148:151]
    v_mfma_f32_16x16x32_bf16 v[148:151], a[228:231], a[56:59], v[148:151]
    v_max3_f32 v14, v80, v81, v82
    v_max3_f32 v14, v14, v83, v84
    v_mfma_f32_16x16x32_bf16 v[152:155], a[200:203], a[40:43], v[152:155]
    v_max3_f32 v14, v14, v85, v86
    v_max_f32 v14, v14, v87
    v_mfma_f32_16x16x32_bf16 v[152:155], a[232:235], a[56:59], v[152:155]
    v_mov_b32 v15, v14
    v_mfma_f32_16x16x32_bf16 v[156:159], a[204:207], a[40:43], v[156:159]
    v_mfma_f32_16x16x32_bf16 v[156:159], a[236:239], a[56:59], v[156:159]
    v_permlane32_swap_b32 v14, v15
    v_max_f32 v14, v14, v15
    v_mfma_f32_16x16x32_bf16 v[160:163], a[208:211], a[40:43], v[160:163]
    v_mov_b32 v15, v14
    v_cvt_pk_bf16_f32 v48, v144, v145
    v_mfma_f32_16x16x32_bf16 v[160:163], a[240:243], a[56:59], v[160:163]
    v_cvt_pk_bf16_f32 v49, v146, v147
    v_cvt_pk_bf16_f32 v50, v148, v149
    v_mfma_f32_16x16x32_bf16 v[164:167], a[212:215], a[40:43], v[164:167]
    v_permlane16_swap_b32 v14, v15
    v_max_f32 v14, v14, v15
    v_mfma_f32_16x16x32_bf16 v[164:167], a[244:247], a[56:59], v[164:167]
    v_add_f32 v14, 0x42300000, v14
    v_cvt_pk_bf16_f32 v51, v150, v151
    v_mfma_f32_16x16x32_bf16 v[168:171], a[216:219], a[40:43], v[168:171]
    v_cvt_pk_bf16_f32 v52, v152, v153
    v_cvt_pk_bf16_f32 v53, v154, v155
    v_mfma_f32_16x16x32_bf16 v[168:171], a[248:251], a[56:59], v[168:171]
    v_cvt_pk_bf16_f32 v54, v156, v157
    v_cvt_pk_bf16_f32 v55, v158, v159
    v_mfma_f32_16x16x32_bf16 v[172:175], a[220:223], a[40:43], v[172:175]
    v_sub_f32 v80, v80, v14
    v_sub_f32 v81, v81, v14
    v_mfma_f32_16x16x32_bf16 v[172:175], a[252:255], a[56:59], v[172:175]
    v_cvt_pk_bf16_f32 v56, v160, v161
    v_cvt_pk_bf16_f32 v57, v162, v163
    v_mfma_f32_16x16x32_bf16 v[88:91], a[128:131], v[32:35], 0
    v_exp_f32 v80, v80
    v_mfma_f32_16x16x32_bf16 v[88:91], a[132:135], v[36:39], v[88:91]
    v_cvt_pk_bf16_f32 v58, v164, v165
    v_cvt_pk_bf16_f32 v59, v166, v167
    v_mfma_f32_16x16x32_bf16 v[88:91], a[136:139], v[40:43], v[88:91]
    v_exp_f32 v81, v81
    v_mfma_f32_16x16x32_bf16 v[88:91], a[140:143], v[44:47], v[88:91]
    v_cvt_pk_bf16_f32 v60, v168, v169
    v_cvt_pk_bf16_f32 v61, v170, v171
    v_mfma_f32_16x16x32_bf16 v[92:95], a[144:147], v[32:35], 0
    v_sub_f32 v82, v82, v14
    v_sub_f32 v83, v83, v14
    v_mfma_f32_16x16x32_bf16 v[92:95], a[148:151], v[36:39], v[92:95]
    v_cvt_pk_bf16_f32 v62, v172, v173
    v_cvt_pk_bf16_f32 v63, v174, v175
    v_mfma_f32_16x16x32_bf16 v[92:95], a[152:155], v[40:43], v[92:95]
    v_exp_f32 v82, v82
    v_mfma_f32_16x16x32_bf16 v[92:95], a[156:159], v[44:47], v[92:95]
    s_waitcnt vmcnt(23)
    v_exp_f32 v83, v83
    v_mfma_f32_16x16x32_bf16 v[176:179], a[192:195], a[44:47], v[176:179]
    v_sub_f32 v84, v84, v14
    v_sub_f32 v85, v85, v14
    v_mfma_f32_16x16x32_bf16 v[176:179], a[224:227], a[60:63], v[176:179]
    ds_read_b64_tr_b16 a[192:193], v216 offset:0
    v_sub_f32 v86, v86, v14
    v_mfma_f32_16x16x32_bf16 v[180:183], a[196:199], a[44:47], v[180:183]
    ds_read_b64_tr_b16 a[194:195], v216 offset:4096
    v_sub_f32 v87, v87, v14
    v_mfma_f32_16x16x32_bf16 v[180:183], a[228:231], a[60:63], v[180:183]
    v_max3_f32 v9, v88, v89, v90
    v_max3_f32 v9, v9, v91, v92
    v_mfma_f32_16x16x32_bf16 v[184:187], a[200:203], a[44:47], v[184:187]
    v_max3_f32 v9, v9, v93, v94
    v_max_f32 v9, v9, v95
    v_mfma_f32_16x16x32_bf16 v[184:187], a[232:235], a[60:63], v[184:187]
    ds_read_b64_tr_b16 a[196:197], v217 offset:0
    v_mov_b32 v10, v9
    v_mfma_f32_16x16x32_bf16 v[188:191], a[204:207], a[44:47], v[188:191]
    ds_read_b64_tr_b16 a[198:199], v217 offset:4096
    v_sub_f32 v128, 0, v14
    v_mfma_f32_16x16x32_bf16 v[188:191], a[236:239], a[60:63], v[188:191]
    v_permlane32_swap_b32 v9, v10
    v_max_f32 v9, v9, v10
    v_mfma_f32_16x16x32_bf16 v[192:195], a[208:211], a[44:47], v[192:195]
    v_mov_b32 v10, v9
    v_cvt_pk_bf16_f32 v64, v176, v177
    v_mfma_f32_16x16x32_bf16 v[192:195], a[240:243], a[60:63], v[192:195]
    v_cvt_pk_bf16_f32 v65, v178, v179
    v_cvt_pk_bf16_f32 v66, v180, v181
    v_mfma_f32_16x16x32_bf16 v[196:199], a[212:215], a[44:47], v[196:199]
    v_permlane16_swap_b32 v9, v10
    v_max_f32 v9, v9, v10
    v_mfma_f32_16x16x32_bf16 v[196:199], a[244:247], a[60:63], v[196:199]
    v_add_f32 v9, 0x42300000, v9
    v_cvt_pk_bf16_f32 v67, v182, v183
    v_mfma_f32_16x16x32_bf16 v[200:203], a[216:219], a[44:47], v[200:203]
    v_cvt_pk_bf16_f32 v68, v184, v185
    v_cvt_pk_bf16_f32 v69, v186, v187
    v_mfma_f32_16x16x32_bf16 v[200:203], a[248:251], a[60:63], v[200:203]
    v_cvt_pk_bf16_f32 v70, v188, v189
    v_cvt_pk_bf16_f32 v71, v190, v191
    v_mfma_f32_16x16x32_bf16 v[204:207], a[220:223], a[44:47], v[204:207]
    ds_read_b64_tr_b16 a[200:201], v218 offset:0
    v_sub_f32 v129, 0, v14
    v_mfma_f32_16x16x32_bf16 v[204:207], a[252:255], a[60:63], v[204:207]
    v_cvt_pk_bf16_f32 v72, v192, v193
    v_cvt_pk_bf16_f32 v73, v194, v195
    v_mfma_f32_16x16x32_bf16 v[96:99], a[128:131], v[48:51], 0
    ds_read_b64_tr_b16 a[202:203], v218 offset:4096
    v_sub_f32 v130, 0, v14
    v_mfma_f32_16x16x32_bf16 v[96:99], a[132:135], v[52:55], v[96:99]
    v_cvt_pk_bf16_f32 v74, v196, v197
    v_cvt_pk_bf16_f32 v75, v198, v199
    v_mfma_f32_16x16x32_bf16 v[96:99], a[136:139], v[56:59], v[96:99]
    ds_read_b64_tr_b16 a[204:205], v219 offset:0
    v_sub_f32 v131, 0, v14
    v_mfma_f32_16x16x32_bf16 v[96:99], a[140:143], v[60:63], v[96:99]
    v_cvt_pk_bf16_f32 v76, v200, v201
    v_cvt_pk_bf16_f32 v77, v202, v203
    v_mfma_f32_16x16x32_bf16 v[100:103], a[144:147], v[48:51], 0
    ds_read_b64_tr_b16 a[206:207], v219 offset:4096
    v_cvt_pk_bf16_f32 v112, v80, v81
    v_mfma_f32_16x16x32_bf16 v[100:103], a[148:151], v[52:55], v[100:103]
    v_cvt_pk_bf16_f32 v78, v204, v205
    v_cvt_pk_bf16_f32 v79, v206, v207
    v_mfma_f32_16x16x32_bf16 v[100:103], a[152:155], v[56:59], v[100:103]
    ds_read_b64_tr_b16 a[208:209], v220 offset:0
    v_cvt_pk_bf16_f32 v113, v82, v83
    v_mfma_f32_16x16x32_bf16 v[100:103], a[156:159], v[60:63], v[100:103]
    ds_read_b64_tr_b16 a[210:211], v220 offset:4096
    v_sub_f32 v88, v88, v9
    v_mfma_f32_16x16x32_bf16 v[104:107], a[128:131], v[64:67], 0
    ds_read_b64_tr_b16 a[212:213], v221 offset:0
    v_sub_f32 v89, v89, v9
    v_mfma_f32_16x16x32_bf16 v[104:107], a[132:135], v[68:71], v[104:107]
    ds_read_b64_tr_b16 a[214:215], v221 offset:4096
    v_sub_f32 v90, v90, v9
    v_mfma_f32_16x16x32_bf16 v[104:107], a[136:139], v[72:75], v[104:107]
    ds_read_b64_tr_b16 a[216:217], v222 offset:0
    v_sub_f32 v91, v91, v9
    v_mfma_f32_16x16x32_bf16 v[104:107], a[140:143], v[76:79], v[104:107]
    v_max3_f32 v14, v96, v97, v98
    v_max3_f32 v14, v14, v99, v100
    v_mfma_f32_16x16x32_bf16 v[108:111], a[144:147], v[64:67], 0
    v_max3_f32 v14, v14, v101, v102
    v_max_f32 v14, v14, v103
    v_mfma_f32_16x16x32_bf16 v[108:111], a[148:151], v[68:71], v[108:111]
    ds_read_b64_tr_b16 a[218:219], v222 offset:4096
    v_mov_b32 v15, v14
    v_mfma_f32_16x16x32_bf16 v[108:111], a[152:155], v[72:75], v[108:111]
    ds_read_b64_tr_b16 a[220:221], v223 offset:0
    ds_read_b64_tr_b16 a[222:223], v223 offset:4096
    v_mfma_f32_16x16x32_bf16 v[108:111], a[156:159], v[76:79], v[108:111]
    v_permlane32_swap_b32 v14, v15
    v_max_f32 v14, v14, v15
    v_mov_b32 v15, v14
    v_exp_f32 v84, v84
    v_exp_f32 v85, v85
    v_exp_f32 v86, v86
    v_exp_f32 v87, v87
    v_exp_f32 v88, v88
    v_exp_f32 v89, v89
    v_exp_f32 v90, v90
    v_exp_f32 v91, v91
    v_sub_f32 v92, v92, v9
    v_sub_f32 v93, v93, v9
    v_sub_f32 v94, v94, v9
    v_sub_f32 v95, v95, v9
    v_sub_f32 v132, 0, v9
    v_sub_f32 v133, 0, v9
    v_sub_f32 v134, 0, v9
    v_sub_f32 v135, 0, v9
    v_mov_b32 v152, 0
    v_mov_b32 v153, 0
    v_mov_b32 v154, 0
    v_mov_b32 v155, 0
    v_mov_b32 v156, 0
    v_mov_b32 v157, 0
    v_mov_b32 v158, 0
    v_mov_b32 v159, 0
    v_accvgpr_write_b32 a40, 0
    v_accvgpr_write_b32 a41, 0
    v_accvgpr_write_b32 a42, 0
    v_accvgpr_write_b32 a43, 0
    v_accvgpr_write_b32 a56, 0
    v_accvgpr_write_b32 a57, 0
    v_accvgpr_write_b32 a58, 0
    v_accvgpr_write_b32 a59, 0
    v_accvgpr_write_b32 a44, 0
    v_accvgpr_write_b32 a45, 0
    v_accvgpr_write_b32 a46, 0
    v_accvgpr_write_b32 a47, 0
    v_accvgpr_write_b32 a60, 0
    v_accvgpr_write_b32 a61, 0
    v_accvgpr_write_b32 a62, 0
    v_accvgpr_write_b32 a63, 0
    v_cvt_pk_bf16_f32 v114, v84, v85
    v_cvt_pk_bf16_f32 v115, v86, v87
    v_exp_f32 v92, v92
    v_exp_f32 v93, v93
    v_exp_f32 v94, v94
    v_exp_f32 v95, v95
    v_cvt_pk_bf16_f32 v116, v88, v89
    v_cvt_pk_bf16_f32 v117, v90, v91
    v_permlane16_swap_b32 v14, v15
    v_max_f32 v14, v14, v15
    v_add_f32 v14, 0x42300000, v14
    v_cvt_pk_bf16_f32 v118, v92, v93
    v_cvt_pk_bf16_f32 v119, v94, v95
    v_sub_f32 v96, v96, v14
    v_sub_f32 v97, v97, v14
    v_sub_f32 v98, v98, v14
    v_sub_f32 v99, v99, v14
    v_sub_f32 v100, v100, v14
    v_sub_f32 v101, v101, v14
    v_sub_f32 v102, v102, v14
    v_sub_f32 v103, v103, v14
    v_max3_f32 v9, v104, v105, v106
    v_max3_f32 v9, v9, v107, v108
    v_max3_f32 v9, v9, v109, v110
    v_max_f32 v9, v9, v111
    v_mov_b32 v10, v9
    v_exp_f32_e64 v144, v96 clamp
    v_exp_f32_e64 v145, v97 clamp
    v_exp_f32_e64 v146, v98 clamp
    v_exp_f32_e64 v147, v99 clamp
    v_exp_f32_e64 v148, v100 clamp
    v_exp_f32_e64 v149, v101 clamp
    v_exp_f32_e64 v150, v102 clamp
    v_exp_f32_e64 v151, v103 clamp
    v_sub_f32 v136, 0, v14
    v_sub_f32 v137, 0, v14
    v_sub_f32 v138, 0, v14
    v_sub_f32 v139, 0, v14
    v_permlane32_swap_b32 v9, v10
    v_max_f32 v9, v9, v10
    v_mov_b32 v10, v9
    s_nop 1
    v_permlane16_swap_b32 v9, v10
    v_max_f32 v9, v9, v10
    v_add_f32 v9, 0x42300000, v9
    v_sub_f32 v104, v104, v9
    v_sub_f32 v105, v105, v9
    v_sub_f32 v106, v106, v9
    v_sub_f32 v107, v107, v9
    v_sub_f32 v108, v108, v9
    v_sub_f32 v109, v109, v9
    v_sub_f32 v110, v110, v9
    v_sub_f32 v111, v111, v9
    v_sub_f32 v140, 0, v9
    v_sub_f32 v141, 0, v9
    v_sub_f32 v142, 0, v9
    v_sub_f32 v143, 0, v9
    v_cvt_pk_bf16_f32 v120, v144, v145
    v_smfmac_f32_16x16x64_bf16 v[152:155], v[208:211], v[112:119], v255
    s_waitcnt vmcnt(20)
    v_cmp_ne_u32 vcc, s3, v13
    s_nop 1
    s_cbranch_vccz Lpe_ok
    s_mov_b32 s33, 0
Lpe:
    buffer_load_dword v13, v12, s[52:55], s46 offen sc1
    s_add_u32 s33, s33, 1
    s_waitcnt vmcnt(0)
    v_cmp_ne_u32 vcc, s3, v13
    s_nop 1
    s_cbranch_vccz Lpe_ok
    s_cmp_gt_u32 s33, 0x10000
    s_cbranch_scc1 Lpe_ok
    s_branch Lpe
Lpe_ok:
    s_waitcnt vmcnt(17) lgkmcnt(0)
    s_barrier
.p2align 6
Lloop:
    v_mfma_f32_16x16x32_bf16 v[80:83], a[160:163], v[16:19], v[128:131]
    v_exp_f32_e64 v176, v104 clamp
    v_mfma_f32_16x16x32_bf16 v[80:83], a[164:167], v[20:23], v[80:83]
    v_exp_f32_e64 v177, v105 clamp
    v_mfma_f32_16x16x32_bf16 v[80:83], a[168:171], v[24:27], v[80:83]
    ds_read_b64_tr_b16 a[224:225], v216 offset:8192
    v_cvt_pk_bf16_f32 v121, v146, v147
    v_mfma_f32_16x16x32_bf16 v[80:83], a[172:175], v[28:31], v[80:83]
    ds_read_b64_tr_b16 a[226:227], v216 offset:12288
    v_cvt_pk_bf16_f32 v122, v148, v149
    v_mfma_f32_16x16x32_bf16 v[84:87], a[176:179], v[16:19], v[128:131]
    v_exp_f32_e64 v178, v106 clamp
    v_mfma_f32_16x16x32_bf16 v[84:87], a[180:183], v[20:23], v[84:87]
    v_exp_f32_e64 v179, v107 clamp
    v_mfma_f32_16x16x32_bf16 v[84:87], a[184:187], v[24:27], v[84:87]
    ds_read_b64_tr_b16 a[228:229], v217 offset:8192
    v_cvt_pk_bf16_f32 v123, v150, v151
    v_mfma_f32_16x16x32_bf16 v[84:87], a[188:191], v[28:31], v[84:87]
    ds_read_b64_tr_b16 a[230:231], v217 offset:12288
    v_cvt_pk_bf16_f32 v124, v176, v177
    v_mfma_f32_16x16x32_bf16 a[0:3], a[192:195], v[112:115], a[0:3]
    v_exp_f32_e64 v180, v108 clamp
    v_mfma_f32_16x16x32_bf16 a[4:7], a[196:199], v[112:115], a[4:7]
    v_exp_f32_e64 v181, v109 clamp
    v_mfma_f32_16x16x32_bf16 a[8:11], a[200:203], v[112:115], a[8:11]
    ds_read_b64_tr_b16 a[232:233], v218 offset:8192
    v_cvt_pk_bf16_f32 v125, v178, v179
    v_mfma_f32_16x16x32_bf16 a[12:15], a[204:207], v[112:115], a[12:15]
    ds_read_b64_tr_b16 a[234:235], v218 offset:12288
    v_cvt_pk_bf16_f32 v126, v180, v181
    v_mfma_f32_16x16x32_bf16 a[16:19], a[208:211], v[112:115], a[16:19]
    v_exp_f32_e64 v182, v110 clamp
    v_mfma_f32_16x16x32_bf16 a[20:23], a[212:215], v[112:115], a[20:23]
    v_exp_f32_e64 v183, v111 clamp
    v_mfma_f32_16x16x32_bf16 a[24:27], a[216:219], v[112:115], a[24:27]
    ds_read_b64_tr_b16 a[236:237], v219 offset:8192
    v_cvt_pk_bf16_f32 v127, v182, v183
    v_mfma_f32_16x16x32_bf16 a[28:31], a[220:223], v[112:115], a[28:31]
    ds_read_b64_tr_b16 a[238:239], v219 offset:12288
    v_smfmac_f32_16x16x64_bf16 v[156:159], v[208:211], v[120:127], v255
    ds_read_b64_tr_b16 a[240:241], v220 offset:8192
    v_mfma_f32_16x16x32_bf16 v[88:91], a[160:163], v[32:35], v[132:135]
    v_exp_f32_e64 v176, v80 clamp
    v_mfma_f32_16x16x32_bf16 v[88:91], a[164:167], v[36:39], v[88:91]
    v_exp_f32_e64 v177, v81 clamp
    v_mfma_f32_16x16x32_bf16 v[88:91], a[168:171], v[40:43], v[88:91]
    ds_read_b64_tr_b16 a[242:243], v220 offset:12288
    v_cvt_pk_bf16_f32 v112, v176, v177
    v_mfma_f32_16x16x32_bf16 v[88:91], a[172:175], v[44:47], v[88:91]
    ds_read_b64_tr_b16 a[244:245], v221 offset:8192
    v_mfma_f32_16x16x32_bf16 v[92:95], a[176:179], v[32:35], v[132:135]
    v_exp_f32_e64 v178, v82 clamp
    v_mfma_f32_16x16x32_bf16 v[92:95], a[180:183], v[36:39], v[92:95]
    v_exp_f32_e64 v179, v83 clamp
    v_mfma_f32_16x16x32_bf16 v[92:95], a[184:187], v[40:43], v[92:95]
    ds_read_b64_tr_b16 a[246:247], v221 offset:12288
    v_cvt_pk_bf16_f32 v113, v178, v179
    v_mfma_f32_16x16x32_bf16 v[92:95], a[188:191], v[44:47], v[92:95]
    ds_read_b64_tr_b16 a[248:249], v222 offset:8192
    v_cmp_lt_f32 vcc, s32, v156
    v_mfma_f32_16x16x32_bf16 a[32:35], a[192:195], v[116:119], a[32:35]
    v_exp_f32_e64 v180, v84 clamp
    v_mfma_f32_16x16x32_bf16 a[36:39], a[196:199], v[116:119], a[36:39]
    v_exp_f32_e64 v181, v85 clamp
    v_mfma_f32_16x16x32_bf16 a[40:43], a[200:203], v[116:119], a[40:43]
    ds_read_b64_tr_b16 a[250:251], v222 offset:12288
    v_cvt_pk_bf16_f32 v114, v180, v181
    v_mfma_f32_16x16x32_bf16 a[44:47], a[204:207], v[116:119], a[44:47]
    s_cbranch_vccnz Lrs0
Lrb0:
    v_mfma_f32_16x16x32_bf16 a[48:51], a[208:211], v[116:119], a[48:51]
    v_exp_f32_e64 v182, v86 clamp
    v_mfma_f32_16x16x32_bf16 a[52:55], a[212:215], v[116:119], a[52:55]
    v_exp_f32_e64 v183, v87 clamp
    v_mfma_f32_16x16x32_bf16 a[56:59], a[216:219], v[116:119], a[56:59]
    ds_read_b64_tr_b16 a[252:253], v223 offset:8192
    v_cvt_pk_bf16_f32 v115, v182, v183
    v_mfma_f32_16x16x32_bf16 a[60:63], a[220:223], v[116:119], a[60:63]
    ds_read_b64_tr_b16 a[254:255], v223 offset:12288
    v_mfma_f32_16x16x32_bf16 v[96:99], a[160:163], v[48:51], v[136:139]
    v_exp_f32_e64 v176, v88 clamp
    v_mfma_f32_16x16x32_bf16 v[96:99], a[164:167], v[52:55], v[96:99]
    v_exp_f32_e64 v177, v89 clamp
    v_mfma_f32_16x16x32_bf16 v[96:99], a[168:171], v[56:59], v[96:99]
    ds_read_b128 a[128:131], v212 offset:16384
    v_cvt_pk_bf16_f32 v116, v176, v177
    v_mfma_f32_16x16x32_bf16 v[96:99], a[172:175], v[60:63], v[96:99]
    ds_read_b128 a[132:135], v213 offset:16384
    v_xor_b32 v14, s3, v14
    v_mfma_f32_16x16x32_bf16 v[100:103], a[176:179], v[48:51], v[136:139]
    v_exp_f32_e64 v178, v90 clamp
    v_mfma_f32_16x16x32_bf16 v[100:103], a[180:183], v[52:55], v[100:103]
    v_exp_f32_e64 v179, v91 clamp
    v_mfma_f32_16x16x32_bf16 v[100:103], a[184:187], v[56:59], v[100:103]
    ds_read_b128 a[136:139], v214 offset:16384
    v_cvt_pk_bf16_f32 v117, v178, v179
    v_mfma_f32_16x16x32_bf16 v[100:103], a[188:191], v[60:63], v[100:103]
    ds_read_b128 a[140:143], v215 offset:16384
    v_xor_b32 v15, s3, v15
    v_mfma_f32_16x16x32_bf16 a[64:67], a[192:195], v[120:123], a[64:67]
    v_exp_f32_e64 v180, v92 clamp
    v_mfma_f32_16x16x32_bf16 a[68:71], a[196:199], v[120:123], a[68:71]
    v_exp_f32_e64 v181, v93 clamp
    v_mfma_f32_16x16x32_bf16 a[72:75], a[200:203], v[120:123], a[72:75]
    ds_read_b128 a[144:147], v212 offset:20480
    v_cvt_pk_bf16_f32 v118, v180, v181
    v_mfma_f32_16x16x32_bf16 a[76:79], a[204:207], v[120:123], a[76:79]
    ds_read_b128 a[148:151], v213 offset:20480
    v_or_b32 v14, v14, v15
    v_mfma_f32_16x16x32_bf16 a[80:83], a[208:211], v[120:123], a[80:83]
    v_exp_f32_e64 v182, v94 clamp
    v_mfma_f32_16x16x32_bf16 a[84:87], a[212:215], v[120:123], a[84:87]
    v_exp_f32_e64 v183, v95 clamp
    v_mfma_f32_16x16x32_bf16 a[88:91], a[216:219], v[120:123], a[88:91]
    ds_read_b128 a[152:155], v214 offset:20480
    v_cvt_pk_bf16_f32 v119, v182, v183
    v_mfma_f32_16x16x32_bf16 a[92:95], a[220:223], v[120:123], a[92:95]
    ds_read_b128 a[156:159], v215 offset:20480
    v_cmp_ne_u32 s[20:21], 0, v14
    v_smfmac_f32_16x16x64_bf16 v[152:155], v[208:211], v[112:119], v255
    s_add_u32 m0, s29, 114688
    v_mfma_f32_16x16x32_bf16 v[104:107], a[160:163], v[64:67], v[140:143]
    v_exp_f32_e64 v144, v96 clamp
    v_mfma_f32_16x16x32_bf16 v[104:107], a[164:167], v[68:71], v[104:107]
    buffer_load_dwordx4 v224, s[12:15], s30 offen offset:0 sc1 nt lds
    v_mfma_f32_16x16x32_bf16 v[104:107], a[168:171], v[72:75], v[104:107]
    v_exp_f32_e64 v145, v97 clamp
    v_mfma_f32_16x16x32_bf16 v[104:107], a[172:175], v[76:79], v[104:107]
    s_cmp_eq_u64 s[20:21], 0
    buffer_load_dwordx4 v225, s[12:15], s30 offen offset:1024 sc1 nt lds
    v_mfma_f32_16x16x32_bf16 v[108:111], a[176:179], v[64:67], v[140:143]
    s_cselect_b32 s45, 7, 99
    v_exp_f32_e64 v146, v98 clamp
    v_mfma_f32_16x16x32_bf16 v[108:111], a[180:183], v[68:71], v[108:111]
    buffer_load_dwordx4 v224, s[12:15], s30 offen offset:2048 sc1 nt lds
    v_mfma_f32_16x16x32_bf16 v[108:111], a[184:187], v[72:75], v[108:111]
    v_exp_f32_e64 v147, v99 clamp
    v_mfma_f32_16x16x32_bf16 v[108:111], a[188:191], v[76:79], v[108:111]
    buffer_load_dwordx4 v225, s[12:15], s30 offen offset:3072 sc1 nt lds
    v_mfma_f32_16x16x32_bf16 a[96:99], a[192:195], v[124:127], a[96:99]
    s_add_u32 s30, s30, s22
    v_cmp_lt_f32 vcc, s32, v152
    v_cvt_pk_bf16_f32 v120, v144, v145
    v_mfma_f32_16x16x32_bf16 a[100:103], a[196:199], v[124:127], a[100:103]
    v_mad_u32_u24 v247, v249, s59, v250
    v_mfma_f32_16x16x32_bf16 a[104:107], a[200:203], v[124:127], a[104:107]
    v_exp_f32_e64 v148, v100 clamp
    v_mfma_f32_16x16x32_bf16 a[108:111], a[204:207], v[124:127], a[108:111]
    s_mov_b32 m0, s62
    v_exp_f32_e64 v149, v101 clamp
    v_mfma_f32_16x16x32_bf16 a[112:115], a[208:211], v[124:127], a[112:115]
    v_exp_f32_e64 v150, v102 clamp
    v_mfma_f32_16x16x32_bf16 a[116:119], a[212:215], v[124:127], a[116:119]
    s_cbranch_vccnz Lrs1
Lrb1:
    v_mfma_f32_16x16x32_bf16 a[120:123], a[216:219], v[124:127], a[120:123]
    s_waitcnt lgkmcnt(0)
    v_exp_f32_e64 v151, v103 clamp
    v_mfma_f32_16x16x32_bf16 a[124:127], a[220:223], v[124:127], a[124:127]
    buffer_load_dwordx4 v247, s[48:51], s56 offen nt lds
    v_mfma_f32_16x16x32_bf16 v[80:83], a[128:131], v[16:19], v[128:131]
    s_cmp_eq_u32 s31, s45
    v_exp_f32_e64 v176, v104 clamp
    v_mfma_f32_16x16x32_bf16 v[80:83], a[132:135], v[20:23], v[80:83]
    s_cselect_b32 s8, s38, s8
    v_exp_f32_e64 v177, v105 clamp
    v_mfma_f32_16x16x32_bf16 v[80:83], a[136:139], v[24:27], v[80:83]
    s_cselect_b32 s9, s39, s9
    ds_read_b64_tr_b16 a[192:193], v216 offset:16384
    v_cvt_pk_bf16_f32 v121, v146, v147
    v_mfma_f32_16x16x32_bf16 v[80:83], a[140:143], v[28:31], v[80:83]
    s_cselect_b32 s12, s40, s12
    ds_read_b64_tr_b16 a[194:195], v216 offset:20480
    v_cvt_pk_bf16_f32 v122, v148, v149
    v_mfma_f32_16x16x32_bf16 v[84:87], a[144:147], v[16:19], v[128:131]
    s_cselect_b32 s13, s41, s13
    v_exp_f32_e64 v178, v106 clamp
    v_mfma_f32_16x16x32_bf16 v[84:87], a[148:151], v[20:23], v[84:87]
    s_cselect_b32 s30, 0, s30
    v_exp_f32_e64 v179, v107 clamp
    v_mfma_f32_16x16x32_bf16 v[84:87], a[152:155], v[24:27], v[84:87]
    s_cselect_b32 s22, 8192, s22
    ds_read_b64_tr_b16 a[196:197], v217 offset:16384
    v_cvt_pk_bf16_f32 v123, v150, v151
    v_mfma_f32_16x16x32_bf16 v[84:87], a[156:159], v[28:31], v[84:87]
    s_cselect_b32 s23, 1, s23
    ds_read_b64_tr_b16 a[198:199], v217 offset:20480
    v_cvt_pk_bf16_f32 v124, v176, v177
    v_mfma_f32_16x16x32_bf16 a[0:3], a[224:227], v[112:115], a[0:3]
    v_exp_f32_e64 v180, v108 clamp
    v_mfma_f32_16x16x32_bf16 a[4:7], a[228:231], v[112:115], a[4:7]
    v_exp_f32_e64 v181, v109 clamp
    v_mfma_f32_16x16x32_bf16 a[8:11], a[232:235], v[112:115], a[8:11]
    ds_read_b64_tr_b16 a[200:201], v218 offset:16384
    v_cvt_pk_bf16_f32 v125, v178, v179
    v_mfma_f32_16x16x32_bf16 a[12:15], a[236:239], v[112:115], a[12:15]
    ds_read_b64_tr_b16 a[202:203], v218 offset:20480
    v_cvt_pk_bf16_f32 v126, v180, v181
    v_mfma_f32_16x16x32_bf16 a[16:19], a[240:243], v[112:115], a[16:19]
    v_exp_f32_e64 v182, v110 clamp
    v_mfma_f32_16x16x32_bf16 a[20:23], a[244:247], v[112:115], a[20:23]
    v_exp_f32_e64 v183, v111 clamp
    v_mfma_f32_16x16x32_bf16 a[24:27], a[248:251], v[112:115], a[24:27]
    ds_read_b64_tr_b16 a[204:205], v219 offset:16384
    v_cvt_pk_bf16_f32 v127, v182, v183
    v_mfma_f32_16x16x32_bf16 a[28:31], a[252:255], v[112:115], a[28:31]
    ds_read_b64_tr_b16 a[206:207], v219 offset:20480
    v_smfmac_f32_16x16x64_bf16 v[156:159], v[208:211], v[120:127], v255
    ds_read_b64_tr_b16 a[208:209], v220 offset:16384
    v_mfma_f32_16x16x32_bf16 v[88:91], a[128:131], v[32:35], v[132:135]
    v_exp_f32_e64 v176, v80 clamp
    v_mfma_f32_16x16x32_bf16 v[88:91], a[132:135], v[36:39], v[88:91]
    v_exp_f32_e64 v177, v81 clamp
    v_mfma_f32_16x16x32_bf16 v[88:91], a[136:139], v[40:43], v[88:91]
    ds_read_b64_tr_b16 a[210:211], v220 offset:20480
    v_cvt_pk_bf16_f32 v112, v176, v177
    v_mfma_f32_16x16x32_bf16 v[88:91], a[140:143], v[44:47], v[88:91]
    ds_read_b64_tr_b16 a[212:213], v221 offset:16384
    v_mfma_f32_16x16x32_bf16 v[92:95], a[144:147], v[32:35], v[132:135]
    v_exp_f32_e64 v178, v82 clamp
    v_mfma_f32_16x16x32_bf16 v[92:95], a[148:151], v[36:39], v[92:95]
    v_exp_f32_e64 v179, v83 clamp
    v_mfma_f32_16x16x32_bf16 v[92:95], a[152:155], v[40:43], v[92:95]
    ds_read_b64_tr_b16 a[214:215], v221 offset:20480
    v_cvt_pk_bf16_f32 v113, v178, v179
    v_mfma_f32_16x16x32_bf16 v[92:95], a[156:159], v[44:47], v[92:95]
    ds_read_b64_tr_b16 a[216:217], v222 offset:16384
    v_cmp_lt_f32 vcc, s32, v156
    v_mfma_f32_16x16x32_bf16 a[32:35], a[224:227], v[116:119], a[32:35]
    v_exp_f32_e64 v180, v84 clamp
    v_mfma_f32_16x16x32_bf16 a[36:39], a[228:231], v[116:119], a[36:39]
    v_exp_f32_e64 v181, v85 clamp
    v_mfma_f32_16x16x32_bf16 a[40:43], a[232:235], v[116:119], a[40:43]
    ds_read_b64_tr_b16 a[218:219], v222 offset:20480
    v_cvt_pk_bf16_f32 v114, v180, v181
    v_mfma_f32_16x16x32_bf16 a[44:47], a[236:239], v[116:119], a[44:47]
    s_cbranch_vccnz Lrs2
Lrb2:
    v_mfma_f32_16x16x32_bf16 a[48:51], a[240:243], v[116:119], a[48:51]
    v_exp_f32_e64 v182, v86 clamp
    v_mfma_f32_16x16x32_bf16 a[52:55], a[244:247], v[116:119], a[52:55]
    v_exp_f32_e64 v183, v87 clamp
    v_mfma_f32_16x16x32_bf16 a[56:59], a[248:251], v[116:119], a[56:59]
    ds_read_b64_tr_b16 a[220:221], v223 offset:16384
    v_cvt_pk_bf16_f32 v115, v182, v183
    v_mfma_f32_16x16x32_bf16 a[60:63], a[252:255], v[116:119], a[60:63]
    ds_read_b64_tr_b16 a[222:223], v223 offset:20480
    v_mfma_f32_16x16x32_bf16 v[96:99], a[128:131], v[48:51], v[136:139]
    v_exp_f32_e64 v176, v88 clamp
    v_mfma_f32_16x16x32_bf16 v[96:99], a[132:135], v[52:55], v[96:99]
    v_exp_f32_e64 v177, v89 clamp
    v_mfma_f32_16x16x32_bf16 v[96:99], a[136:139], v[56:59], v[96:99]
    ds_read_b128 a[160:163], v212 offset:24576
    v_cvt_pk_bf16_f32 v116, v176, v177
    v_mfma_f32_16x16x32_bf16 v[96:99], a[140:143], v[60:63], v[96:99]
    ds_read_b128 a[164:167], v213 offset:24576
    v_mul_u32_u24 v248, s16, v249
    v_mfma_f32_16x16x32_bf16 v[100:103], a[144:147], v[48:51], v[136:139]
    v_exp_f32_e64 v178, v90 clamp
    v_mfma_f32_16x16x32_bf16 v[100:103], a[148:151], v[52:55], v[100:103]
    v_exp_f32_e64 v179, v91 clamp
    v_mfma_f32_16x16x32_bf16 v[100:103], a[152:155], v[56:59], v[100:103]
    ds_read_b128 a[168:171], v214 offset:24576
    v_cvt_pk_bf16_f32 v117, v178, v179
    v_mfma_f32_16x16x32_bf16 v[100:103], a[156:159], v[60:63], v[100:103]
    ds_read_b128 a[172:175], v215 offset:24576
    v_mad_u32_u24 v248, v250, s17, v248
    v_mfma_f32_16x16x32_bf16 a[64:67], a[224:227], v[120:123], a[64:67]
    v_exp_f32_e64 v180, v92 clamp
    v_mfma_f32_16x16x32_bf16 a[68:71], a[228:231], v[120:123], a[68:71]
    v_exp_f32_e64 v181, v93 clamp
    v_mfma_f32_16x16x32_bf16 a[72:75], a[232:235], v[120:123], a[72:75]
    ds_read_b128 a[176:179], v212 offset:28672
    v_cvt_pk_bf16_f32 v118, v180, v181
    v_mfma_f32_16x16x32_bf16 a[76:79], a[236:239], v[120:123], a[76:79]
    ds_read_b128 a[180:183], v213 offset:28672
    v_mfma_f32_16x16x32_bf16 a[80:83], a[240:243], v[120:123], a[80:83]
    v_exp_f32_e64 v182, v94 clamp
    v_mfma_f32_16x16x32_bf16 a[84:87], a[244:247], v[120:123], a[84:87]
    v_exp_f32_e64 v183, v95 clamp
    v_mfma_f32_16x16x32_bf16 a[88:91], a[248:251], v[120:123], a[88:91]
    ds_read_b128 a[184:187], v214 offset:28672
    v_cvt_pk_bf16_f32 v119, v182, v183
    v_mfma_f32_16x16x32_bf16 a[92:95], a[252:255], v[120:123], a[92:95]
    ds_read_b128 a[188:191], v215 offset:28672
    v_smfmac_f32_16x16x64_bf16 v[152:155], v[208:211], v[112:119], v255
    s_add_u32 m0, s29, 0
    v_mfma_f32_16x16x32_bf16 v[104:107], a[128:131], v[64:67], v[140:143]
    v_exp_f32_e64 v144, v96 clamp
    v_mfma_f32_16x16x32_bf16 v[104:107], a[132:135], v[68:71], v[104:107]
    buffer_load_dwordx4 v224, s[8:11], s30 offen offset:0 sc1 nt lds
    v_mfma_f32_16x16x32_bf16 v[104:107], a[136:139], v[72:75], v[104:107]
    v_exp_f32_e64 v145, v97 clamp
    v_mfma_f32_16x16x32_bf16 v[104:107], a[140:143], v[76:79], v[104:107]
    buffer_load_dwordx4 v225, s[8:11], s30 offen offset:1024 sc1 nt lds
    v_mfma_f32_16x16x32_bf16 v[108:111], a[144:147], v[64:67], v[140:143]
    v_exp_f32_e64 v146, v98 clamp
    v_mfma_f32_16x16x32_bf16 v[108:111], a[148:151], v[68:71], v[108:111]
    buffer_load_dwordx4 v224, s[8:11], s30 offen offset:2048 sc1 nt lds
    v_mfma_f32_16x16x32_bf16 v[108:111], a[152:155], v[72:75], v[108:111]
    v_exp_f32_e64 v147, v99 clamp
    v_mfma_f32_16x16x32_bf16 v[108:111], a[156:159], v[76:79], v[108:111]
    buffer_load_dwordx4 v225, s[8:11], s30 offen offset:3072 sc1 nt lds
    v_mfma_f32_16x16x32_bf16 a[96:99], a[224:227], v[124:127], a[96:99]
    v_cmp_lt_f32 vcc, s32, v152
    v_cvt_pk_bf16_f32 v120, v144, v145
    v_mfma_f32_16x16x32_bf16 a[100:103], a[228:231], v[124:127], a[100:103]
    v_mfma_f32_16x16x32_bf16 a[104:107], a[232:235], v[124:127], a[104:107]
    v_exp_f32_e64 v148, v100 clamp
    v_mfma_f32_16x16x32_bf16 a[108:111], a[236:239], v[124:127], a[108:111]
    s_add_u32 m0, s62, 1024
    v_exp_f32_e64 v149, v101 clamp
    v_mfma_f32_16x16x32_bf16 a[112:115], a[240:243], v[124:127], a[112:115]
    v_exp_f32_e64 v150, v102 clamp
    v_mfma_f32_16x16x32_bf16 a[116:119], a[244:247], v[124:127], a[116:119]
    s_cbranch_vccnz Lrs3
Lrb3:
    v_mfma_f32_16x16x32_bf16 a[120:123], a[248:251], v[124:127], a[120:123]
    s_waitcnt vmcnt(15) lgkmcnt(0)
    v_exp_f32_e64 v151, v103 clamp
    v_mfma_f32_16x16x32_bf16 a[124:127], a[252:255], v[124:127], a[124:127]
    s_barrier
    buffer_load_dwordx4 v248, s[96:99], s61 offen sc1 lds
    v_mfma_f32_16x16x32_bf16 v[80:83], a[160:163], v[16:19], v[128:131]
    v_exp_f32_e64 v176, v104 clamp
    v_mfma_f32_16x16x32_bf16 v[80:83], a[164:167], v[20:23], v[80:83]
    v_exp_f32_e64 v177, v105 clamp
    v_mfma_f32_16x16x32_bf16 v[80:83], a[168:171], v[24:27], v[80:83]
    ds_read_b64_tr_b16 a[224:225], v216 offset:24576
    v_cvt_pk_bf16_f32 v121, v146, v147
    v_mfma_f32_16x16x32_bf16 v[80:83], a[172:175], v[28:31], v[80:83]
    ds_read_b64_tr_b16 a[226:227], v216 offset:28672
    v_cvt_pk_bf16_f32 v122, v148, v149
    v_mfma_f32_16x16x32_bf16 v[84:87], a[176:179], v[16:19], v[128:131]
    v_exp_f32_e64 v178, v106 clamp
    v_mfma_f32_16x16x32_bf16 v[84:87], a[180:183], v[20:23], v[84:87]
    v_exp_f32_e64 v179, v107 clamp
    v_mfma_f32_16x16x32_bf16 v[84:87], a[184:187], v[24:27], v[84:87]
    ds_read_b64_tr_b16 a[228:229], v217 offset:24576
    v_cvt_pk_bf16_f32 v123, v150, v151
    v_mfma_f32_16x16x32_bf16 v[84:87], a[188:191], v[28:31], v[84:87]
    ds_read_b64_tr_b16 a[230:231], v217 offset:28672
    v_cvt_pk_bf16_f32 v124, v176, v177
    v_mfma_f32_16x16x32_bf16 a[0:3], a[192:195], v[112:115], a[0:3]
    v_exp_f32_e64 v180, v108 clamp
    v_mfma_f32_16x16x32_bf16 a[4:7], a[196:199], v[112:115], a[4:7]
    v_exp_f32_e64 v181, v109 clamp
    v_mfma_f32_16x16x32_bf16 a[8:11], a[200:203], v[112:115], a[8:11]
    ds_read_b64_tr_b16 a[232:233], v218 offset:24576
    v_cvt_pk_bf16_f32 v125, v178, v179
    v_mfma_f32_16x16x32_bf16 a[12:15], a[204:207], v[112:115], a[12:15]
    ds_read_b64_tr_b16 a[234:235], v218 offset:28672
    v_cvt_pk_bf16_f32 v126, v180, v181
    v_mfma_f32_16x16x32_bf16 a[16:19], a[208:211], v[112:115], a[16:19]
    v_exp_f32_e64 v182, v110 clamp
    v_mfma_f32_16x16x32_bf16 a[20:23], a[212:215], v[112:115], a[20:23]
    v_exp_f32_e64 v183, v111 clamp
    v_mfma_f32_16x16x32_bf16 a[24:27], a[216:219], v[112:115], a[24:27]
    ds_read_b64_tr_b16 a[236:237], v219 offset:24576
    v_cvt_pk_bf16_f32 v127, v182, v183
    v_mfma_f32_16x16x32_bf16 a[28:31], a[220:223], v[112:115], a[28:31]
    ds_read_b64_tr_b16 a[238:239], v219 offset:28672
    v_smfmac_f32_16x16x64_bf16 v[156:159], v[208:211], v[120:127], v255
    ds_read_b64_tr_b16 a[240:241], v220 offset:24576
    v_mfma_f32_16x16x32_bf16 v[88:91], a[160:163], v[32:35], v[132:135]
    v_exp_f32_e64 v176, v80 clamp
    v_mfma_f32_16x16x32_bf16 v[88:91], a[164:167], v[36:39], v[88:91]
    v_exp_f32_e64 v177, v81 clamp
    v_mfma_f32_16x16x32_bf16 v[88:91], a[168:171], v[40:43], v[88:91]
    ds_read_b64_tr_b16 a[242:243], v220 offset:28672
    v_cvt_pk_bf16_f32 v112, v176, v177
    v_mfma_f32_16x16x32_bf16 v[88:91], a[172:175], v[44:47], v[88:91]
    ds_read_b64_tr_b16 a[244:245], v221 offset:24576
    v_mfma_f32_16x16x32_bf16 v[92:95], a[176:179], v[32:35], v[132:135]
    v_exp_f32_e64 v178, v82 clamp
    v_mfma_f32_16x16x32_bf16 v[92:95], a[180:183], v[36:39], v[92:95]
    v_exp_f32_e64 v179, v83 clamp
    v_mfma_f32_16x16x32_bf16 v[92:95], a[184:187], v[40:43], v[92:95]
    ds_read_b64_tr_b16 a[246:247], v221 offset:28672
    v_cvt_pk_bf16_f32 v113, v178, v179
    v_mfma_f32_16x16x32_bf16 v[92:95], a[188:191], v[44:47], v[92:95]
    ds_read_b64_tr_b16 a[248:249], v222 offset:24576
    v_cmp_lt_f32 vcc, s32, v156
    v_mfma_f32_16x16x32_bf16 a[32:35], a[192:195], v[116:119], a[32:35]
    v_exp_f32_e64 v180, v84 clamp
    v_mfma_f32_16x16x32_bf16 a[36:39], a[196:199], v[116:119], a[36:39]
    v_exp_f32_e64 v181, v85 clamp
    v_mfma_f32_16x16x32_bf16 a[40:43], a[200:203], v[116:119], a[40:43]
    ds_read_b64_tr_b16 a[250:251], v222 offset:28672
    v_cvt_pk_bf16_f32 v114, v180, v181
    v_mfma_f32_16x16x32_bf16 a[44:47], a[204:207], v[116:119], a[44:47]
    s_cbranch_vccnz Lrs4
Lrb4:
    v_mfma_f32_16x16x32_bf16 a[48:51], a[208:211], v[116:119], a[48:51]
    v_exp_f32_e64 v182, v86 clamp
    v_mfma_f32_16x16x32_bf16 a[52:55], a[212:215], v[116:119], a[52:55]
    v_exp_f32_e64 v183, v87 clamp
    v_mfma_f32_16x16x32_bf16 a[56:59], a[216:219], v[116:119], a[56:59]
    ds_read_b64_tr_b16 a[252:253], v223 offset:24576
    v_cvt_pk_bf16_f32 v115, v182, v183
    v_mfma_f32_16x16x32_bf16 a[60:63], a[220:223], v[116:119], a[60:63]
    ds_read_b64_tr_b16 a[254:255], v223 offset:28672
    v_mfma_f32_16x16x32_bf16 v[96:99], a[160:163], v[48:51], v[136:139]
    v_exp_f32_e64 v176, v88 clamp
    v_mfma_f32_16x16x32_bf16 v[96:99], a[164:167], v[52:55], v[96:99]
    v_exp_f32_e64 v177, v89 clamp
    v_mfma_f32_16x16x32_bf16 v[96:99], a[168:171], v[56:59], v[96:99]
    ds_read_b128 a[128:131], v212 offset:32768
    v_cvt_pk_bf16_f32 v116, v176, v177
    v_mfma_f32_16x16x32_bf16 v[96:99], a[172:175], v[60:63], v[96:99]
    ds_read_b128 a[132:135], v213 offset:32768
    v_mfma_f32_16x16x32_bf16 v[100:103], a[176:179], v[48:51], v[136:139]
    v_exp_f32_e64 v178, v90 clamp
    v_mfma_f32_16x16x32_bf16 v[100:103], a[180:183], v[52:55], v[100:103]
    v_exp_f32_e64 v179, v91 clamp
    v_mfma_f32_16x16x32_bf16 v[100:103], a[184:187], v[56:59], v[100:103]
    ds_read_b128 a[136:139], v214 offset:32768
    v_cvt_pk_bf16_f32 v117, v178, v179
    v_mfma_f32_16x16x32_bf16 v[100:103], a[188:191], v[60:63], v[100:103]
    ds_read_b128 a[140:143], v215 offset:32768
    v_mfma_f32_16x16x32_bf16 a[64:67], a[192:195], v[120:123], a[64:67]
    v_exp_f32_e64 v180, v92 clamp
    v_mfma_f32_16x16x32_bf16 a[68:71], a[196:199], v[120:123], a[68:71]
    v_exp_f32_e64 v181, v93 clamp
    v_mfma_f32_16x16x32_bf16 a[72:75], a[200:203], v[120:123], a[72:75]
    ds_read_b128 a[144:147], v212 offset:36864
    v_cvt_pk_bf16_f32 v118, v180, v181
    v_mfma_f32_16x16x32_bf16 a[76:79], a[204:207], v[120:123], a[76:79]
    ds_read_b128 a[148:151], v213 offset:36864
    v_mfma_f32_16x16x32_bf16 a[80:83], a[208:211], v[120:123], a[80:83]
    v_exp_f32_e64 v182, v94 clamp
    v_mfma_f32_16x16x32_bf16 a[84:87], a[212:215], v[120:123], a[84:87]
    v_exp_f32_e64 v183, v95 clamp
    v_mfma_f32_16x16x32_bf16 a[88:91], a[216:219], v[120:123], a[88:91]
    ds_read_b128 a[152:155], v214 offset:36864
    v_cvt_pk_bf16_f32 v119, v182, v183
    v_mfma_f32_16x16x32_bf16 a[92:95], a[220:223], v[120:123], a[92:95]
    ds_read_b128 a[156:159], v215 offset:36864
    v_smfmac_f32_16x16x64_bf16 v[152:155], v[208:211], v[112:119], v255
    s_add_u32 m0, s29, 65536
    v_mfma_f32_16x16x32_bf16 v[104:107], a[160:163], v[64:67], v[140:143]
    v_exp_f32_e64 v144, v96 clamp
    v_mfma_f32_16x16x32_bf16 v[104:107], a[164:167], v[68:71], v[104:107]
    buffer_load_dwordx4 v224, s[12:15], s30 offen offset:0 sc1 nt lds
    v_mfma_f32_16x16x32_bf16 v[104:107], a[168:171], v[72:75], v[104:107]
    v_exp_f32_e64 v145, v97 clamp
    v_mfma_f32_16x16x32_bf16 v[104:107], a[172:175], v[76:79], v[104:107]
    buffer_load_dwordx4 v225, s[12:15], s30 offen offset:1024 sc1 nt lds
    v_mfma_f32_16x16x32_bf16 v[108:111], a[176:179], v[64:67], v[140:143]
    v_exp_f32_e64 v146, v98 clamp
    v_mfma_f32_16x16x32_bf16 v[108:111], a[180:183], v[68:71], v[108:111]
    buffer_load_dwordx4 v224, s[12:15], s30 offen offset:2048 sc1 nt lds
    v_mfma_f32_16x16x32_bf16 v[108:111], a[184:187], v[72:75], v[108:111]
    v_exp_f32_e64 v147, v99 clamp
    v_mfma_f32_16x16x32_bf16 v[108:111], a[188:191], v[76:79], v[108:111]
    buffer_load_dwordx4 v225, s[12:15], s30 offen offset:3072 sc1 nt lds
    v_mfma_f32_16x16x32_bf16 a[96:99], a[192:195], v[124:127], a[96:99]
    s_add_u32 s30, s30, s22
    v_cmp_lt_f32 vcc, s32, v152
    v_cvt_pk_bf16_f32 v120, v144, v145
    v_mfma_f32_16x16x32_bf16 a[100:103], a[196:199], v[124:127], a[100:103]
    v_mfma_f32_16x16x32_bf16 a[104:107], a[200:203], v[124:127], a[104:107]
    v_exp_f32_e64 v148, v100 clamp
    v_mfma_f32_16x16x32_bf16 a[108:111], a[204:207], v[124:127], a[108:111]
    v_exp_f32_e64 v149, v101 clamp
    v_mfma_f32_16x16x32_bf16 a[112:115], a[208:211], v[124:127], a[112:115]
    v_exp_f32_e64 v150, v102 clamp
    v_mfma_f32_16x16x32_bf16 a[116:119], a[212:215], v[124:127], a[116:119]
    s_cbranch_vccnz Lrs5
Lrb5:
    v_mfma_f32_16x16x32_bf16 a[120:123], a[216:219], v[124:127], a[120:123]
    s_waitcnt lgkmcnt(0)
    v_exp_f32_e64 v151, v103 clamp
    v_mfma_f32_16x16x32_bf16 a[124:127], a[220:223], v[124:127], a[124:127]
    buffer_load_dwordx4 v[226:229], v252, s[52:55], s58 offen sc1
    v_mfma_f32_16x16x32_bf16 v[80:83], a[128:131], v[16:19], v[128:131]
    v_exp_f32_e64 v176, v104 clamp
    v_mfma_f32_16x16x32_bf16 v[80:83], a[132:135], v[20:23], v[80:83]
    v_exp_f32_e64 v177, v105 clamp
    v_mfma_f32_16x16x32_bf16 v[80:83], a[136:139], v[24:27], v[80:83]
    ds_read_b64_tr_b16 a[192:193], v216 offset:32768
    v_cvt_pk_bf16_f32 v121, v146, v147
    v_mfma_f32_16x16x32_bf16 v[80:83], a[140:143], v[28:31], v[80:83]
    ds_read_b64_tr_b16 a[194:195], v216 offset:36864
    v_cvt_pk_bf16_f32 v122, v148, v149
    v_mfma_f32_16x16x32_bf16 v[84:87], a[144:147], v[16:19], v[128:131]
    v_exp_f32_e64 v178, v106 clamp
    v_mfma_f32_16x16x32_bf16 v[84:87], a[148:151], v[20:23], v[84:87]
    v_exp_f32_e64 v179, v107 clamp
    v_mfma_f32_16x16x32_bf16 v[84:87], a[152:155], v[24:27], v[84:87]
    ds_read_b64_tr_b16 a[196:197], v217 offset:32768
    v_cvt_pk_bf16_f32 v123, v150, v151
    v_mfma_f32_16x16x32_bf16 v[84:87], a[156:159], v[28:31], v[84:87]
    ds_read_b64_tr_b16 a[198:199], v217 offset:36864
    v_cvt_pk_bf16_f32 v124, v176, v177
    v_mfma_f32_16x16x32_bf16 a[0:3], a[224:227], v[112:115], a[0:3]
    v_exp_f32_e64 v180, v108 clamp
    v_mfma_f32_16x16x32_bf16 a[4:7], a[228:231], v[112:115], a[4:7]
    v_exp_f32_e64 v181, v109 clamp
    v_mfma_f32_16x16x32_bf16 a[8:11], a[232:235], v[112:115], a[8:11]
    ds_read_b64_tr_b16 a[200:201], v218 offset:32768
    v_cvt_pk_bf16_f32 v125, v178, v179
    v_mfma_f32_16x16x32_bf16 a[12:15], a[236:239], v[112:115], a[12:15]
    ds_read_b64_tr_b16 a[202:203], v218 offset:36864
    v_cvt_pk_bf16_f32 v126, v180, v181
    v_mfma_f32_16x16x32_bf16 a[16:19], a[240:243], v[112:115], a[16:19]
    v_exp_f32_e64 v182, v110 clamp
    v_mfma_f32_16x16x32_bf16 a[20:23], a[244:247], v[112:115], a[20:23]
    v_exp_f32_e64 v183, v111 clamp
    v_mfma_f32_16x16x32_bf16 a[24:27], a[248:251], v[112:115], a[24:27]
    ds_read_b64_tr_b16 a[204:205], v219 offset:32768
    v_cvt_pk_bf16_f32 v127, v182, v183
    v_mfma_f32_16x16x32_bf16 a[28:31], a[252:255], v[112:115], a[28:31]
    ds_read_b64_tr_b16 a[206:207], v219 offset:36864
    v_smfmac_f32_16x16x64_bf16 v[156:159], v[208:211], v[120:127], v255
    ds_read_b64_tr_b16 a[208:209], v220 offset:32768
    v_mfma_f32_16x16x32_bf16 v[88:91], a[128:131], v[32:35], v[132:135]
    v_exp_f32_e64 v176, v80 clamp
    v_mfma_f32_16x16x32_bf16 v[88:91], a[132:135], v[36:39], v[88:91]
    v_exp_f32_e64 v177, v81 clamp
    v_mfma_f32_16x16x32_bf16 v[88:91], a[136:139], v[40:43], v[88:91]
    ds_read_b64_tr_b16 a[210:211], v220 offset:36864
    v_cvt_pk_bf16_f32 v112, v176, v177
    v_mfma_f32_16x16x32_bf16 v[88:91], a[140:143], v[44:47], v[88:91]
    ds_read_b64_tr_b16 a[212:213], v221 offset:32768
    v_mfma_f32_16x16x32_bf16 v[92:95], a[144:147], v[32:35], v[132:135]
    v_exp_f32_e64 v178, v82 clamp
    v_mfma_f32_16x16x32_bf16 v[92:95], a[148:151], v[36:39], v[92:95]
    v_exp_f32_e64 v179, v83 clamp
    v_mfma_f32_16x16x32_bf16 v[92:95], a[152:155], v[40:43], v[92:95]
    ds_read_b64_tr_b16 a[214:215], v221 offset:36864
    v_cvt_pk_bf16_f32 v113, v178, v179
    v_mfma_f32_16x16x32_bf16 v[92:95], a[156:159], v[44:47], v[92:95]
    ds_read_b64_tr_b16 a[216:217], v222 offset:32768
    v_cmp_lt_f32 vcc, s32, v156
    v_mfma_f32_16x16x32_bf16 a[32:35], a[224:227], v[116:119], a[32:35]
    v_exp_f32_e64 v180, v84 clamp
    v_mfma_f32_16x16x32_bf16 a[36:39], a[228:231], v[116:119], a[36:39]
    v_exp_f32_e64 v181, v85 clamp
    v_mfma_f32_16x16x32_bf16 a[40:43], a[232:235], v[116:119], a[40:43]
    ds_read_b64_tr_b16 a[218:219], v222 offset:36864
    v_cvt_pk_bf16_f32 v114, v180, v181
    v_mfma_f32_16x16x32_bf16 a[44:47], a[236:239], v[116:119], a[44:47]
    s_cbranch_vccnz Lrs6
Lrb6:
    v_mfma_f32_16x16x32_bf16 a[48:51], a[240:243], v[116:119], a[48:51]
    v_exp_f32_e64 v182, v86 clamp
    v_mfma_f32_16x16x32_bf16 a[52:55], a[244:247], v[116:119], a[52:55]
    v_exp_f32_e64 v183, v87 clamp
    v_mfma_f32_16x16x32_bf16 a[56:59], a[248:251], v[116:119], a[56:59]
    ds_read_b64_tr_b16 a[220:221], v223 offset:32768
    v_cvt_pk_bf16_f32 v115, v182, v183
    v_mfma_f32_16x16x32_bf16 a[60:63], a[252:255], v[116:119], a[60:63]
    ds_read_b64_tr_b16 a[222:223], v223 offset:36864
    v_mfma_f32_16x16x32_bf16 v[96:99], a[128:131], v[48:51], v[136:139]
    v_exp_f32_e64 v176, v88 clamp
    v_mfma_f32_16x16x32_bf16 v[96:99], a[132:135], v[52:55], v[96:99]
    v_exp_f32_e64 v177, v89 clamp
    v_mfma_f32_16x16x32_bf16 v[96:99], a[136:139], v[56:59], v[96:99]
    ds_read_b128 a[160:163], v212 offset:40960
    v_cvt_pk_bf16_f32 v116, v176, v177
    v_mfma_f32_16x16x32_bf16 v[96:99], a[140:143], v[60:63], v[96:99]
    ds_read_b128 a[164:167], v213 offset:40960
    v_mfma_f32_16x16x32_bf16 v[100:103], a[144:147], v[48:51], v[136:139]
    v_exp_f32_e64 v178, v90 clamp
    v_mfma_f32_16x16x32_bf16 v[100:103], a[148:151], v[52:55], v[100:103]
    v_exp_f32_e64 v179, v91 clamp
    v_mfma_f32_16x16x32_bf16 v[100:103], a[152:155], v[56:59], v[100:103]
    ds_read_b128 a[168:171], v214 offset:40960
    v_cvt_pk_bf16_f32 v117, v178, v179
    v_mfma_f32_16x16x32_bf16 v[100:103], a[156:159], v[60:63], v[100:103]
    ds_read_b128 a[172:175], v215 offset:40960
    v_mfma_f32_16x16x32_bf16 a[64:67], a[224:227], v[120:123], a[64:67]
    v_exp_f32_e64 v180, v92 clamp
    v_mfma_f32_16x16x32_bf16 a[68:71], a[228:231], v[120:123], a[68:71]
    v_exp_f32_e64 v181, v93 clamp
    v_mfma_f32_16x16x32_bf16 a[72:75], a[232:235], v[120:123], a[72:75]
    ds_read_b128 a[176:179], v212 offset:45056
    v_cvt_pk_bf16_f32 v118, v180, v181
    v_mfma_f32_16x16x32_bf16 a[76:79], a[236:239], v[120:123], a[76:79]
    ds_read_b128 a[180:183], v213 offset:45056
    v_mfma_f32_16x16x32_bf16 a[80:83], a[240:243], v[120:123], a[80:83]
    v_exp_f32_e64 v182, v94 clamp
    v_mfma_f32_16x16x32_bf16 a[84:87], a[244:247], v[120:123], a[84:87]
    v_exp_f32_e64 v183, v95 clamp
    v_mfma_f32_16x16x32_bf16 a[88:91], a[248:251], v[120:123], a[88:91]
    ds_read_b128 a[184:187], v214 offset:45056
    v_cvt_pk_bf16_f32 v119, v182, v183
    v_mfma_f32_16x16x32_bf16 a[92:95], a[252:255], v[120:123], a[92:95]
    ds_read_b128 a[188:191], v215 offset:45056
    v_smfmac_f32_16x16x64_bf16 v[152:155], v[208:211], v[112:119], v255
    s_add_u32 m0, s29, 16384
    v_mfma_f32_16x16x32_bf16 v[104:107], a[128:131], v[64:67], v[140:143]
    v_exp_f32_e64 v144, v96 clamp
    v_mfma_f32_16x16x32_bf16 v[104:107], a[132:135], v[68:71], v[104:107]
    buffer_load_dwordx4 v224, s[8:11], s30 offen offset:0 sc1 nt lds
    v_mfma_f32_16x16x32_bf16 v[104:107], a[136:139], v[72:75], v[104:107]
    v_exp_f32_e64 v145, v97 clamp
    v_mfma_f32_16x16x32_bf16 v[104:107], a[140:143], v[76:79], v[104:107]
    buffer_load_dwordx4 v225, s[8:11], s30 offen offset:1024 sc1 nt lds
    v_mfma_f32_16x16x32_bf16 v[108:111], a[144:147], v[64:67], v[140:143]
    v_exp_f32_e64 v146, v98 clamp
    v_mfma_f32_16x16x32_bf16 v[108:111], a[148:151], v[68:71], v[108:111]
    buffer_load_dwordx4 v224, s[8:11], s30 offen offset:2048 sc1 nt lds
    v_mfma_f32_16x16x32_bf16 v[108:111], a[152:155], v[72:75], v[108:111]
    v_exp_f32_e64 v147, v99 clamp
    v_mfma_f32_16x16x32_bf16 v[108:111], a[156:159], v[76:79], v[108:111]
    buffer_load_dwordx4 v225, s[8:11], s30 offen offset:3072 sc1 nt lds
    v_mfma_f32_16x16x32_bf16 a[96:99], a[224:227], v[124:127], a[96:99]
    v_cmp_lt_f32 vcc, s32, v152
    v_cvt_pk_bf16_f32 v120, v144, v145
    v_mfma_f32_16x16x32_bf16 a[100:103], a[228:231], v[124:127], a[100:103]
    v_mfma_f32_16x16x32_bf16 a[104:107], a[232:235], v[124:127], a[104:107]
    v_exp_f32_e64 v148, v100 clamp
    v_mfma_f32_16x16x32_bf16 a[108:111], a[236:239], v[124:127], a[108:111]
    v_exp_f32_e64 v149, v101 clamp
    v_mfma_f32_16x16x32_bf16 a[112:115], a[240:243], v[124:127], a[112:115]
    v_exp_f32_e64 v150, v102 clamp
    v_mfma_f32_16x16x32_bf16 a[116:119], a[244:247], v[124:127], a[116:119]
    s_cbranch_vccnz Lrs7
Lrb7:
    v_mfma_f32_16x16x32_bf16 a[120:123], a[248:251], v[124:127], a[120:123]
    s_waitcnt vmcnt(14) lgkmcnt(0)
    v_exp_f32_e64 v151, v103 clamp
    v_mfma_f32_16x16x32_bf16 a[124:127], a[252:255], v[124:127], a[124:127]
    s_barrier
    buffer_store_dword v254, v253, s[52:55], s100 offen sc1
    v_mfma_f32_16x16x32_bf16 v[80:83], a[160:163], v[16:19], v[128:131]
    v_exp_f32_e64 v176, v104 clamp
    v_mfma_f32_16x16x32_bf16 v[80:83], a[164:167], v[20:23], v[80:83]
    v_exp_f32_e64 v177, v105 clamp
    v_mfma_f32_16x16x32_bf16 v[80:83], a[168:171], v[24:27], v[80:83]
    ds_read_b64_tr_b16 a[224:225], v216 offset:40960
    v_cvt_pk_bf16_f32 v121, v146, v147
    v_mfma_f32_16x16x32_bf16 v[80:83], a[172:175], v[28:31], v[80:83]
    ds_read_b64_tr_b16 a[226:227], v216 offset:45056
    v_cvt_pk_bf16_f32 v122, v148, v149
    v_mfma_f32_16x16x32_bf16 v[84:87], a[176:179], v[16:19], v[128:131]
    v_exp_f32_e64 v178, v106 clamp
    v_mfma_f32_16x16x32_bf16 v[84:87], a[180:183], v[20:23], v[84:87]
    v_exp_f32_e64 v179, v107 clamp
    v_mfma_f32_16x16x32_bf16 v[84:87], a[184:187], v[24:27], v[84:87]
    ds_read_b64_tr_b16 a[228:229], v217 offset:40960
    v_cvt_pk_bf16_f32 v123, v150, v151
    v_mfma_f32_16x16x32_bf16 v[84:87], a[188:191], v[28:31], v[84:87]
    ds_read_b64_tr_b16 a[230:231], v217 offset:45056
    v_cvt_pk_bf16_f32 v124, v176, v177
    v_mfma_f32_16x16x32_bf16 a[0:3], a[192:195], v[112:115], a[0:3]
    v_exp_f32_e64 v180, v108 clamp
    v_mfma_f32_16x16x32_bf16 a[4:7], a[196:199], v[112:115], a[4:7]
    v_exp_f32_e64 v181, v109 clamp
    v_mfma_f32_16x16x32_bf16 a[8:11], a[200:203], v[112:115], a[8:11]
    ds_read_b64_tr_b16 a[232:233], v218 offset:40960
    v_cvt_pk_bf16_f32 v125, v178, v179
    v_mfma_f32_16x16x32_bf16 a[12:15], a[204:207], v[112:115], a[12:15]
    ds_read_b64_tr_b16 a[234:235], v218 offset:45056
    v_cvt_pk_bf16_f32 v126, v180, v181
    v_mfma_f32_16x16x32_bf16 a[16:19], a[208:211], v[112:115], a[16:19]
    v_exp_f32_e64 v182, v110 clamp
    v_mfma_f32_16x16x32_bf16 a[20:23], a[212:215], v[112:115], a[20:23]
    v_exp_f32_e64 v183, v111 clamp
    v_mfma_f32_16x16x32_bf16 a[24:27], a[216:219], v[112:115], a[24:27]
    ds_read_b64_tr_b16 a[236:237], v219 offset:40960
    v_cvt_pk_bf16_f32 v127, v182, v183
    v_mfma_f32_16x16x32_bf16 a[28:31], a[220:223], v[112:115], a[28:31]
    ds_read_b64_tr_b16 a[238:239], v219 offset:45056
    v_smfmac_f32_16x16x64_bf16 v[156:159], v[208:211], v[120:127], v255
    ds_read_b64_tr_b16 a[240:241], v220 offset:40960
    v_mfma_f32_16x16x32_bf16 v[88:91], a[160:163], v[32:35], v[132:135]
    v_exp_f32_e64 v176, v80 clamp
    v_mfma_f32_16x16x32_bf16 v[88:91], a[164:167], v[36:39], v[88:91]
    v_exp_f32_e64 v177, v81 clamp
    v_mfma_f32_16x16x32_bf16 v[88:91], a[168:171], v[40:43], v[88:91]
    ds_read_b64_tr_b16 a[242:243], v220 offset:45056
    v_cvt_pk_bf16_f32 v112, v176, v177
    v_mfma_f32_16x16x32_bf16 v[88:91], a[172:175], v[44:47], v[88:91]
    ds_read_b64_tr_b16 a[244:245], v221 offset:40960
    v_mfma_f32_16x16x32_bf16 v[92:95], a[176:179], v[32:35], v[132:135]
    v_exp_f32_e64 v178, v82 clamp
    v_mfma_f32_16x16x32_bf16 v[92:95], a[180:183], v[36:39], v[92:95]
    v_exp_f32_e64 v179, v83 clamp
    v_mfma_f32_16x16x32_bf16 v[92:95], a[184:187], v[40:43], v[92:95]
    ds_read_b64_tr_b16 a[246:247], v221 offset:45056
    v_cvt_pk_bf16_f32 v113, v178, v179
    v_mfma_f32_16x16x32_bf16 v[92:95], a[188:191], v[44:47], v[92:95]
    ds_read_b64_tr_b16 a[248:249], v222 offset:40960
    v_cmp_lt_f32 vcc, s32, v156
    v_mfma_f32_16x16x32_bf16 a[32:35], a[192:195], v[116:119], a[32:35]
    v_exp_f32_e64 v180, v84 clamp
    v_mfma_f32_16x16x32_bf16 a[36:39], a[196:199], v[116:119], a[36:39]
    v_exp_f32_e64 v181, v85 clamp
    v_mfma_f32_16x16x32_bf16 a[40:43], a[200:203], v[116:119], a[40:43]
    ds_read_b64_tr_b16 a[250:251], v222 offset:45056
    v_cvt_pk_bf16_f32 v114, v180, v181
    v_mfma_f32_16x16x32_bf16 a[44:47], a[204:207], v[116:119], a[44:47]
    s_cbranch_vccnz Lrs8
Lrb8:
    v_mfma_f32_16x16x32_bf16 a[48:51], a[208:211], v[116:119], a[48:51]
    v_exp_f32_e64 v182, v86 clamp
    v_mfma_f32_16x16x32_bf16 a[52:55], a[212:215], v[116:119], a[52:55]
    v_exp_f32_e64 v183, v87 clamp
    v_mfma_f32_16x16x32_bf16 a[56:59], a[216:219], v[116:119], a[56:59]
    ds_read_b64_tr_b16 a[252:253], v223 offset:40960
    v_cvt_pk_bf16_f32 v115, v182, v183
    v_mfma_f32_16x16x32_bf16 a[60:63], a[220:223], v[116:119], a[60:63]
    ds_read_b64_tr_b16 a[254:255], v223 offset:45056
    v_mfma_f32_16x16x32_bf16 v[96:99], a[160:163], v[48:51], v[136:139]
    v_exp_f32_e64 v176, v88 clamp
    v_mfma_f32_16x16x32_bf16 v[96:99], a[164:167], v[52:55], v[96:99]
    v_exp_f32_e64 v177, v89 clamp
    v_mfma_f32_16x16x32_bf16 v[96:99], a[168:171], v[56:59], v[96:99]
    ds_read_b128 a[128:131], v212 offset:49152
    v_cvt_pk_bf16_f32 v116, v176, v177
    v_mfma_f32_16x16x32_bf16 v[96:99], a[172:175], v[60:63], v[96:99]
    ds_read_b128 a[132:135], v213 offset:49152
    v_mfma_f32_16x16x32_bf16 v[100:103], a[176:179], v[48:51], v[136:139]
    v_exp_f32_e64 v178, v90 clamp
    v_mfma_f32_16x16x32_bf16 v[100:103], a[180:183], v[52:55], v[100:103]
    v_exp_f32_e64 v179, v91 clamp
    v_mfma_f32_16x16x32_bf16 v[100:103], a[184:187], v[56:59], v[100:103]
    ds_read_b128 a[136:139], v214 offset:49152
    v_cvt_pk_bf16_f32 v117, v178, v179
    v_mfma_f32_16x16x32_bf16 v[100:103], a[188:191], v[60:63], v[100:103]
    ds_read_b128 a[140:143], v215 offset:49152
    v_mfma_f32_16x16x32_bf16 a[64:67], a[192:195], v[120:123], a[64:67]
    v_exp_f32_e64 v180, v92 clamp
    v_mfma_f32_16x16x32_bf16 a[68:71], a[196:199], v[120:123], a[68:71]
    v_exp_f32_e64 v181, v93 clamp
    v_mfma_f32_16x16x32_bf16 a[72:75], a[200:203], v[120:123], a[72:75]
    ds_read_b128 a[144:147], v212 offset:53248
    v_cvt_pk_bf16_f32 v118, v180, v181
    v_mfma_f32_16x16x32_bf16 a[76:79], a[204:207], v[120:123], a[76:79]
    ds_read_b128 a[148:151], v213 offset:53248
    v_mfma_f32_16x16x32_bf16 a[80:83], a[208:211], v[120:123], a[80:83]
    v_exp_f32_e64 v182, v94 clamp
    v_mfma_f32_16x16x32_bf16 a[84:87], a[212:215], v[120:123], a[84:87]
    v_exp_f32_e64 v183, v95 clamp
    v_mfma_f32_16x16x32_bf16 a[88:91], a[216:219], v[120:123], a[88:91]
    ds_read_b128 a[152:155], v214 offset:53248
    v_cvt_pk_bf16_f32 v119, v182, v183
    v_mfma_f32_16x16x32_bf16 a[92:95], a[220:223], v[120:123], a[92:95]
    ds_read_b128 a[156:159], v215 offset:53248
    v_smfmac_f32_16x16x64_bf16 v[152:155], v[208:211], v[112:119], v255
    s_add_u32 m0, s29, 81920
    ds_read_b64_tr_b16 v[200:201], v251 offset:0
    v_mfma_f32_16x16x32_bf16 v[104:107], a[160:163], v[64:67], v[140:143]
    v_exp_f32_e64 v144, v96 clamp
    v_mfma_f32_16x16x32_bf16 v[104:107], a[164:167], v[68:71], v[104:107]
    buffer_load_dwordx4 v224, s[12:15], s30 offen offset:0 sc1 nt lds
    v_mfma_f32_16x16x32_bf16 v[104:107], a[168:171], v[72:75], v[104:107]
    v_exp_f32_e64 v145, v97 clamp
    v_mfma_f32_16x16x32_bf16 v[104:107], a[172:175], v[76:79], v[104:107]
    buffer_load_dwordx4 v225, s[12:15], s30 offen offset:1024 sc1 nt lds
    v_mfma_f32_16x16x32_bf16 v[108:111], a[176:179], v[64:67], v[140:143]
    v_exp_f32_e64 v146, v98 clamp
    v_mfma_f32_16x16x32_bf16 v[108:111], a[180:183], v[68:71], v[108:111]
    buffer_load_dwordx4 v224, s[12:15], s30 offen offset:2048 sc1 nt lds
    v_mfma_f32_16x16x32_bf16 v[108:111], a[184:187], v[72:75], v[108:111]
    v_exp_f32_e64 v147, v99 clamp
    v_mfma_f32_16x16x32_bf16 v[108:111], a[188:191], v[76:79], v[108:111]
    buffer_load_dwordx4 v225, s[12:15], s30 offen offset:3072 sc1 nt lds
    v_mfma_f32_16x16x32_bf16 a[96:99], a[192:195], v[124:127], a[96:99]
    s_add_u32 s30, s30, s22
    v_cmp_lt_f32 vcc, s32, v152
    v_cvt_pk_bf16_f32 v120, v144, v145
    v_mfma_f32_16x16x32_bf16 a[100:103], a[196:199], v[124:127], a[100:103]
    v_mfma_f32_16x16x32_bf16 a[104:107], a[200:203], v[124:127], a[104:107]
    v_exp_f32_e64 v148, v100 clamp
    v_mfma_f32_16x16x32_bf16 a[108:111], a[204:207], v[124:127], a[108:111]
    v_exp_f32_e64 v149, v101 clamp
    v_mfma_f32_16x16x32_bf16 a[112:115], a[208:211], v[124:127], a[112:115]
    v_exp_f32_e64 v150, v102 clamp
    v_mfma_f32_16x16x32_bf16 a[116:119], a[212:215], v[124:127], a[116:119]
    s_cbranch_vccnz Lrs9
Lrb9:
    v_mfma_f32_16x16x32_bf16 a[120:123], a[216:219], v[124:127], a[120:123]
    s_waitcnt lgkmcnt(0)
    v_exp_f32_e64 v151, v103 clamp
    v_mfma_f32_16x16x32_bf16 a[124:127], a[220:223], v[124:127], a[124:127]
    buffer_load_dwordx2 v[14:15], v7, s[52:55], s36 offen sc1
    v_mfma_f32_16x16x32_bf16 v[80:83], a[128:131], v[16:19], v[128:131]
    v_exp_f32_e64 v176, v104 clamp
    v_mfma_f32_16x16x32_bf16 v[80:83], a[132:135], v[20:23], v[80:83]
    v_exp_f32_e64 v177, v105 clamp
    v_mfma_f32_16x16x32_bf16 v[80:83], a[136:139], v[24:27], v[80:83]
    ds_read_b64_tr_b16 a[192:193], v216 offset:49152
    v_cvt_pk_bf16_f32 v121, v146, v147
    v_mfma_f32_16x16x32_bf16 v[80:83], a[140:143], v[28:31], v[80:83]
    ds_read_b64_tr_b16 a[194:195], v216 offset:53248
    v_cvt_pk_bf16_f32 v122, v148, v149
    v_mfma_f32_16x16x32_bf16 v[84:87], a[144:147], v[16:19], v[128:131]
    v_exp_f32_e64 v178, v106 clamp
    v_mfma_f32_16x16x32_bf16 v[84:87], a[148:151], v[20:23], v[84:87]
    v_exp_f32_e64 v179, v107 clamp
    v_mfma_f32_16x16x32_bf16 v[84:87], a[152:155], v[24:27], v[84:87]
    ds_read_b64_tr_b16 a[196:197], v217 offset:49152
    v_cvt_pk_bf16_f32 v123, v150, v151
    v_mfma_f32_16x16x32_bf16 v[84:87], a[156:159], v[28:31], v[84:87]
    ds_read_b64_tr_b16 a[198:199], v217 offset:53248
    v_cvt_pk_bf16_f32 v124, v176, v177
    v_mfma_f32_16x16x32_bf16 a[0:3], a[224:227], v[112:115], a[0:3]
    v_exp_f32_e64 v180, v108 clamp
    v_mfma_f32_16x16x32_bf16 a[4:7], a[228:231], v[112:115], a[4:7]
    v_exp_f32_e64 v181, v109 clamp
    v_mfma_f32_16x16x32_bf16 a[8:11], a[232:235], v[112:115], a[8:11]
    ds_read_b64_tr_b16 a[200:201], v218 offset:49152
    v_cvt_pk_bf16_f32 v125, v178, v179
    v_mfma_f32_16x16x32_bf16 a[12:15], a[236:239], v[112:115], a[12:15]
    ds_read_b64_tr_b16 a[202:203], v218 offset:53248
    v_cvt_pk_bf16_f32 v126, v180, v181
    v_mfma_f32_16x16x32_bf16 a[16:19], a[240:243], v[112:115], a[16:19]
    v_exp_f32_e64 v182, v110 clamp
    v_mfma_f32_16x16x32_bf16 a[20:23], a[244:247], v[112:115], a[20:23]
    v_exp_f32_e64 v183, v111 clamp
    v_mfma_f32_16x16x32_bf16 a[24:27], a[248:251], v[112:115], a[24:27]
    ds_read_b64_tr_b16 a[204:205], v219 offset:49152
    v_cvt_pk_bf16_f32 v127, v182, v183
    v_mfma_f32_16x16x32_bf16 a[28:31], a[252:255], v[112:115], a[28:31]
    ds_read_b64_tr_b16 a[206:207], v219 offset:53248
    v_smfmac_f32_16x16x64_bf16 v[156:159], v[208:211], v[120:127], v255
    ds_read_b64_tr_b16 a[208:209], v220 offset:49152
    v_mfma_f32_16x16x32_bf16 v[88:91], a[128:131], v[32:35], v[132:135]
    v_exp_f32_e64 v176, v80 clamp
    v_mfma_f32_16x16x32_bf16 v[88:91], a[132:135], v[36:39], v[88:91]
    v_exp_f32_e64 v177, v81 clamp
    v_mfma_f32_16x16x32_bf16 v[88:91], a[136:139], v[40:43], v[88:91]
    ds_read_b64_tr_b16 a[210:211], v220 offset:53248
    v_cvt_pk_bf16_f32 v112, v176, v177
    v_mfma_f32_16x16x32_bf16 v[88:91], a[140:143], v[44:47], v[88:91]
    ds_read_b64_tr_b16 a[212:213], v221 offset:49152
    v_mfma_f32_16x16x32_bf16 v[92:95], a[144:147], v[32:35], v[132:135]
    v_exp_f32_e64 v178, v82 clamp
    v_mfma_f32_16x16x32_bf16 v[92:95], a[148:151], v[36:39], v[92:95]
    v_exp_f32_e64 v179, v83 clamp
    v_mfma_f32_16x16x32_bf16 v[92:95], a[152:155], v[40:43], v[92:95]
    ds_read_b64_tr_b16 a[214:215], v221 offset:53248
    v_cvt_pk_bf16_f32 v113, v178, v179
    v_mfma_f32_16x16x32_bf16 v[92:95], a[156:159], v[44:47], v[92:95]
    ds_read_b64_tr_b16 a[216:217], v222 offset:49152
    v_cmp_lt_f32 vcc, s32, v156
    v_mfma_f32_16x16x32_bf16 a[32:35], a[224:227], v[116:119], a[32:35]
    v_exp_f32_e64 v180, v84 clamp
    v_mfma_f32_16x16x32_bf16 a[36:39], a[228:231], v[116:119], a[36:39]
    v_exp_f32_e64 v181, v85 clamp
    v_mfma_f32_16x16x32_bf16 a[40:43], a[232:235], v[116:119], a[40:43]
    ds_read_b64_tr_b16 a[218:219], v222 offset:53248
    v_cvt_pk_bf16_f32 v114, v180, v181
    v_mfma_f32_16x16x32_bf16 a[44:47], a[236:239], v[116:119], a[44:47]
    s_cbranch_vccnz Lrs10
Lrb10:
    v_mfma_f32_16x16x32_bf16 a[48:51], a[240:243], v[116:119], a[48:51]
    v_exp_f32_e64 v182, v86 clamp
    v_mfma_f32_16x16x32_bf16 a[52:55], a[244:247], v[116:119], a[52:55]
    v_exp_f32_e64 v183, v87 clamp
    v_mfma_f32_16x16x32_bf16 a[56:59], a[248:251], v[116:119], a[56:59]
    ds_read_b64_tr_b16 a[220:221], v223 offset:49152
    v_cvt_pk_bf16_f32 v115, v182, v183
    v_mfma_f32_16x16x32_bf16 a[60:63], a[252:255], v[116:119], a[60:63]
    ds_read_b64_tr_b16 a[222:223], v223 offset:53248
    v_mfma_f32_16x16x32_bf16 v[96:99], a[128:131], v[48:51], v[136:139]
    v_exp_f32_e64 v176, v88 clamp
    v_mfma_f32_16x16x32_bf16 v[96:99], a[132:135], v[52:55], v[96:99]
    v_exp_f32_e64 v177, v89 clamp
    v_mfma_f32_16x16x32_bf16 v[96:99], a[136:139], v[56:59], v[96:99]
    ds_read_b128 a[160:163], v212 offset:57344
    v_cvt_pk_bf16_f32 v116, v176, v177
    v_mfma_f32_16x16x32_bf16 v[96:99], a[140:143], v[60:63], v[96:99]
    ds_read_b128 a[164:167], v213 offset:57344
    v_mfma_f32_16x16x32_bf16 v[100:103], a[144:147], v[48:51], v[136:139]
    v_exp_f32_e64 v178, v90 clamp
    v_mfma_f32_16x16x32_bf16 v[100:103], a[148:151], v[52:55], v[100:103]
    v_exp_f32_e64 v179, v91 clamp
    v_mfma_f32_16x16x32_bf16 v[100:103], a[152:155], v[56:59], v[100:103]
    ds_read_b128 a[168:171], v214 offset:57344
    v_cvt_pk_bf16_f32 v117, v178, v179
    v_mfma_f32_16x16x32_bf16 v[100:103], a[156:159], v[60:63], v[100:103]
    ds_read_b128 a[172:175], v215 offset:57344
    v_mfma_f32_16x16x32_bf16 a[64:67], a[224:227], v[120:123], a[64:67]
    v_exp_f32_e64 v180, v92 clamp
    v_mfma_f32_16x16x32_bf16 a[68:71], a[228:231], v[120:123], a[68:71]
    v_exp_f32_e64 v181, v93 clamp
    v_mfma_f32_16x16x32_bf16 a[72:75], a[232:235], v[120:123], a[72:75]
    ds_read_b128 a[176:179], v212 offset:61440
    v_cvt_pk_bf16_f32 v118, v180, v181
    v_mfma_f32_16x16x32_bf16 a[76:79], a[236:239], v[120:123], a[76:79]
    ds_read_b128 a[180:183], v213 offset:61440
    v_mfma_f32_16x16x32_bf16 a[80:83], a[240:243], v[120:123], a[80:83]
    v_exp_f32_e64 v182, v94 clamp
    v_mfma_f32_16x16x32_bf16 a[84:87], a[244:247], v[120:123], a[84:87]
    v_exp_f32_e64 v183, v95 clamp
    v_mfma_f32_16x16x32_bf16 a[88:91], a[248:251], v[120:123], a[88:91]
    ds_read_b128 a[184:187], v214 offset:61440
    v_cvt_pk_bf16_f32 v119, v182, v183
    v_mfma_f32_16x16x32_bf16 a[92:95], a[252:255], v[120:123], a[92:95]
    ds_read_b128 a[188:191], v215 offset:61440
    v_smfmac_f32_16x16x64_bf16 v[152:155], v[208:211], v[112:119], v255
    s_add_u32 m0, s29, 32768
    ds_read_b64_tr_b16 v[202:203], v251 offset:512
    v_mfma_f32_16x16x32_bf16 v[104:107], a[128:131], v[64:67], v[140:143]
    v_exp_f32_e64 v144, v96 clamp
    v_mfma_f32_16x16x32_bf16 v[104:107], a[132:135], v[68:71], v[104:107]
    buffer_load_dwordx4 v224, s[8:11], s30 offen offset:0 sc1 nt lds
    v_mfma_f32_16x16x32_bf16 v[104:107], a[136:139], v[72:75], v[104:107]
    v_exp_f32_e64 v145, v97 clamp
    v_mfma_f32_16x16x32_bf16 v[104:107], a[140:143], v[76:79], v[104:107]
    buffer_load_dwordx4 v225, s[8:11], s30 offen offset:1024 sc1 nt lds
    v_mfma_f32_16x16x32_bf16 v[108:111], a[144:147], v[64:67], v[140:143]
    v_exp_f32_e64 v146, v98 clamp
    v_mfma_f32_16x16x32_bf16 v[108:111], a[148:151], v[68:71], v[108:111]
    buffer_load_dwordx4 v224, s[8:11], s30 offen offset:2048 sc1 nt lds
    v_mfma_f32_16x16x32_bf16 v[108:111], a[152:155], v[72:75], v[108:111]
    v_exp_f32_e64 v147, v99 clamp
    v_mfma_f32_16x16x32_bf16 v[108:111], a[156:159], v[76:79], v[108:111]
    buffer_load_dwordx4 v225, s[8:11], s30 offen offset:3072 sc1 nt lds
    v_mfma_f32_16x16x32_bf16 a[96:99], a[224:227], v[124:127], a[96:99]
    v_cmp_lt_f32 vcc, s32, v152
    v_cvt_pk_bf16_f32 v120, v144, v145
    v_mfma_f32_16x16x32_bf16 a[100:103], a[228:231], v[124:127], a[100:103]
    v_mfma_f32_16x16x32_bf16 a[104:107], a[232:235], v[124:127], a[104:107]
    v_exp_f32_e64 v148, v100 clamp
    v_mfma_f32_16x16x32_bf16 a[108:111], a[236:239], v[124:127], a[108:111]
    v_exp_f32_e64 v149, v101 clamp
    v_mfma_f32_16x16x32_bf16 a[112:115], a[240:243], v[124:127], a[112:115]
    v_exp_f32_e64 v150, v102 clamp
    v_mfma_f32_16x16x32_bf16 a[116:119], a[244:247], v[124:127], a[116:119]
    s_cbranch_vccnz Lrs11
Lrb11:
    v_mfma_f32_16x16x32_bf16 a[120:123], a[248:251], v[124:127], a[120:123]
    s_waitcnt vmcnt(14) lgkmcnt(0)
    v_exp_f32_e64 v151, v103 clamp
    v_mfma_f32_16x16x32_bf16 a[124:127], a[252:255], v[124:127], a[124:127]
    s_barrier
    ds_read_b64_tr_b16 v[204:205], v251 offset:1024
    v_mfma_f32_16x16x32_bf16 v[80:83], a[160:163], v[16:19], v[128:131]
    v_exp_f32_e64 v176, v104 clamp
    v_mfma_f32_16x16x32_bf16 v[80:83], a[164:167], v[20:23], v[80:83]
    v_exp_f32_e64 v177, v105 clamp
    v_mfma_f32_16x16x32_bf16 v[80:83], a[168:171], v[24:27], v[80:83]
    ds_read_b64_tr_b16 a[224:225], v216 offset:57344
    v_cvt_pk_bf16_f32 v121, v146, v147
    v_mfma_f32_16x16x32_bf16 v[80:83], a[172:175], v[28:31], v[80:83]
    ds_read_b64_tr_b16 a[226:227], v216 offset:61440
    v_cvt_pk_bf16_f32 v122, v148, v149
    v_mfma_f32_16x16x32_bf16 v[84:87], a[176:179], v[16:19], v[128:131]
    v_exp_f32_e64 v178, v106 clamp
    v_mfma_f32_16x16x32_bf16 v[84:87], a[180:183], v[20:23], v[84:87]
    v_exp_f32_e64 v179, v107 clamp
    v_mfma_f32_16x16x32_bf16 v[84:87], a[184:187], v[24:27], v[84:87]
    ds_read_b64_tr_b16 a[228:229], v217 offset:57344
    v_cvt_pk_bf16_f32 v123, v150, v151
    v_mfma_f32_16x16x32_bf16 v[84:87], a[188:191], v[28:31], v[84:87]
    ds_read_b64_tr_b16 a[230:231], v217 offset:61440
    v_cvt_pk_bf16_f32 v124, v176, v177
    v_mfma_f32_16x16x32_bf16 a[0:3], a[192:195], v[112:115], a[0:3]
    v_exp_f32_e64 v180, v108 clamp
    v_mfma_f32_16x16x32_bf16 a[4:7], a[196:199], v[112:115], a[4:7]
    v_exp_f32_e64 v181, v109 clamp
    v_mfma_f32_16x16x32_bf16 a[8:11], a[200:203], v[112:115], a[8:11]
    ds_read_b64_tr_b16 a[232:233], v218 offset:57344
    v_cvt_pk_bf16_f32 v125, v178, v179
    v_mfma_f32_16x16x32_bf16 a[12:15], a[204:207], v[112:115], a[12:15]
    ds_read_b64_tr_b16 a[234:235], v218 offset:61440
    v_cvt_pk_bf16_f32 v126, v180, v181
    v_mfma_f32_16x16x32_bf16 a[16:19], a[208:211], v[112:115], a[16:19]
    v_exp_f32_e64 v182, v110 clamp
    v_mfma_f32_16x16x32_bf16 a[20:23], a[212:215], v[112:115], a[20:23]
    v_exp_f32_e64 v183, v111 clamp
    v_mfma_f32_16x16x32_bf16 a[24:27], a[216:219], v[112:115], a[24:27]
    ds_read_b64_tr_b16 a[236:237], v219 offset:57344
    v_cvt_pk_bf16_f32 v127, v182, v183
    v_mfma_f32_16x16x32_bf16 a[28:31], a[220:223], v[112:115], a[28:31]
    ds_read_b64_tr_b16 a[238:239], v219 offset:61440
    v_smfmac_f32_16x16x64_bf16 v[156:159], v[208:211], v[120:127], v255
    ds_read_b64_tr_b16 a[240:241], v220 offset:57344
    v_mfma_f32_16x16x32_bf16 v[88:91], a[160:163], v[32:35], v[132:135]
    v_exp_f32_e64 v176, v80 clamp
    v_mfma_f32_16x16x32_bf16 v[88:91], a[164:167], v[36:39], v[88:91]
    v_exp_f32_e64 v177, v81 clamp
    v_mfma_f32_16x16x32_bf16 v[88:91], a[168:171], v[40:43], v[88:91]
    ds_read_b64_tr_b16 a[242:243], v220 offset:61440
    v_cvt_pk_bf16_f32 v112, v176, v177
    v_mfma_f32_16x16x32_bf16 v[88:91], a[172:175], v[44:47], v[88:91]
    ds_read_b64_tr_b16 a[244:245], v221 offset:57344
    v_mfma_f32_16x16x32_bf16 v[92:95], a[176:179], v[32:35], v[132:135]
    v_exp_f32_e64 v178, v82 clamp
    v_mfma_f32_16x16x32_bf16 v[92:95], a[180:183], v[36:39], v[92:95]
    v_exp_f32_e64 v179, v83 clamp
    v_mfma_f32_16x16x32_bf16 v[92:95], a[184:187], v[40:43], v[92:95]
    ds_read_b64_tr_b16 a[246:247], v221 offset:61440
    v_cvt_pk_bf16_f32 v113, v178, v179
    v_mfma_f32_16x16x32_bf16 v[92:95], a[188:191], v[44:47], v[92:95]
    ds_read_b64_tr_b16 a[248:249], v222 offset:57344
    v_cmp_lt_f32 vcc, s32, v156
    v_mfma_f32_16x16x32_bf16 a[32:35], a[192:195], v[116:119], a[32:35]
    v_exp_f32_e64 v180, v84 clamp
    v_mfma_f32_16x16x32_bf16 a[36:39], a[196:199], v[116:119], a[36:39]
    v_exp_f32_e64 v181, v85 clamp
    v_mfma_f32_16x16x32_bf16 a[40:43], a[200:203], v[116:119], a[40:43]
    ds_read_b64_tr_b16 a[250:251], v222 offset:61440
    v_cvt_pk_bf16_f32 v114, v180, v181
    v_mfma_f32_16x16x32_bf16 a[44:47], a[204:207], v[116:119], a[44:47]
    s_cbranch_vccnz Lrs12
Lrb12:
    v_mfma_f32_16x16x32_bf16 a[48:51], a[208:211], v[116:119], a[48:51]
    v_exp_f32_e64 v182, v86 clamp
    v_mfma_f32_16x16x32_bf16 a[52:55], a[212:215], v[116:119], a[52:55]
    v_exp_f32_e64 v183, v87 clamp
    v_mfma_f32_16x16x32_bf16 a[56:59], a[216:219], v[116:119], a[56:59]
    ds_read_b64_tr_b16 a[252:253], v223 offset:57344
    v_cvt_pk_bf16_f32 v115, v182, v183
    v_mfma_f32_16x16x32_bf16 a[60:63], a[220:223], v[116:119], a[60:63]
    ds_read_b64_tr_b16 a[254:255], v223 offset:61440
    v_mfma_f32_16x16x32_bf16 v[96:99], a[160:163], v[48:51], v[136:139]
    v_exp_f32_e64 v176, v88 clamp
    v_mfma_f32_16x16x32_bf16 v[96:99], a[164:167], v[52:55], v[96:99]
    v_exp_f32_e64 v177, v89 clamp
    v_mfma_f32_16x16x32_bf16 v[96:99], a[168:171], v[56:59], v[96:99]
    ds_read_b128 a[128:131], v212 offset:0
    v_cvt_pk_bf16_f32 v116, v176, v177
    v_mfma_f32_16x16x32_bf16 v[96:99], a[172:175], v[60:63], v[96:99]
    ds_read_b128 a[132:135], v213 offset:0
    v_mfma_f32_16x16x32_bf16 v[100:103], a[176:179], v[48:51], v[136:139]
    v_exp_f32_e64 v178, v90 clamp
    v_mfma_f32_16x16x32_bf16 v[100:103], a[180:183], v[52:55], v[100:103]
    v_exp_f32_e64 v179, v91 clamp
    v_mfma_f32_16x16x32_bf16 v[100:103], a[184:187], v[56:59], v[100:103]
    ds_read_b128 a[136:139], v214 offset:0
    v_cvt_pk_bf16_f32 v117, v178, v179
    v_mfma_f32_16x16x32_bf16 v[100:103], a[188:191], v[60:63], v[100:103]
    ds_read_b128 a[140:143], v215 offset:0
    v_mfma_f32_16x16x32_bf16 a[64:67], a[192:195], v[120:123], a[64:67]
    v_exp_f32_e64 v180, v92 clamp
    v_mfma_f32_16x16x32_bf16 a[68:71], a[196:199], v[120:123], a[68:71]
    v_exp_f32_e64 v181, v93 clamp
    v_mfma_f32_16x16x32_bf16 a[72:75], a[200:203], v[120:123], a[72:75]
    ds_read_b128 a[144:147], v212 offset:4096
    v_cvt_pk_bf16_f32 v118, v180, v181
    v_mfma_f32_16x16x32_bf16 a[76:79], a[204:207], v[120:123], a[76:79]
    ds_read_b128 a[148:151], v213 offset:4096
    v_mfma_f32_16x16x32_bf16 a[80:83], a[208:211], v[120:123], a[80:83]
    v_exp_f32_e64 v182, v94 clamp
    v_mfma_f32_16x16x32_bf16 a[84:87], a[212:215], v[120:123], a[84:87]
    v_exp_f32_e64 v183, v95 clamp
    v_mfma_f32_16x16x32_bf16 a[88:91], a[216:219], v[120:123], a[88:91]
    ds_read_b128 a[152:155], v214 offset:4096
    v_cvt_pk_bf16_f32 v119, v182, v183
    v_mfma_f32_16x16x32_bf16 a[92:95], a[220:223], v[120:123], a[92:95]
    ds_read_b128 a[156:159], v215 offset:4096
    v_smfmac_f32_16x16x64_bf16 v[152:155], v[208:211], v[112:119], v255
    s_add_u32 m0, s29, 98304
    ds_read_b64_tr_b16 v[206:207], v251 offset:1536
    v_mfma_f32_16x16x32_bf16 v[104:107], a[160:163], v[64:67], v[140:143]
    v_exp_f32_e64 v144, v96 clamp
    v_mfma_f32_16x16x32_bf16 v[104:107], a[164:167], v[68:71], v[104:107]
    buffer_load_dwordx4 v224, s[12:15], s30 offen offset:0 sc1 nt lds
    v_mfma_f32_16x16x32_bf16 v[104:107], a[168:171], v[72:75], v[104:107]
    v_exp_f32_e64 v145, v97 clamp
    v_mfma_f32_16x16x32_bf16 v[104:107], a[172:175], v[76:79], v[104:107]
    buffer_load_dwordx4 v225, s[12:15], s30 offen offset:1024 sc1 nt lds
    v_mfma_f32_16x16x32_bf16 v[108:111], a[176:179], v[64:67], v[140:143]
    v_exp_f32_e64 v146, v98 clamp
    v_mfma_f32_16x16x32_bf16 v[108:111], a[180:183], v[68:71], v[108:111]
    buffer_load_dwordx4 v224, s[12:15], s30 offen offset:2048 sc1 nt lds
    v_mfma_f32_16x16x32_bf16 v[108:111], a[184:187], v[72:75], v[108:111]
    v_exp_f32_e64 v147, v99 clamp
    v_mfma_f32_16x16x32_bf16 v[108:111], a[188:191], v[76:79], v[108:111]
    buffer_load_dwordx4 v225, s[12:15], s30 offen offset:3072 sc1 nt lds
    v_mfma_f32_16x16x32_bf16 a[96:99], a[192:195], v[124:127], a[96:99]
    s_add_u32 s30, s30, s22
    v_cmp_lt_f32 vcc, s32, v152
    v_cvt_pk_bf16_f32 v120, v144, v145
    v_mfma_f32_16x16x32_bf16 a[100:103], a[196:199], v[124:127], a[100:103]
    s_add_u32 s31, s31, 1
    v_mfma_f32_16x16x32_bf16 a[104:107], a[200:203], v[124:127], a[104:107]
    s_cmp_eq_u32 s31, 8
    v_exp_f32_e64 v148, v100 clamp
    v_mfma_f32_16x16x32_bf16 a[108:111], a[204:207], v[124:127], a[108:111]
    v_exp_f32_e64 v149, v101 clamp
    v_mfma_f32_16x16x32_bf16 a[112:115], a[208:211], v[124:127], a[112:115]
    v_exp_f32_e64 v150, v102 clamp
    v_mfma_f32_16x16x32_bf16 a[116:119], a[212:215], v[124:127], a[116:119]
    s_cbranch_vccnz Lrs13
Lrb13:
    v_mfma_f32_16x16x32_bf16 a[120:123], a[216:219], v[124:127], a[120:123]
    s_waitcnt lgkmcnt(0)
    v_exp_f32_e64 v151, v103 clamp
    v_mfma_f32_16x16x32_bf16 a[124:127], a[220:223], v[124:127], a[124:127]
    buffer_store_dwordx4 v[200:203], v252, s[52:55], s57 offen sc1
    v_mfma_f32_16x16x32_bf16 v[230:233], v[200:203], v[226:229], v[230:233]
    s_cbranch_scc1 Ltail
    v_mfma_f32_16x16x32_bf16 v[80:83], a[128:131], v[16:19], v[128:131]
    s_mov_b32 s37, s63
    v_exp_f32_e64 v176, v104 clamp
    v_mfma_f32_16x16x32_bf16 v[80:83], a[132:135], v[20:23], v[80:83]
    s_add_u32 s56, s56, s94
    v_exp_f32_e64 v177, v105 clamp
    v_mfma_f32_16x16x32_bf16 v[80:83], a[136:139], v[24:27], v[80:83]
    s_add_u32 s57, s57, s95
    ds_read_b64_tr_b16 a[192:193], v216 offset:0
    v_cvt_pk_bf16_f32 v121, v146, v147
    v_mfma_f32_16x16x32_bf16 v[80:83], a[140:143], v[28:31], v[80:83]
    s_add_u32 s58, s58, 1024
    ds_read_b64_tr_b16 a[194:195], v216 offset:4096
    v_cvt_pk_bf16_f32 v122, v148, v149
    v_mfma_f32_16x16x32_bf16 v[84:87], a[144:147], v[16:19], v[128:131]
    s_add_u32 s61, s61, s18
    v_exp_f32_e64 v178, v106 clamp
    v_mfma_f32_16x16x32_bf16 v[84:87], a[148:151], v[20:23], v[84:87]
    s_add_u32 s63, s63, 1024
    v_exp_f32_e64 v179, v107 clamp
    v_mfma_f32_16x16x32_bf16 v[84:87], a[152:155], v[24:27], v[84:87]
    s_cmp_eq_u32 s31, 5
    ds_read_b64_tr_b16 a[196:197], v217 offset:0
    v_cvt_pk_bf16_f32 v123, v150, v151
    v_mfma_f32_16x16x32_bf16 v[84:87], a[156:159], v[28:31], v[84:87]
    s_cselect_b32 s100, s101, 67108864
    ds_read_b64_tr_b16 a[198:199], v217 offset:4096
    v_cvt_pk_bf16_f32 v124, v176, v177
    v_mfma_f32_16x16x32_bf16 a[0:3], a[224:227], v[112:115], a[0:3]
    s_cmp_eq_u32 s31, 4
    v_exp_f32_e64 v180, v108 clamp
    v_mfma_f32_16x16x32_bf16 a[4:7], a[228:231], v[112:115], a[4:7]
    s_cselect_b32 s44, s6, 0
    v_exp_f32_e64 v181, v109 clamp
    v_mfma_f32_16x16x32_bf16 a[8:11], a[232:235], v[112:115], a[8:11]
    s_sub_u32 s61, s61, s44
    ds_read_b64_tr_b16 a[200:201], v218 offset:0
    v_cvt_pk_bf16_f32 v125, v178, v179
    v_mfma_f32_16x16x32_bf16 a[12:15], a[236:239], v[112:115], a[12:15]
    ds_read_b64_tr_b16 a[202:203], v218 offset:4096
    v_cvt_pk_bf16_f32 v126, v180, v181
    v_mfma_f32_16x16x32_bf16 a[16:19], a[240:243], v[112:115], a[16:19]
    s_sub_u32 s95, s87, s95
    v_exp_f32_e64 v182, v110 clamp
    v_mfma_f32_16x16x32_bf16 a[20:23], a[244:247], v[112:115], a[20:23]
    v_exp_f32_e64 v183, v111 clamp
    v_mfma_f32_16x16x32_bf16 a[24:27], a[248:251], v[112:115], a[24:27]
    ds_read_b64_tr_b16 a[204:205], v219 offset:0
    v_cvt_pk_bf16_f32 v127, v182, v183
    v_mfma_f32_16x16x32_bf16 a[28:31], a[252:255], v[112:115], a[28:31]
    ds_read_b64_tr_b16 a[206:207], v219 offset:4096
    v_smfmac_f32_16x16x64_bf16 v[156:159], v[208:211], v[120:127], v255
    s_cmp_eq_u32 s31, 5
    ds_read_b64_tr_b16 a[208:209], v220 offset:0
    v_mfma_f32_16x16x32_bf16 v[88:91], a[128:131], v[32:35], v[132:135]
    s_cselect_b32 s48, s92, s48
    v_exp_f32_e64 v176, v80 clamp
    v_mfma_f32_16x16x32_bf16 v[88:91], a[132:135], v[36:39], v[88:91]
    s_cselect_b32 s49, s93, s49
    v_exp_f32_e64 v177, v81 clamp
    v_mfma_f32_16x16x32_bf16 v[88:91], a[136:139], v[40:43], v[88:91]
    s_cselect_b32 s56, s90, s56
    ds_read_b64_tr_b16 a[210:211], v220 offset:4096
    v_cvt_pk_bf16_f32 v112, v176, v177
    v_mfma_f32_16x16x32_bf16 v[88:91], a[140:143], v[44:47], v[88:91]
    s_cselect_b32 s57, s91, s57
    ds_read_b64_tr_b16 a[212:213], v221 offset:0
    v_mfma_f32_16x16x32_bf16 v[92:95], a[144:147], v[32:35], v[132:135]
    s_cselect_b32 s58, 67108864, s58
    v_exp_f32_e64 v178, v82 clamp
    v_mfma_f32_16x16x32_bf16 v[92:95], a[148:151], v[36:39], v[92:95]
    s_cselect_b32 s59, 1280, s59
    v_exp_f32_e64 v179, v83 clamp
    v_mfma_f32_16x16x32_bf16 v[92:95], a[152:155], v[40:43], v[92:95]
    s_cselect_b32 s94, 737280, s94
    ds_read_b64_tr_b16 a[214:215], v221 offset:4096
    v_cvt_pk_bf16_f32 v113, v178, v179
    v_mfma_f32_16x16x32_bf16 v[92:95], a[156:159], v[44:47], v[92:95]
    s_cselect_b32 s95, 737280, s95
    ds_read_b64_tr_b16 a[216:217], v222 offset:0
    v_cmp_lt_f32 vcc, s32, v156
    v_mfma_f32_16x16x32_bf16 a[32:35], a[224:227], v[116:119], a[32:35]
    s_cselect_b32 s61, s19, s61
    v_exp_f32_e64 v180, v84 clamp
    v_mfma_f32_16x16x32_bf16 a[36:39], a[228:231], v[116:119], a[36:39]
    s_cselect_b32 s63, 67108864, s63
    v_exp_f32_e64 v181, v85 clamp
    v_mfma_f32_16x16x32_bf16 a[40:43], a[232:235], v[116:119], a[40:43]
    ds_read_b64_tr_b16 a[218:219], v222 offset:4096
    v_cvt_pk_bf16_f32 v114, v180, v181
    v_mfma_f32_16x16x32_bf16 a[44:47], a[236:239], v[116:119], a[44:47]
    s_cbranch_vccnz Lrs14
Lrb14:
    v_mfma_f32_16x16x32_bf16 a[48:51], a[240:243], v[116:119], a[48:51]
    v_exp_f32_e64 v182, v86 clamp
    v_mfma_f32_16x16x32_bf16 a[52:55], a[244:247], v[116:119], a[52:55]
    v_exp_f32_e64 v183, v87 clamp
    v_mfma_f32_16x16x32_bf16 a[56:59], a[248:251], v[116:119], a[56:59]
    ds_read_b64_tr_b16 a[220:221], v223 offset:0
    v_cvt_pk_bf16_f32 v115, v182, v183
    v_mfma_f32_16x16x32_bf16 a[60:63], a[252:255], v[116:119], a[60:63]
    ds_read_b64_tr_b16 a[222:223], v223 offset:4096
    v_mfma_f32_16x16x32_bf16 v[96:99], a[128:131], v[48:51], v[136:139]
    s_cmp_eq_u32 s31, 5
    v_exp_f32_e64 v176, v88 clamp
    v_mfma_f32_16x16x32_bf16 v[96:99], a[132:135], v[52:55], v[96:99]
    s_cselect_b32 s87, 1474560, s87
    v_exp_f32_e64 v177, v89 clamp
    v_mfma_f32_16x16x32_bf16 v[96:99], a[136:139], v[56:59], v[96:99]
    s_cselect_b32 s96, s52, s96
    ds_read_b128 a[160:163], v212 offset:8192
    v_cvt_pk_bf16_f32 v116, v176, v177
    v_mfma_f32_16x16x32_bf16 v[96:99], a[140:143], v[60:63], v[96:99]
    s_cselect_b32 s97, s53, s97
    ds_read_b128 a[164:167], v213 offset:8192
    v_mfma_f32_16x16x32_bf16 v[100:103], a[144:147], v[48:51], v[136:139]
    s_cselect_b32 s98, s54, s98
    v_exp_f32_e64 v178, v90 clamp
    v_mfma_f32_16x16x32_bf16 v[100:103], a[148:151], v[52:55], v[100:103]
    s_cselect_b32 s16, 256, s16
    v_exp_f32_e64 v179, v91 clamp
    v_mfma_f32_16x16x32_bf16 v[100:103], a[152:155], v[56:59], v[100:103]
    s_cselect_b32 s17, 8, s17
    ds_read_b128 a[168:171], v214 offset:8192
    v_cvt_pk_bf16_f32 v117, v178, v179
    v_mfma_f32_16x16x32_bf16 v[100:103], a[156:159], v[60:63], v[100:103]
    s_cselect_b32 s18, 6144, s18
    ds_read_b128 a[172:175], v215 offset:8192
    v_mfma_f32_16x16x32_bf16 a[64:67], a[224:227], v[120:123], a[64:67]
    v_exp_f32_e64 v180, v92 clamp
    v_mfma_f32_16x16x32_bf16 a[68:71], a[228:231], v[120:123], a[68:71]
    v_exp_f32_e64 v181, v93 clamp
    v_mfma_f32_16x16x32_bf16 a[72:75], a[232:235], v[120:123], a[72:75]
    ds_read_b128 a[176:179], v212 offset:12288
    v_cvt_pk_bf16_f32 v118, v180, v181
    v_mfma_f32_16x16x32_bf16 a[76:79], a[236:239], v[120:123], a[76:79]
    ds_read_b128 a[180:183], v213 offset:12288
    v_mfma_f32_16x16x32_bf16 a[80:83], a[240:243], v[120:123], a[80:83]
    v_exp_f32_e64 v182, v94 clamp
    v_mfma_f32_16x16x32_bf16 a[84:87], a[244:247], v[120:123], a[84:87]
    v_exp_f32_e64 v183, v95 clamp
    v_mfma_f32_16x16x32_bf16 a[88:91], a[248:251], v[120:123], a[88:91]
    ds_read_b128 a[184:187], v214 offset:12288
    v_cvt_pk_bf16_f32 v119, v182, v183
    v_mfma_f32_16x16x32_bf16 a[92:95], a[252:255], v[120:123], a[92:95]
    ds_read_b128 a[188:191], v215 offset:12288
    v_smfmac_f32_16x16x64_bf16 v[152:155], v[208:211], v[112:119], v255
    s_add_u32 m0, s29, 49152
    v_mfma_f32_16x16x32_bf16 v[104:107], a[128:131], v[64:67], v[140:143]
    v_exp_f32_e64 v144, v96 clamp
    v_mfma_f32_16x16x32_bf16 v[104:107], a[132:135], v[68:71], v[104:107]
    buffer_load_dwordx4 v224, s[8:11], s30 offen offset:0 sc1 nt lds
    v_mfma_f32_16x16x32_bf16 v[104:107], a[136:139], v[72:75], v[104:107]
    v_exp_f32_e64 v145, v97 clamp
    v_mfma_f32_16x16x32_bf16 v[104:107], a[140:143], v[76:79], v[104:107]
    buffer_load_dwordx4 v225, s[8:11], s30 offen offset:1024 sc1 nt lds
    v_mfma_f32_16x16x32_bf16 v[108:111], a[144:147], v[64:67], v[140:143]
    v_exp_f32_e64 v146, v98 clamp
    v_mfma_f32_16x16x32_bf16 v[108:111], a[148:151], v[68:71], v[108:111]
    buffer_load_dwordx4 v224, s[8:11], s30 offen offset:2048 sc1 nt lds
    v_mfma_f32_16x16x32_bf16 v[108:111], a[152:155], v[72:75], v[108:111]
    v_exp_f32_e64 v147, v99 clamp
    v_mfma_f32_16x16x32_bf16 v[108:111], a[156:159], v[76:79], v[108:111]
    buffer_load_dwordx4 v225, s[8:11], s30 offen offset:3072 sc1 nt lds
    v_mfma_f32_16x16x32_bf16 a[96:99], a[224:227], v[124:127], a[96:99]
    v_cmp_lt_f32 vcc, s32, v152
    v_cvt_pk_bf16_f32 v120, v144, v145
    v_mfma_f32_16x16x32_bf16 a[100:103], a[228:231], v[124:127], a[100:103]
    v_mfma_f32_16x16x32_bf16 a[104:107], a[232:235], v[124:127], a[104:107]
    v_exp_f32_e64 v148, v100 clamp
    v_mfma_f32_16x16x32_bf16 a[108:111], a[236:239], v[124:127], a[108:111]
    v_exp_f32_e64 v149, v101 clamp
    v_mfma_f32_16x16x32_bf16 a[112:115], a[240:243], v[124:127], a[112:115]
    v_exp_f32_e64 v150, v102 clamp
    v_mfma_f32_16x16x32_bf16 a[116:119], a[244:247], v[124:127], a[116:119]
    s_cbranch_vccnz Lrs15
Lrb15:
    v_mfma_f32_16x16x32_bf16 a[120:123], a[248:251], v[124:127], a[120:123]
    s_waitcnt vmcnt(13) lgkmcnt(0)
    v_exp_f32_e64 v151, v103 clamp
    v_mfma_f32_16x16x32_bf16 a[124:127], a[252:255], v[124:127], a[124:127]
    s_barrier
    buffer_store_dwordx4 v[204:207], v252, s[52:55], s37 offen sc1
    s_branch Lloop
Ltail:
    s_cmp_eq_u32 s23, 0
    s_cbranch_scc1 Llate
Lgo:
    v_mfma_f32_16x16x32_bf16 a[0:3], a[224:227], v[112:115], a[0:3]
    v_exp_f32_e64 v176, v104 clamp
    v_mfma_f32_16x16x32_bf16 a[4:7], a[228:231], v[112:115], a[4:7]
    v_exp_f32_e64 v177, v105 clamp
    v_mfma_f32_16x16x32_bf16 a[8:11], a[232:235], v[112:115], a[8:11]
    v_exp_f32_e64 v178, v106 clamp
    v_mfma_f32_16x16x32_bf16 a[12:15], a[236:239], v[112:115], a[12:15]
    v_exp_f32_e64 v179, v107 clamp
    v_mfma_f32_16x16x32_bf16 a[16:19], a[240:243], v[112:115], a[16:19]
    v_exp_f32_e64 v180, v108 clamp
    v_mfma_f32_16x16x32_bf16 a[20:23], a[244:247], v[112:115], a[20:23]
    v_exp_f32_e64 v181, v109 clamp
    v_mfma_f32_16x16x32_bf16 a[24:27], a[248:251], v[112:115], a[24:27]
    v_exp_f32_e64 v182, v110 clamp
    v_mfma_f32_16x16x32_bf16 a[28:31], a[252:255], v[112:115], a[28:31]
    v_exp_f32_e64 v183, v111 clamp
    v_mfma_f32_16x16x32_bf16 a[32:35], a[224:227], v[116:119], a[32:35]
    v_cvt_pk_bf16_f32 v121, v146, v147
    v_cvt_pk_bf16_f32 v122, v148, v149
    v_mfma_f32_16x16x32_bf16 a[36:39], a[228:231], v[116:119], a[36:39]
    v_cvt_pk_bf16_f32 v123, v150, v151
    v_cvt_pk_bf16_f32 v124, v176, v177
    v_mfma_f32_16x16x32_bf16 a[40:43], a[232:235], v[116:119], a[40:43]
    v_cvt_pk_bf16_f32 v125, v178, v179
    v_cvt_pk_bf16_f32 v126, v180, v181
    v_mfma_f32_16x16x32_bf16 a[44:47], a[236:239], v[116:119], a[44:47]
    v_cvt_pk_bf16_f32 v127, v182, v183
    v_mfma_f32_16x16x32_bf16 a[48:51], a[240:243], v[116:119], a[48:51]
    s_add_u32 s40, s7, 0
    buffer_load_dwordx4 a[128:131], v252, s[52:55], s40 offen offset:0 sc1
    v_smfmac_f32_16x16x64_bf16 v[156:159], v[208:211], v[120:127], v255
    v_mov_b32 v5, v252
    v_mfma_f32_16x16x32_bf16 a[52:55], a[244:247], v[116:119], a[52:55]
    buffer_load_dwordx4 a[132:135], v252, s[52:55], s40 offen offset:1024 sc1
    v_mfma_f32_16x16x32_bf16 a[56:59], a[248:251], v[116:119], a[56:59]
    buffer_load_dwordx4 a[136:139], v252, s[52:55], s40 offen offset:2048 sc1
    v_mfma_f32_16x16x32_bf16 a[60:63], a[252:255], v[116:119], a[60:63]
    buffer_load_dwordx4 a[140:143], v252, s[52:55], s40 offen offset:3072 sc1
    s_mov_b32 s20, -1
    s_mov_b32 s21, 0
    v_cmp_lt_f32 vcc, s32, v156
    s_mov_b32 s46, 0
    v_add_f32 v192, v152, v153
    v_add_f32 v193, v154, v155
    v_cndmask_b32 v192, v193, v192, s[20:21]
    v_rcp_f32 v192, v192
    v_accvgpr_read_b32 v16, a0
    v_accvgpr_read_b32 v17, a1
    v_accvgpr_read_b32 v18, a2
    s_cbranch_vccnz Lrs16
Lrb16:
    v_mfma_f32_16x16x32_bf16 a[64:67], a[224:227], v[120:123], a[64:67]
    s_add_u32 s41, s7, 4096
    buffer_load_dwordx4 a[144:147], v252, s[52:55], s41 offen offset:0 sc1
    v_accvgpr_read_b32 v19, a3
    v_accvgpr_read_b32 v20, a4
    v_mfma_f32_16x16x32_bf16 a[68:71], a[228:231], v[120:123], a[68:71]
    buffer_load_dwordx4 a[148:151], v252, s[52:55], s41 offen offset:1024 sc1
    v_accvgpr_read_b32 v21, a5
    v_accvgpr_read_b32 v22, a6
    v_mfma_f32_16x16x32_bf16 a[72:75], a[232:235], v[120:123], a[72:75]
    buffer_load_dwordx4 a[152:155], v252, s[52:55], s41 offen offset:2048 sc1
    v_accvgpr_read_b32 v23, a7
    v_mul_f32 v16, v16, v192
    v_mfma_f32_16x16x32_bf16 a[76:79], a[236:239], v[120:123], a[76:79]
    buffer_load_dwordx4 a[156:159], v252, s[52:55], s41 offen offset:3072 sc1
    v_mul_f32 v17, v17, v192
    v_mul_f32 v18, v18, v192
    v_mfma_f32_16x16x32_bf16 a[80:83], a[240:243], v[120:123], a[80:83]
    s_add_u32 s40, s7, 8192
    buffer_load_dwordx4 a[160:163], v252, s[52:55], s40 offen offset:0 sc1
    v_mul_f32 v19, v19, v192
    v_mul_f32 v20, v20, v192
    v_mfma_f32_16x16x32_bf16 a[84:87], a[244:247], v[120:123], a[84:87]
    buffer_load_dwordx4 a[164:167], v252, s[52:55], s40 offen offset:1024 sc1
    v_mul_f32 v21, v21, v192
    v_mul_f32 v22, v22, v192
    v_mfma_f32_16x16x32_bf16 a[88:91], a[248:251], v[120:123], a[88:91]
    buffer_load_dwordx4 a[168:171], v252, s[52:55], s40 offen offset:2048 sc1
    v_mul_f32 v23, v23, v192
    v_cvt_pk_bf16_f32 v176, v16, v17
    v_mfma_f32_16x16x32_bf16 a[92:95], a[252:255], v[120:123], a[92:95]
    buffer_load_dwordx4 a[172:175], v252, s[52:55], s40 offen offset:3072 sc1
    v_cvt_pk_bf16_f32 v177, v18, v19
    v_cvt_pk_bf16_f32 v178, v20, v21
    v_mfma_f32_16x16x32_bf16 a[96:99], a[224:227], v[124:127], a[96:99]
    v_cvt_pk_bf16_f32 v179, v22, v23
    buffer_store_dwordx4 v[176:179], v246, s[24:27], s46 offen offset:0 sc1
    v_mfma_f32_16x16x32_bf16 a[100:103], a[228:231], v[124:127], a[100:103]
    v_accvgpr_read_b32 v24, a8
    v_accvgpr_read_b32 v25, a9
    v_mfma_f32_16x16x32_bf16 a[104:107], a[232:235], v[124:127], a[104:107]
    v_accvgpr_read_b32 v26, a10
    v_accvgpr_read_b32 v27, a11
    v_mfma_f32_16x16x32_bf16 a[108:111], a[236:239], v[124:127], a[108:111]
    v_accvgpr_read_b32 v28, a12
    v_accvgpr_read_b32 v29, a13
    v_mfma_f32_16x16x32_bf16 a[112:115], a[240:243], v[124:127], a[112:115]
    v_accvgpr_read_b32 v30, a14
    v_accvgpr_read_b32 v31, a15
    v_mfma_f32_16x16x32_bf16 a[116:119], a[244:247], v[124:127], a[116:119]
    v_mul_f32 v24, v24, v192
    v_mul_f32 v25, v25, v192
    v_mfma_f32_16x16x32_bf16 a[120:123], a[248:251], v[124:127], a[120:123]
    v_mul_f32 v26, v26, v192
    v_mul_f32 v27, v27, v192
    v_mfma_f32_16x16x32_bf16 a[124:127], a[252:255], v[124:127], a[124:127]
    v_mul_f32 v28, v28, v192
    v_mul_f32 v29, v29, v192
    v_mul_f32 v30, v30, v192
    v_mul_f32 v31, v31, v192
    v_cvt_pk_bf16_f32 v180, v24, v25
    v_cvt_pk_bf16_f32 v181, v26, v27
    v_cvt_pk_bf16_f32 v182, v28, v29
    v_cvt_pk_bf16_f32 v183, v30, v31
    buffer_store_dwordx4 v[180:183], v246, s[24:27], s46 offen offset:1024 sc1
    v_accvgpr_read_b32 v16, a16
    v_accvgpr_read_b32 v17, a17
    v_accvgpr_read_b32 v18, a18
    v_accvgpr_read_b32 v19, a19
    v_accvgpr_read_b32 v20, a20
    v_accvgpr_read_b32 v21, a21
    v_accvgpr_read_b32 v22, a22
    v_accvgpr_read_b32 v23, a23
    v_pk_mul_f32 v[16:17], v[16:17], v[192:193] op_sel_hi:[1,0]
    v_pk_mul_f32 v[18:19], v[18:19], v[192:193] op_sel_hi:[1,0]
    v_pk_mul_f32 v[20:21], v[20:21], v[192:193] op_sel_hi:[1,0]
    v_pk_mul_f32 v[22:23], v[22:23], v[192:193] op_sel_hi:[1,0]
    v_cvt_pk_bf16_f32 v176, v16, v17
    v_cvt_pk_bf16_f32 v177, v18, v19
    v_cvt_pk_bf16_f32 v178, v20, v21
    v_cvt_pk_bf16_f32 v179, v22, v23
    buffer_store_dwordx4 v[176:179], v246, s[24:27], s46 offen offset:2048 sc1
    v_accvgpr_read_b32 v24, a24
    v_accvgpr_read_b32 v25, a25
    v_accvgpr_read_b32 v26, a26
    v_accvgpr_read_b32 v27, a27
    v_accvgpr_read_b32 v28, a28
    v_accvgpr_read_b32 v29, a29
    v_accvgpr_read_b32 v30, a30
    v_accvgpr_read_b32 v31, a31
    v_pk_mul_f32 v[24:25], v[24:25], v[192:193] op_sel_hi:[1,0]
    v_pk_mul_f32 v[26:27], v[26:27], v[192:193] op_sel_hi:[1,0]
    v_pk_mul_f32 v[28:29], v[28:29], v[192:193] op_sel_hi:[1,0]
    v_pk_mul_f32 v[30:31], v[30:31], v[192:193] op_sel_hi:[1,0]
    v_cvt_pk_bf16_f32 v180, v24, v25
    v_cvt_pk_bf16_f32 v181, v26, v27
    v_cvt_pk_bf16_f32 v182, v28, v29
    v_cvt_pk_bf16_f32 v183, v30, v31
    buffer_store_dwordx4 v[180:183], v246, s[24:27], s46 offen offset:3072 sc1
    s_mov_b32 s46, 131072
    v_add_f32 v192, v154, v155
    v_add_f32 v193, v152, v153
    v_cndmask_b32 v192, v193, v192, s[20:21]
    v_rcp_f32 v192, v192
    v_accvgpr_read_b32 v32, a32
    v_accvgpr_read_b32 v33, a33
    v_accvgpr_read_b32 v34, a34
    v_accvgpr_read_b32 v35, a35
    v_accvgpr_read_b32 v36, a36
    v_accvgpr_read_b32 v37, a37
    v_accvgpr_read_b32 v38, a38
    v_accvgpr_read_b32 v39, a39
    v_pk_mul_f32 v[32:33], v[32:33], v[192:193] op_sel_hi:[1,0]
    v_pk_mul_f32 v[34:35], v[34:35], v[192:193] op_sel_hi:[1,0]
    v_pk_mul_f32 v[36:37], v[36:37], v[192:193] op_sel_hi:[1,0]
    v_pk_mul_f32 v[38:39], v[38:39], v[192:193] op_sel_hi:[1,0]
    v_cvt_pk_bf16_f32 v176, v32, v33
    v_cvt_pk_bf16_f32 v177, v34, v35
    v_cvt_pk_bf16_f32 v178, v36, v37
    v_cvt_pk_bf16_f32 v179, v38, v39
    buffer_store_dwordx4 v[176:179], v246, s[24:27], s46 offen offset:0 sc1
    v_accvgpr_read_b32 v40, a40
    v_accvgpr_read_b32 v41, a41
    v_accvgpr_read_b32 v42, a42
    v_accvgpr_read_b32 v43, a43
    v_accvgpr_read_b32 v44, a44
    v_accvgpr_read_b32 v45, a45
    v_accvgpr_read_b32 v46, a46
    v_accvgpr_read_b32 v47, a47
    v_pk_mul_f32 v[40:41], v[40:41], v[192:193] op_sel_hi:[1,0]
    v_pk_mul_f32 v[42:43], v[42:43], v[192:193] op_sel_hi:[1,0]
    v_pk_mul_f32 v[44:45], v[44:45], v[192:193] op_sel_hi:[1,0]
    v_pk_mul_f32 v[46:47], v[46:47], v[192:193] op_sel_hi:[1,0]
    v_cvt_pk_bf16_f32 v180, v40, v41
    v_cvt_pk_bf16_f32 v181, v42, v43
    v_cvt_pk_bf16_f32 v182, v44, v45
    v_cvt_pk_bf16_f32 v183, v46, v47
    buffer_store_dwordx4 v[180:183], v246, s[24:27], s46 offen offset:1024 sc1
    v_accvgpr_read_b32 v32, a48
    v_accvgpr_read_b32 v33, a49
    v_accvgpr_read_b32 v34, a50
    v_accvgpr_read_b32 v35, a51
    v_accvgpr_read_b32 v36, a52
    v_accvgpr_read_b32 v37, a53
    v_accvgpr_read_b32 v38, a54
    v_accvgpr_read_b32 v39, a55
    v_pk_mul_f32 v[32:33], v[32:33], v[192:193] op_sel_hi:[1,0]
    v_pk_mul_f32 v[34:35], v[34:35], v[192:193] op_sel_hi:[1,0]
    v_pk_mul_f32 v[36:37], v[36:37], v[192:193] op_sel_hi:[1,0]
    v_pk_mul_f32 v[38:39], v[38:39], v[192:193] op_sel_hi:[1,0]
    v_cvt_pk_bf16_f32 v176, v32, v33
    v_cvt_pk_bf16_f32 v177, v34, v35
    v_cvt_pk_bf16_f32 v178, v36, v37
    v_cvt_pk_bf16_f32 v179, v38, v39
    buffer_store_dwordx4 v[176:179], v246, s[24:27], s46 offen offset:2048 sc1
    v_accvgpr_read_b32 v40, a56
    v_accvgpr_read_b32 v41, a57
    v_accvgpr_read_b32 v42, a58
    v_accvgpr_read_b32 v43, a59
    v_accvgpr_read_b32 v44, a60
    v_accvgpr_read_b32 v45, a61
    v_accvgpr_read_b32 v46, a62
    v_accvgpr_read_b32 v47, a63
    v_pk_mul_f32 v[40:41], v[40:41], v[192:193] op_sel_hi:[1,0]
    v_pk_mul_f32 v[42:43], v[42:43], v[192:193] op_sel_hi:[1,0]
    v_pk_mul_f32 v[44:45], v[44:45], v[192:193] op_sel_hi:[1,0]
    v_pk_mul_f32 v[46:47], v[46:47], v[192:193] op_sel_hi:[1,0]
    v_cvt_pk_bf16_f32 v180, v40, v41
    v_cvt_pk_bf16_f32 v181, v42, v43
    v_cvt_pk_bf16_f32 v182, v44, v45
    v_cvt_pk_bf16_f32 v183, v46, v47
    buffer_store_dwordx4 v[180:183], v246, s[24:27], s46 offen offset:3072 sc1
    s_mov_b32 s46, 262144
    v_add_f32 v192, v156, v157
    v_add_f32 v193, v158, v159
    v_cndmask_b32 v192, v193, v192, s[20:21]
    v_rcp_f32 v192, v192
    v_accvgpr_read_b32 v48, a64
    v_accvgpr_read_b32 v49, a65
    v_accvgpr_read_b32 v50, a66
    v_accvgpr_read_b32 v51, a67
    v_accvgpr_read_b32 v52, a68
    v_accvgpr_read_b32 v53, a69
    v_accvgpr_read_b32 v54, a70
    v_accvgpr_read_b32 v55, a71
    v_pk_mul_f32 v[48:49], v[48:49], v[192:193] op_sel_hi:[1,0]
    v_pk_mul_f32 v[50:51], v[50:51], v[192:193] op_sel_hi:[1,0]
    v_pk_mul_f32 v[52:53], v[52:53], v[192:193] op_sel_hi:[1,0]
    v_pk_mul_f32 v[54:55], v[54:55], v[192:193] op_sel_hi:[1,0]
    v_cvt_pk_bf16_f32 v176, v48, v49
    v_cvt_pk_bf16_f32 v177, v50, v51
    v_cvt_pk_bf16_f32 v178, v52, v53
    v_cvt_pk_bf16_f32 v179, v54, v55
    buffer_store_dwordx4 v[176:179], v246, s[24:27], s46 offen offset:0 sc1
    v_accvgpr_read_b32 v56, a72
    v_accvgpr_read_b32 v57, a73
    v_accvgpr_read_b32 v58, a74
    v_accvgpr_read_b32 v59, a75
    v_accvgpr_read_b32 v60, a76
    v_accvgpr_read_b32 v61, a77
    v_accvgpr_read_b32 v62, a78
    v_accvgpr_read_b32 v63, a79
    v_pk_mul_f32 v[56:57], v[56:57], v[192:193] op_sel_hi:[1,0]
    v_pk_mul_f32 v[58:59], v[58:59], v[192:193] op_sel_hi:[1,0]
    v_pk_mul_f32 v[60:61], v[60:61], v[192:193] op_sel_hi:[1,0]
    v_pk_mul_f32 v[62:63], v[62:63], v[192:193] op_sel_hi:[1,0]
    v_cvt_pk_bf16_f32 v180, v56, v57
    v_cvt_pk_bf16_f32 v181, v58, v59
    v_cvt_pk_bf16_f32 v182, v60, v61
    v_cvt_pk_bf16_f32 v183, v62, v63
    buffer_store_dwordx4 v[180:183], v246, s[24:27], s46 offen offset:1024 sc1
    v_accvgpr_read_b32 v48, a80
    v_accvgpr_read_b32 v49, a81
    v_accvgpr_read_b32 v50, a82
    v_accvgpr_read_b32 v51, a83
    v_accvgpr_read_b32 v52, a84
    v_accvgpr_read_b32 v53, a85
    v_accvgpr_read_b32 v54, a86
    v_accvgpr_read_b32 v55, a87
    v_pk_mul_f32 v[48:49], v[48:49], v[192:193] op_sel_hi:[1,0]
    v_pk_mul_f32 v[50:51], v[50:51], v[192:193] op_sel_hi:[1,0]
    v_pk_mul_f32 v[52:53], v[52:53], v[192:193] op_sel_hi:[1,0]
    v_pk_mul_f32 v[54:55], v[54:55], v[192:193] op_sel_hi:[1,0]
    v_cvt_pk_bf16_f32 v176, v48, v49
    v_cvt_pk_bf16_f32 v177, v50, v51
    v_cvt_pk_bf16_f32 v178, v52, v53
    v_cvt_pk_bf16_f32 v179, v54, v55
    buffer_store_dwordx4 v[176:179], v246, s[24:27], s46 offen offset:2048 sc1
    v_accvgpr_read_b32 v56, a88
    v_accvgpr_read_b32 v57, a89
    v_accvgpr_read_b32 v58, a90
    v_accvgpr_read_b32 v59, a91
    v_accvgpr_read_b32 v60, a92
    v_accvgpr_read_b32 v61, a93
    v_accvgpr_read_b32 v62, a94
    v_accvgpr_read_b32 v63, a95
    v_pk_mul_f32 v[56:57], v[56:57], v[192:193] op_sel_hi:[1,0]
    v_pk_mul_f32 v[58:59], v[58:59], v[192:193] op_sel_hi:[1,0]
    v_pk_mul_f32 v[60:61], v[60:61], v[192:193] op_sel_hi:[1,0]
    v_pk_mul_f32 v[62:63], v[62:63], v[192:193] op_sel_hi:[1,0]
    v_cvt_pk_bf16_f32 v180, v56, v57
    v_cvt_pk_bf16_f32 v181, v58, v59
    v_cvt_pk_bf16_f32 v182, v60, v61
    v_cvt_pk_bf16_f32 v183, v62, v63
    buffer_store_dwordx4 v[180:183], v246, s[24:27], s46 offen offset:3072 sc1
    s_mov_b32 s46, 393216
    v_add_f32 v192, v158, v159
    v_add_f32 v193, v156, v157
    v_cndmask_b32 v192, v193, v192, s[20:21]
    v_rcp_f32 v192, v192
    v_accvgpr_read_b32 v64, a96
    v_accvgpr_read_b32 v65, a97
    v_accvgpr_read_b32 v66, a98
    v_accvgpr_read_b32 v67, a99
    v_accvgpr_read_b32 v68, a100
    v_accvgpr_read_b32 v69, a101
    v_accvgpr_read_b32 v70, a102
    v_accvgpr_read_b32 v71, a103
    v_pk_mul_f32 v[64:65], v[64:65], v[192:193] op_sel_hi:[1,0]
    v_pk_mul_f32 v[66:67], v[66:67], v[192:193] op_sel_hi:[1,0]
    v_pk_mul_f32 v[68:69], v[68:69], v[192:193] op_sel_hi:[1,0]
    v_pk_mul_f32 v[70:71], v[70:71], v[192:193] op_sel_hi:[1,0]
    v_cvt_pk_bf16_f32 v176, v64, v65
    v_cvt_pk_bf16_f32 v177, v66, v67
    v_cvt_pk_bf16_f32 v178, v68, v69
    v_cvt_pk_bf16_f32 v179, v70, v71
    buffer_store_dwordx4 v[176:179], v246, s[24:27], s46 offen offset:0 sc1
    v_accvgpr_read_b32 v72, a104
    v_accvgpr_read_b32 v73, a105
    v_accvgpr_read_b32 v74, a106
    v_accvgpr_read_b32 v75, a107
    v_accvgpr_read_b32 v76, a108
    v_accvgpr_read_b32 v77, a109
    v_accvgpr_read_b32 v78, a110
    v_accvgpr_read_b32 v79, a111
    v_pk_mul_f32 v[72:73], v[72:73], v[192:193] op_sel_hi:[1,0]
    v_pk_mul_f32 v[74:75], v[74:75], v[192:193] op_sel_hi:[1,0]
    v_pk_mul_f32 v[76:77], v[76:77], v[192:193] op_sel_hi:[1,0]
    v_pk_mul_f32 v[78:79], v[78:79], v[192:193] op_sel_hi:[1,0]
    v_cvt_pk_bf16_f32 v180, v72, v73
    v_cvt_pk_bf16_f32 v181, v74, v75
    v_cvt_pk_bf16_f32 v182, v76, v77
    v_cvt_pk_bf16_f32 v183, v78, v79
    buffer_store_dwordx4 v[180:183], v246, s[24:27], s46 offen offset:1024 sc1
    v_accvgpr_read_b32 v64, a112
    v_accvgpr_read_b32 v65, a113
    v_accvgpr_read_b32 v66, a114
    v_accvgpr_read_b32 v67, a115
    v_accvgpr_read_b32 v68, a116
    v_accvgpr_read_b32 v69, a117
    v_accvgpr_read_b32 v70, a118
    v_accvgpr_read_b32 v71, a119
    v_pk_mul_f32 v[64:65], v[64:65], v[192:193] op_sel_hi:[1,0]
    v_pk_mul_f32 v[66:67], v[66:67], v[192:193] op_sel_hi:[1,0]
    v_pk_mul_f32 v[68:69], v[68:69], v[192:193] op_sel_hi:[1,0]
    v_pk_mul_f32 v[70:71], v[70:71], v[192:193] op_sel_hi:[1,0]
    v_cvt_pk_bf16_f32 v176, v64, v65
    v_cvt_pk_bf16_f32 v177, v66, v67
    v_cvt_pk_bf16_f32 v178, v68, v69
    v_cvt_pk_bf16_f32 v179, v70, v71
    buffer_store_dwordx4 v[176:179], v246, s[24:27], s46 offen offset:2048 sc1
    v_accvgpr_read_b32 v72, a120
    v_accvgpr_read_b32 v73, a121
    v_accvgpr_read_b32 v74, a122
    v_accvgpr_read_b32 v75, a123
    v_accvgpr_read_b32 v76, a124
    v_accvgpr_read_b32 v77, a125
    v_accvgpr_read_b32 v78, a126
    v_accvgpr_read_b32 v79, a127
    v_pk_mul_f32 v[72:73], v[72:73], v[192:193] op_sel_hi:[1,0]
    v_pk_mul_f32 v[74:75], v[74:75], v[192:193] op_sel_hi:[1,0]
    v_pk_mul_f32 v[76:77], v[76:77], v[192:193] op_sel_hi:[1,0]
    v_pk_mul_f32 v[78:79], v[78:79], v[192:193] op_sel_hi:[1,0]
    v_cvt_pk_bf16_f32 v180, v72, v73
    v_cvt_pk_bf16_f32 v181, v74, v75
    v_cvt_pk_bf16_f32 v182, v76, v77
    v_cvt_pk_bf16_f32 v183, v78, v79
    buffer_store_dwordx4 v[180:183], v246, s[24:27], s46 offen offset:3072 sc1
    v_lshlrev_b32 v8, 4, v0
    v_add_u32 v8, 0x25000, v8
    ds_write_b128 v8, v[230:233]
    v_lshlrev_b32 v6, 4, v4
    v_add_u32 v226, 65536, v224
    v_add_u32 v227, 65536, v225
    s_lshl_b32 s94, s60, 6
    s_add_u32 s94, s94, 2658304
    s_waitcnt vmcnt(28)
    ds_read_b128 a[32:35], v224 offset:0
    ds_read_b128 a[36:39], v225 offset:1024
    ds_read_b128 a[40:43], v224 offset:2048
    ds_read_b128 a[44:47], v225 offset:3072
    ds_read_b128 a[48:51], v226 offset:0
    ds_read_b128 a[52:55], v227 offset:1024
    ds_read_b128 a[56:59], v226 offset:2048
    ds_read_b128 a[60:63], v227 offset:3072
    ds_read_b128 a[64:67], v224 offset:16384
    ds_read_b128 a[68:71], v225 offset:17408
    ds_read_b128 a[72:75], v224 offset:18432
    ds_read_b128 a[76:79], v225 offset:19456
    ds_read_b128 a[80:83], v226 offset:16384
    ds_read_b128 a[84:87], v227 offset:17408
    ds_read_b128 a[88:91], v226 offset:18432
    ds_read_b128 a[92:95], v227 offset:19456
    ds_read_b128 a[96:99], v224 offset:32768
    ds_read_b128 a[100:103], v225 offset:33792
    ds_read_b128 a[104:107], v224 offset:34816
    ds_read_b128 a[108:111], v225 offset:35840
    ds_read_b128 a[112:115], v226 offset:32768
    ds_read_b128 a[116:119], v227 offset:33792
    ds_read_b128 a[120:123], v226 offset:34816
    ds_read_b128 a[124:127], v227 offset:35840
    s_bfe_u32 s38, s2, 0x20003
    s_and_b32 s39, s2, 1
    s_lshl_b32 s39, s39, 2
    s_add_u32 s56, s39, s38
    s_bfe_u32 s39, s2, 0x20001
    s_lshl_b32 s39, s39, 3
    s_lshr_b32 s37, s2, 5
    s_add_u32 s57, s39, s37
    s_and_b32 s39, s2, 3
    s_lshl_b32 s39, s39, 2
    s_add_u32 s58, s39, s38
    s_bfe_u32 s39, s2, 0x10002
    s_lshl_b32 s39, s39, 3
    s_add_u32 s59, s39, s37
    s_and_b32 s95, s38, 1
    s_cselect_b32 s96, 0, 4
    v_mul_u32_u24 v7, 16384, v2
    v_add_u32 v7, v7, v5
    v_add_u32 v8, 0, v2
    v_and_b32 v8, 3, v8
    v_mul_u32_u24 v8, 131072, v8
    v_add_u32 v10, v8, v7
    v_add_u32 v8, 1, v2
    v_and_b32 v8, 3, v8
    v_mul_u32_u24 v8, 131072, v8
    v_add_u32 v11, v8, v7
    v_add_u32 v8, 2, v2
    v_and_b32 v8, 3, v8
    v_mul_u32_u24 v8, 131072, v8
    v_add_u32 v12, v8, v7
    v_add_u32 v8, 3, v2
    v_and_b32 v8, 3, v8
    v_mul_u32_u24 v8, 131072, v8
    v_add_u32 v13, v8, v7
    s_and_b32 s39, s57, 62
    s_mul_i32 s39, s39, 524288
    s_add_u32 s38, s39, 16777216
    s_add_u32 s8, s42, s38
    s_addc_u32 s9, s43, 0
    s_sub_u32 s10, 16777216, s39
    s_mov_b32 s11, 0x20000
    s_and_b32 s38, s57, 1
    s_lshl_b32 s39, s38, 16
    s_lshl_b32 s38, s38, 19
    s_add_u32 s48, s38, s39
    s_xor_b32 s44, s48, 0x80000
    s_add_u32 s45, s44, 4096
    s_add_u32 s49, s48, 4096
    s_add_u32 s46, s44, 8192
    s_add_u32 s50, s48, 8192
    s_add_u32 s47, s44, 12288
    s_add_u32 s51, s48, 12288
    s_lshr_b32 s36, s2, 5
    s_lshl_b32 s36, s36, 2
    s_add_u32 s36, s36, s28
    s_lshl_b32 s36, s36, 5
    s_and_b32 s38, s2, 7
    s_lshl_b32 s38, s38, 2
    s_add_u32 s36, s36, s38
    s_bfe_u32 s38, s2, 0x20003
    s_add_u32 s36, s36, s38
    s_lshl_b32 s36, s36, 7
    s_add_u32 s36, s36, 48496640
    s_mul_i32 s39, s56, 320
    s_add_u32 s62, s39, 2634240
    s_and_b32 s38, s28, 1
    s_mul_i32 s60, s38, 5120
    s_add_u32 s60, s60, s39
    s_add_u32 s60, s60, 2626560
    s_lshl_b32 s61, s38, 10
    v_lshl_add_u32 v8, v2, 4, v3
    v_mul_u32_u24 v8, 1280, v8
    v_lshl_add_u32 v250, v4, 3, v8
    s_mul_i32 s63, s57, 81920
    s_mul_i32 s39, s56, 160
    s_add_u32 s63, s63, s39
    s_lshl_b32 s39, s96, 5
    s_add_u32 s101, s63, s39
    s_lshl_b32 s39, s95, 5
    s_add_u32 s63, s63, s39
    s_mov_b32 s90, 48250880
    s_mov_b32 s91, 48251904
    s_mov_b32 s92, 48252928
    s_mov_b32 s93, 48253952
    s_load_dwordx2 s[4:5], s[0:1], 88
    v_mov_b32 v8, s3
    v_and_b32 v9, 31, v1
    v_lshlrev_b32 v9, 2, v9
    s_waitcnt vmcnt(0)
    buffer_store_dword v8, v9, s[52:55], s36 offen sc1
    s_add_u32 s41, s7, 12288
    buffer_load_dwordx4 a[176:179], v252, s[52:55], s41 offen offset:0 sc1
    buffer_load_dwordx4 a[180:183], v252, s[52:55], s41 offen offset:1024 sc1
    buffer_load_dwordx4 a[184:187], v252, s[52:55], s41 offen offset:2048 sc1
    buffer_load_dwordx4 a[188:191], v252, s[52:55], s41 offen offset:3072 sc1
    s_add_u32 s40, s7, 16384
    buffer_load_dwordx4 a[192:195], v252, s[52:55], s40 offen offset:0 sc1
    buffer_load_dwordx4 a[196:199], v252, s[52:55], s40 offen offset:1024 sc1
    buffer_load_dwordx4 a[200:203], v252, s[52:55], s40 offen offset:2048 sc1
    buffer_load_dwordx4 a[204:207], v252, s[52:55], s40 offen offset:3072 sc1
    s_waitcnt lgkmcnt(0)
    s_barrier
    v_add_u32 v8, 0x25000, v5
    ds_read_b128 v[208:211], v8 offset:0
    ds_read_b128 v[212:215], v8 offset:1024
    ds_read_b128 v[216:219], v8 offset:2048
    ds_read_b128 v[220:223], v8 offset:3072
    s_add_u32 s41, s7, 20480
    buffer_load_dwordx4 a[208:211], v252, s[52:55], s41 offen offset:0 sc1
    buffer_load_dwordx4 a[212:215], v252, s[52:55], s41 offen offset:1024 sc1
    buffer_load_dwordx4 a[216:219], v252, s[52:55], s41 offen offset:2048 sc1
    buffer_load_dwordx4 a[220:223], v252, s[52:55], s41 offen offset:3072 sc1
    s_add_u32 s40, s7, 24576
    buffer_load_dwordx4 a[224:227], v252, s[52:55], s40 offen offset:0 sc1
    buffer_load_dwordx4 a[228:231], v252, s[52:55], s40 offen offset:1024 sc1
    buffer_load_dwordx4 a[232:235], v252, s[52:55], s40 offen offset:2048 sc1
    buffer_load_dwordx4 a[236:239], v252, s[52:55], s40 offen offset:3072 sc1
    v_mul_u32_u24 v8, 13824, v3
    v_add_u32 v8, v8, v6
    v_and_b32 v9, 0xce, v0
    v_cmp_eq_u32 vcc, 0, v9
    v_mov_b32 v9, 67108864
    s_nop 0
    v_cndmask_b32 v8, v9, v8, vcc
    s_waitcnt lgkmcnt(0)
    v_pk_add_f32 v[208:209], v[208:209], v[212:213]
    v_pk_add_f32 v[216:217], v[216:217], v[220:221]
    v_pk_add_f32 v[210:211], v[210:211], v[214:215]
    v_pk_add_f32 v[218:219], v[218:219], v[222:223]
    v_pk_add_f32 v[208:209], v[208:209], v[216:217]
    v_pk_add_f32 v[210:211], v[210:211], v[218:219]
    buffer_store_dwordx4 v[208:211], v8, s[52:55], s94 offen sc1
    v_and_b32 v7, 3, v1
    v_bfe_u32 v8, v1, 2, 1
    v_lshl_add_u32 v7, v8, 5, v7
    v_lshlrev_b32 v7, 7, v7
    s_and_b32 s36, s57, 62
    s_lshl_b32 s36, s36, 3
    s_and_b32 s38, s57, 1
    s_lshl_b32 s38, s38, 2
    s_add_u32 s36, s36, s38
    s_add_u32 s36, s36, s28
    s_lshl_b32 s36, s36, 9
    s_add_u32 s36, s36, 48496640
    s_add_u32 m0, s61, 86016
    v_lshlrev_b32 v253, 2, v1
    buffer_load_dword v253, s[52:55], s60 offen sc1 lds
    buffer_load_dword v253, s[52:55], s60 offen offset:256 sc1 lds
    s_add_u32 s41, s7, 28672
    buffer_load_dwordx4 a[240:243], v252, s[52:55], s41 offen offset:0 sc1
    buffer_load_dwordx4 a[244:247], v252, s[52:55], s41 offen offset:1024 sc1
    buffer_load_dwordx4 a[248:251], v252, s[52:55], s41 offen offset:2048 sc1
    buffer_load_dwordx4 a[252:255], v252, s[52:55], s41 offen offset:3072 sc1
    s_add_u32 s40, s7, 32768
    buffer_load_dwordx4 v[80:83], v252, s[52:55], s40 offen offset:0 sc1
    buffer_load_dwordx4 v[84:87], v252, s[52:55], s40 offen offset:1024 sc1
    buffer_load_dwordx4 v[88:91], v252, s[52:55], s40 offen offset:2048 sc1
    buffer_load_dwordx4 v[92:95], v252, s[52:55], s40 offen offset:3072 sc1
    s_add_u32 s41, s7, 36864
    buffer_load_dwordx4 v[96:99], v252, s[52:55], s41 offen offset:0 sc1
    buffer_load_dwordx4 v[100:103], v252, s[52:55], s41 offen offset:1024 sc1
    buffer_load_dwordx4 v[104:107], v252, s[52:55], s41 offen offset:2048 sc1
    buffer_load_dwordx4 v[108:111], v252, s[52:55], s41 offen offset:3072 sc1
    s_add_u32 s40, s7, 40960
    buffer_load_dwordx4 v[112:115], v252, s[52:55], s40 offen offset:0 sc1
    buffer_load_dwordx4 v[116:119], v252, s[52:55], s40 offen offset:1024 sc1
    buffer_load_dwordx4 v[120:123], v252, s[52:55], s40 offen offset:2048 sc1
    buffer_load_dwordx4 v[124:127], v252, s[52:55], s40 offen offset:3072 sc1
    buffer_load_dword v14, v7, s[52:55], s36 offen sc1
    s_add_u32 s41, s7, 45056
    buffer_load_dwordx4 v[128:131], v252, s[52:55], s41 offen offset:0 sc1
    buffer_load_dwordx4 v[132:135], v252, s[52:55], s41 offen offset:1024 sc1
    buffer_load_dwordx4 v[136:139], v252, s[52:55], s41 offen offset:2048 sc1
    buffer_load_dwordx4 v[140:143], v252, s[52:55], s41 offen offset:3072 sc1
    s_add_u32 s40, s7, 49152
    buffer_load_dwordx4 a[0:3], v252, s[52:55], s40 offen offset:0 sc1
    buffer_load_dwordx4 a[4:7], v252, s[52:55], s40 offen offset:1024 sc1
    buffer_load_dwordx4 a[8:11], v252, s[52:55], s40 offen offset:2048 sc1
    buffer_load_dwordx4 a[12:15], v252, s[52:55], s40 offen offset:3072 sc1
    s_add_u32 s41, s7, 53248
    buffer_load_dwordx4 a[16:19], v252, s[52:55], s41 offen offset:0 sc1
    buffer_load_dwordx4 a[20:23], v252, s[52:55], s41 offen offset:1024 sc1
    buffer_load_dwordx4 a[24:27], v252, s[52:55], s41 offen offset:2048 sc1
    buffer_load_dwordx4 a[28:31], v252, s[52:55], s41 offen offset:3072 sc1
    s_waitcnt vmcnt(12)
    v_cmp_ne_u32 vcc, s3, v14
    s_nop 1
    s_cbranch_vccz Lp1_ok
    s_mov_b32 s33, 0
Lp1:
    buffer_load_dword v14, v7, s[52:55], s36 offen sc1
    s_add_u32 s33, s33, 1
    s_waitcnt vmcnt(0)
    v_cmp_ne_u32 vcc, s3, v14
    s_nop 1
    s_cbranch_vccz Lp1_ok
    s_cmp_gt_u32 s33, 0x10000
    s_cbranch_scc1 Lp1_ok
    s_branch Lp1
Lp1_ok:
    s_lshl_b32 s36, s2, 4
    s_add_u32 s36, s36, 48250880
    s_cmp_eq_u32 s28, 0
    s_cselect_b32 s36, s36, 67108864
    v_mov_b32 v8, s3
    v_mov_b32 v9, 0
    buffer_store_dword v8, v9, s[52:55], s36 offen sc1
    s_getpc_b64 s[16:17]
Lpc2:
    s_add_u32 s16, s16, Lp2e-Lpc2
    s_addc_u32 s17, s17, 0
    s_mov_b32 s18, Lwarm_end-Lp2e
    s_mov_b32 s19, 0x20000
    v_lshlrev_b32 v232, 7, v0
    s_andn2_b32 s16, s16, 127
    buffer_load_dwordx4 v[16:19], v11, s[8:11], s44 offen offset:0 sc1
    buffer_load_dwordx4 v[20:23], v11, s[8:11], s44 offen offset:1024 sc1
    buffer_load_dwordx4 v[24:27], v11, s[8:11], s44 offen offset:2048 sc1
    buffer_load_dwordx4 v[28:31], v11, s[8:11], s44 offen offset:3072 sc1
    buffer_load_dwordx4 v[32:35], v11, s[8:11], s45 offen offset:0 sc1
    buffer_load_dwordx4 v[36:39], v11, s[8:11], s45 offen offset:1024 sc1
    buffer_load_dwordx4 v[40:43], v11, s[8:11], s45 offen offset:2048 sc1
    buffer_load_dwordx4 v[44:47], v11, s[8:11], s45 offen offset:3072 sc1
    buffer_load_dwordx4 v[48:51], v11, s[8:11], s46 offen offset:0 sc1
    buffer_load_dwordx4 v[52:55], v11, s[8:11], s46 offen offset:1024 sc1
    buffer_load_dwordx4 v[56:59], v11, s[8:11], s46 offen offset:2048 sc1
    buffer_load_dwordx4 v[60:63], v11, s[8:11], s46 offen offset:3072 sc1
    s_waitcnt vmcnt(8)
    v_mfma_f32_16x16x32_bf16 v[144:147], a[128:131], v[16:19], 0
    v_mfma_f32_16x16x32_bf16 v[144:147], a[148:151], v[20:23], v[144:147]
    buffer_load_dwordx4 v[64:67], v11, s[8:11], s47 offen offset:0 sc1
    v_mfma_f32_16x16x32_bf16 v[144:147], a[168:171], v[24:27], v[144:147]
    v_add_u32 v7, 1, v2
    v_mfma_f32_16x16x32_bf16 v[144:147], a[188:191], v[28:31], v[144:147]
    v_and_b32 v7, 3, v7
    v_mfma_f32_16x16x32_bf16 v[148:151], a[132:135], v[16:19], 0
    v_mul_u32_u24 v7, 15360, v7
    v_mfma_f32_16x16x32_bf16 v[148:151], a[152:155], v[20:23], v[148:151]
    v_add_u32 v7, v7, v5
    v_mfma_f32_16x16x32_bf16 v[148:151], a[172:175], v[24:27], v[148:151]
    buffer_load_dwordx4 v[68:71], v11, s[8:11], s47 offen offset:1024 sc1
    v_mfma_f32_16x16x32_bf16 v[148:151], a[192:195], v[28:31], v[148:151]
    v_add_u32 v245, 0, v7
    v_mfma_f32_16x16x32_bf16 v[152:155], a[136:139], v[16:19], 0
    v_add_u32 v7, 2, v2
    v_mfma_f32_16x16x32_bf16 v[152:155], a[156:159], v[20:23], v[152:155]
    v_and_b32 v7, 3, v7
    v_mfma_f32_16x16x32_bf16 v[152:155], a[176:179], v[24:27], v[152:155]
    v_mul_u32_u24 v7, 15360, v7
    v_mfma_f32_16x16x32_bf16 v[152:155], a[196:199], v[28:31], v[152:155]
    buffer_load_dwordx4 v[72:75], v11, s[8:11], s47 offen offset:2048 sc1
    v_mfma_f32_16x16x32_bf16 v[156:159], a[140:143], v[16:19], 0
    v_add_u32 v7, v7, v5
    v_mfma_f32_16x16x32_bf16 v[156:159], a[160:163], v[20:23], v[156:159]
    v_add_u32 v246, 5120, v7
    v_mfma_f32_16x16x32_bf16 v[156:159], a[180:183], v[24:27], v[156:159]
    v_add_u32 v7, 3, v2
    v_mfma_f32_16x16x32_bf16 v[156:159], a[200:203], v[28:31], v[156:159]
    v_and_b32 v7, 3, v7
    v_mfma_f32_16x16x32_bf16 v[160:163], a[144:147], v[16:19], 0
    buffer_load_dwordx4 v[76:79], v11, s[8:11], s47 offen offset:3072 sc1
    v_mfma_f32_16x16x32_bf16 v[160:163], a[164:167], v[20:23], v[160:163]
    v_mul_u32_u24 v7, 15360, v7
    v_mfma_f32_16x16x32_bf16 v[160:163], a[184:187], v[24:27], v[160:163]
    v_add_u32 v7, v7, v5
    v_mfma_f32_16x16x32_bf16 v[160:163], a[204:207], v[28:31], v[160:163]
    s_waitcnt vmcnt(8)
    v_add_u32 v247, 10240, v7
    v_mfma_f32_16x16x32_bf16 v[144:147], a[208:211], v[32:35], v[144:147]
    v_add_u32 v7, 0, v2
    v_mfma_f32_16x16x32_bf16 v[144:147], a[228:231], v[36:39], v[144:147]
    buffer_load_dwordx4 v[16:19], v12, s[8:11], s44 offen offset:0 sc1
    v_mfma_f32_16x16x32_bf16 v[144:147], a[248:251], v[40:43], v[144:147]
    v_and_b32 v7, 3, v7
    v_mfma_f32_16x16x32_bf16 v[144:147], v[92:95], v[44:47], v[144:147]
    v_mul_u32_u24 v7, 15360, v7
    v_mfma_f32_16x16x32_bf16 v[148:151], a[212:215], v[32:35], v[148:151]
    v_add_u32 v7, v7, v5
    v_mfma_f32_16x16x32_bf16 v[148:151], a[232:235], v[36:39], v[148:151]
    v_add_u32 v244, 0, v7
    v_mfma_f32_16x16x32_bf16 v[148:151], a[252:255], v[40:43], v[148:151]
    buffer_load_dwordx4 v[20:23], v12, s[8:11], s44 offen offset:1024 sc1
    v_mfma_f32_16x16x32_bf16 v[148:151], v[96:99], v[44:47], v[148:151]
    v_add_u32 v15, 4096, v5
    v_mfma_f32_16x16x32_bf16 v[152:155], a[216:219], v[32:35], v[152:155]
    v_mov_b32 v8, s3
    v_mfma_f32_16x16x32_bf16 v[152:155], a[236:239], v[36:39], v[152:155]
    v_and_b32 v9, 31, v1
    v_mfma_f32_16x16x32_bf16 v[152:155], v[80:83], v[40:43], v[152:155]
    v_lshlrev_b32 v9, 2, v9
    v_mfma_f32_16x16x32_bf16 v[152:155], v[100:103], v[44:47], v[152:155]
    s_lshl_b32 s23, s57, 3
    buffer_load_dwordx4 v[24:27], v12, s[8:11], s44 offen offset:2048 sc1
    v_mfma_f32_16x16x32_bf16 v[156:159], a[220:223], v[32:35], v[156:159]
    s_add_u32 s23, s23, s56
    v_mfma_f32_16x16x32_bf16 v[156:159], a[240:243], v[36:39], v[156:159]
    s_lshl_b32 s23, s23, 2
    v_mfma_f32_16x16x32_bf16 v[156:159], v[84:87], v[40:43], v[156:159]
    s_add_u32 s23, s23, s28
    v_mfma_f32_16x16x32_bf16 v[156:159], v[104:107], v[44:47], v[156:159]
    s_xor_b32 s21, s23, 32
    v_mfma_f32_16x16x32_bf16 v[160:163], a[224:227], v[32:35], v[160:163]
    s_mul_i32 s20, s21, 5120
    buffer_load_dwordx4 v[28:31], v12, s[8:11], s44 offen offset:3072 sc1
    v_mfma_f32_16x16x32_bf16 v[160:163], a[244:247], v[36:39], v[160:163]
    s_mul_i32 s22, s23, 5120
    v_mfma_f32_16x16x32_bf16 v[160:163], v[88:91], v[40:43], v[160:163]
    s_add_u32 s20, s20, 51380224
    v_mfma_f32_16x16x32_bf16 v[160:163], v[108:111], v[44:47], v[160:163]
    s_waitcnt vmcnt(8)
    v_mfma_f32_16x16x32_bf16 v[144:147], v[112:115], v[48:51], v[144:147]
    s_add_u32 s22, s22, 51380224
    v_mfma_f32_16x16x32_bf16 v[144:147], v[132:135], v[52:55], v[144:147]
    s_lshl_b32 s21, s21, 7
    buffer_load_dwordx4 v[32:35], v12, s[8:11], s45 offen offset:0 sc1
    v_mfma_f32_16x16x32_bf16 v[144:147], a[8:11], v[56:59], v[144:147]
    s_lshl_b32 s23, s23, 7
    v_mfma_f32_16x16x32_bf16 v[144:147], a[28:31], v[60:63], v[144:147]
    s_add_u32 s21, s21, 49152000
    v_mfma_f32_16x16x32_bf16 v[148:151], v[116:119], v[48:51], v[148:151]
    s_add_u32 s23, s23, 49152000
    v_mfma_f32_16x16x32_bf16 v[148:151], v[136:139], v[52:55], v[148:151]
    s_lshl_b32 s39, s95, 6
    v_mfma_f32_16x16x32_bf16 v[148:151], a[12:15], v[56:59], v[148:151]
    s_add_u32 s39, s39, 86016
    buffer_load_dwordx4 v[36:39], v12, s[8:11], s45 offen offset:1024 sc1
    v_mfma_f32_16x16x32_bf16 v[148:151], a[32:35], v[60:63], v[148:151]
    v_add_u32 v254, s39, v6
    v_mfma_f32_16x16x32_bf16 v[152:155], v[120:123], v[48:51], v[152:155]
    s_lshl_b32 s39, s96, 6
    v_mfma_f32_16x16x32_bf16 v[152:155], v[140:143], v[52:55], v[152:155]
    s_add_u32 s39, s39, 86016
    v_mfma_f32_16x16x32_bf16 v[152:155], a[16:19], v[56:59], v[152:155]
    v_add_u32 v255, s39, v6
    v_mfma_f32_16x16x32_bf16 v[152:155], a[36:39], v[60:63], v[152:155]
    buffer_load_dwordx4 v[40:43], v12, s[8:11], s45 offen offset:2048 sc1
    v_mfma_f32_16x16x32_bf16 v[156:159], v[124:127], v[48:51], v[156:159]
    v_mul_u32_u24 v7, 7168, v2
    v_mfma_f32_16x16x32_bf16 v[156:159], a[0:3], v[52:55], v[156:159]
    v_add_u32 v248, v7, v5
    v_mfma_f32_16x16x32_bf16 v[156:159], a[20:23], v[56:59], v[156:159]
    v_add_u32 v249, 4096, v248
    v_mfma_f32_16x16x32_bf16 v[156:159], a[40:43], v[60:63], v[156:159]
    s_mul_i32 s37, s28, 7168
    v_mfma_f32_16x16x32_bf16 v[160:163], v[128:131], v[48:51], v[160:163]
    s_mul_i32 s39, s58, 286720
    buffer_load_dwordx4 v[44:47], v12, s[8:11], s45 offen offset:3072 sc1
    v_mfma_f32_16x16x32_bf16 v[160:163], a[4:7], v[52:55], v[160:163]
    s_add_u32 s39, s39, 42991616
    v_mfma_f32_16x16x32_bf16 v[160:163], a[24:27], v[56:59], v[160:163]
    s_add_u32 s12, s42, s39
    s_addc_u32 s13, s43, 0
    v_mfma_f32_16x16x32_bf16 v[160:163], a[44:47], v[60:63], v[160:163]
    s_waitcnt vmcnt(8)
    v_mfma_f32_16x16x32_bf16 v[144:147], a[48:51], v[64:67], v[144:147]
    s_mov_b32 s14, 286720
    v_mfma_f32_16x16x32_bf16 v[144:147], a[68:71], v[68:71], v[144:147]
    s_mov_b32 s15, 0x20000
    buffer_load_dwordx4 v[48:51], v12, s[8:11], s46 offen offset:0 sc1
    v_mfma_f32_16x16x32_bf16 v[144:147], a[88:91], v[72:75], v[144:147]
    v_mfma_f32_16x16x32_bf16 v[144:147], a[108:111], v[76:79], v[144:147]
    v_mfma_f32_16x16x32_bf16 v[148:151], a[52:55], v[64:67], v[148:151]
    v_mfma_f32_16x16x32_bf16 v[148:151], a[72:75], v[68:71], v[148:151]
    v_mfma_f32_16x16x32_bf16 v[148:151], a[92:95], v[72:75], v[148:151]
    buffer_load_dwordx4 v[52:55], v12, s[8:11], s46 offen offset:1024 sc1
    v_mfma_f32_16x16x32_bf16 v[148:151], a[112:115], v[76:79], v[148:151]
    v_mfma_f32_16x16x32_bf16 v[152:155], a[56:59], v[64:67], v[152:155]
    v_mfma_f32_16x16x32_bf16 v[152:155], a[76:79], v[68:71], v[152:155]
    s_nop 0
    ds_write_b128 v245, v[144:147] offset:0
    v_mfma_f32_16x16x32_bf16 v[152:155], a[96:99], v[72:75], v[152:155]
    v_mfma_f32_16x16x32_bf16 v[152:155], a[116:119], v[76:79], v[152:155]
    buffer_load_dwordx4 v[56:59], v12, s[8:11], s46 offen offset:2048 sc1
    v_mfma_f32_16x16x32_bf16 v[156:159], a[60:63], v[64:67], v[156:159]
    v_mfma_f32_16x16x32_bf16 v[156:159], a[80:83], v[68:71], v[156:159]
    ds_write_b128 v245, v[148:151] offset:1024
    v_mfma_f32_16x16x32_bf16 v[156:159], a[100:103], v[72:75], v[156:159]
    v_mfma_f32_16x16x32_bf16 v[156:159], a[120:123], v[76:79], v[156:159]
    v_mfma_f32_16x16x32_bf16 v[160:163], a[64:67], v[64:67], v[160:163]
    buffer_load_dwordx4 v[60:63], v12, s[8:11], s46 offen offset:3072 sc1
    v_mfma_f32_16x16x32_bf16 v[160:163], a[84:87], v[68:71], v[160:163]
    ds_write_b128 v245, v[152:155] offset:2048
    v_mfma_f32_16x16x32_bf16 v[160:163], a[104:107], v[72:75], v[160:163]
    v_mfma_f32_16x16x32_bf16 v[160:163], a[124:127], v[76:79], v[160:163]
    s_waitcnt vmcnt(8)
    v_mfma_f32_16x16x32_bf16 v[164:167], a[128:131], v[16:19], 0
    v_mfma_f32_16x16x32_bf16 v[164:167], a[148:151], v[20:23], v[164:167]
    buffer_load_dwordx4 v[64:67], v12, s[8:11], s47 offen offset:0 sc1
    v_mfma_f32_16x16x32_bf16 v[164:167], a[168:171], v[24:27], v[164:167]
    ds_write_b128 v245, v[156:159] offset:3072
    v_mfma_f32_16x16x32_bf16 v[164:167], a[188:191], v[28:31], v[164:167]
    v_mfma_f32_16x16x32_bf16 v[168:171], a[132:135], v[16:19], 0
    v_mfma_f32_16x16x32_bf16 v[168:171], a[152:155], v[20:23], v[168:171]
    ds_write_b128 v245, v[160:163] offset:4096
    v_mfma_f32_16x16x32_bf16 v[168:171], a[172:175], v[24:27], v[168:171]
    buffer_load_dwordx4 v[68:71], v12, s[8:11], s47 offen offset:1024 sc1
    v_mfma_f32_16x16x32_bf16 v[168:171], a[192:195], v[28:31], v[168:171]
    v_mfma_f32_16x16x32_bf16 v[172:175], a[136:139], v[16:19], 0
    v_mfma_f32_16x16x32_bf16 v[172:175], a[156:159], v[20:23], v[172:175]
    v_mfma_f32_16x16x32_bf16 v[172:175], a[176:179], v[24:27], v[172:175]
    v_mfma_f32_16x16x32_bf16 v[172:175], a[196:199], v[28:31], v[172:175]
    buffer_load_dwordx4 v[72:75], v12, s[8:11], s47 offen offset:2048 sc1
    v_mfma_f32_16x16x32_bf16 v[176:179], a[140:143], v[16:19], 0
    v_mfma_f32_16x16x32_bf16 v[176:179], a[160:163], v[20:23], v[176:179]
    v_mfma_f32_16x16x32_bf16 v[176:179], a[180:183], v[24:27], v[176:179]
    v_mfma_f32_16x16x32_bf16 v[176:179], a[200:203], v[28:31], v[176:179]
    v_mfma_f32_16x16x32_bf16 v[180:183], a[144:147], v[16:19], 0
    buffer_load_dwordx4 v[76:79], v12, s[8:11], s47 offen offset:3072 sc1
    v_mfma_f32_16x16x32_bf16 v[180:183], a[164:167], v[20:23], v[180:183]
    v_mfma_f32_16x16x32_bf16 v[180:183], a[184:187], v[24:27], v[180:183]
    v_mfma_f32_16x16x32_bf16 v[180:183], a[204:207], v[28:31], v[180:183]
    s_waitcnt vmcnt(8)
    v_mfma_f32_16x16x32_bf16 v[164:167], a[208:211], v[32:35], v[164:167]
    v_mfma_f32_16x16x32_bf16 v[164:167], a[228:231], v[36:39], v[164:167]
    buffer_load_dwordx4 v[16:19], v13, s[8:11], s44 offen offset:0 sc1
    v_mfma_f32_16x16x32_bf16 v[164:167], a[248:251], v[40:43], v[164:167]
    v_mfma_f32_16x16x32_bf16 v[164:167], v[92:95], v[44:47], v[164:167]
    v_mfma_f32_16x16x32_bf16 v[168:171], a[212:215], v[32:35], v[168:171]
    v_mfma_f32_16x16x32_bf16 v[168:171], a[232:235], v[36:39], v[168:171]
    v_mfma_f32_16x16x32_bf16 v[168:171], a[252:255], v[40:43], v[168:171]
    buffer_load_dwordx4 v[20:23], v13, s[8:11], s44 offen offset:1024 sc1
    v_mfma_f32_16x16x32_bf16 v[168:171], v[96:99], v[44:47], v[168:171]
    v_mfma_f32_16x16x32_bf16 v[172:175], a[216:219], v[32:35], v[172:175]
    v_mfma_f32_16x16x32_bf16 v[172:175], a[236:239], v[36:39], v[172:175]
    v_mfma_f32_16x16x32_bf16 v[172:175], v[80:83], v[40:43], v[172:175]
    v_mfma_f32_16x16x32_bf16 v[172:175], v[100:103], v[44:47], v[172:175]
    buffer_load_dwordx4 v[24:27], v13, s[8:11], s44 offen offset:2048 sc1
    v_mfma_f32_16x16x32_bf16 v[176:179], a[220:223], v[32:35], v[176:179]
    v_mfma_f32_16x16x32_bf16 v[176:179], a[240:243], v[36:39], v[176:179]
    v_mfma_f32_16x16x32_bf16 v[176:179], v[84:87], v[40:43], v[176:179]
    v_mfma_f32_16x16x32_bf16 v[176:179], v[104:107], v[44:47], v[176:179]
    v_mfma_f32_16x16x32_bf16 v[180:183], a[224:227], v[32:35], v[180:183]
    buffer_load_dwordx4 v[28:31], v13, s[8:11], s44 offen offset:3072 sc1
    v_mfma_f32_16x16x32_bf16 v[180:183], a[244:247], v[36:39], v[180:183]
    v_mfma_f32_16x16x32_bf16 v[180:183], v[88:91], v[40:43], v[180:183]
    v_mfma_f32_16x16x32_bf16 v[180:183], v[108:111], v[44:47], v[180:183]
    s_waitcnt vmcnt(8)
    v_mfma_f32_16x16x32_bf16 v[164:167], v[112:115], v[48:51], v[164:167]
    v_mfma_f32_16x16x32_bf16 v[164:167], v[132:135], v[52:55], v[164:167]
    buffer_load_dwordx4 v[32:35], v13, s[8:11], s45 offen offset:0 sc1
    v_mfma_f32_16x16x32_bf16 v[164:167], a[8:11], v[56:59], v[164:167]
    v_mfma_f32_16x16x32_bf16 v[164:167], a[28:31], v[60:63], v[164:167]
    v_mfma_f32_16x16x32_bf16 v[168:171], v[116:119], v[48:51], v[168:171]
    v_mfma_f32_16x16x32_bf16 v[168:171], v[136:139], v[52:55], v[168:171]
    v_mfma_f32_16x16x32_bf16 v[168:171], a[12:15], v[56:59], v[168:171]
    buffer_load_dwordx4 v[36:39], v13, s[8:11], s45 offen offset:1024 sc1
    v_mfma_f32_16x16x32_bf16 v[168:171], a[32:35], v[60:63], v[168:171]
    v_mfma_f32_16x16x32_bf16 v[172:175], v[120:123], v[48:51], v[172:175]
    v_mfma_f32_16x16x32_bf16 v[172:175], v[140:143], v[52:55], v[172:175]
    v_mfma_f32_16x16x32_bf16 v[172:175], a[16:19], v[56:59], v[172:175]
    v_mfma_f32_16x16x32_bf16 v[172:175], a[36:39], v[60:63], v[172:175]
    buffer_load_dwordx4 v[40:43], v13, s[8:11], s45 offen offset:2048 sc1
    v_mfma_f32_16x16x32_bf16 v[176:179], v[124:127], v[48:51], v[176:179]
    v_mfma_f32_16x16x32_bf16 v[176:179], a[0:3], v[52:55], v[176:179]
    v_mfma_f32_16x16x32_bf16 v[176:179], a[20:23], v[56:59], v[176:179]
    v_mfma_f32_16x16x32_bf16 v[176:179], a[40:43], v[60:63], v[176:179]
    v_mfma_f32_16x16x32_bf16 v[180:183], v[128:131], v[48:51], v[180:183]
    buffer_load_dwordx4 v[44:47], v13, s[8:11], s45 offen offset:3072 sc1
    v_mfma_f32_16x16x32_bf16 v[180:183], a[4:7], v[52:55], v[180:183]
    v_mfma_f32_16x16x32_bf16 v[180:183], a[24:27], v[56:59], v[180:183]
    v_mfma_f32_16x16x32_bf16 v[180:183], a[44:47], v[60:63], v[180:183]
    s_waitcnt vmcnt(8)
    v_mfma_f32_16x16x32_bf16 v[164:167], a[48:51], v[64:67], v[164:167]
    v_mfma_f32_16x16x32_bf16 v[164:167], a[68:71], v[68:71], v[164:167]
    buffer_load_dwordx4 v[48:51], v13, s[8:11], s46 offen offset:0 sc1
    v_mfma_f32_16x16x32_bf16 v[164:167], a[88:91], v[72:75], v[164:167]
    v_mfma_f32_16x16x32_bf16 v[164:167], a[108:111], v[76:79], v[164:167]
    v_mfma_f32_16x16x32_bf16 v[168:171], a[52:55], v[64:67], v[168:171]
    v_mfma_f32_16x16x32_bf16 v[168:171], a[72:75], v[68:71], v[168:171]
    v_mfma_f32_16x16x32_bf16 v[168:171], a[92:95], v[72:75], v[168:171]
    buffer_load_dwordx4 v[52:55], v13, s[8:11], s46 offen offset:1024 sc1
    v_mfma_f32_16x16x32_bf16 v[168:171], a[112:115], v[76:79], v[168:171]
    v_mfma_f32_16x16x32_bf16 v[172:175], a[56:59], v[64:67], v[172:175]
    v_mfma_f32_16x16x32_bf16 v[172:175], a[76:79], v[68:71], v[172:175]
    s_nop 0
    ds_write_b128 v246, v[164:167] offset:0
    v_mfma_f32_16x16x32_bf16 v[172:175], a[96:99], v[72:75], v[172:175]
    v_mfma_f32_16x16x32_bf16 v[172:175], a[116:119], v[76:79], v[172:175]
    buffer_load_dwordx4 v[56:59], v13, s[8:11], s46 offen offset:2048 sc1
    v_mfma_f32_16x16x32_bf16 v[176:179], a[60:63], v[64:67], v[176:179]
    v_mfma_f32_16x16x32_bf16 v[176:179], a[80:83], v[68:71], v[176:179]
    ds_write_b128 v246, v[168:171] offset:1024
    v_mfma_f32_16x16x32_bf16 v[176:179], a[100:103], v[72:75], v[176:179]
    v_mfma_f32_16x16x32_bf16 v[176:179], a[120:123], v[76:79], v[176:179]
    v_mfma_f32_16x16x32_bf16 v[180:183], a[64:67], v[64:67], v[180:183]
    buffer_load_dwordx4 v[60:63], v13, s[8:11], s46 offen offset:3072 sc1
    v_mfma_f32_16x16x32_bf16 v[180:183], a[84:87], v[68:71], v[180:183]
    ds_write_b128 v246, v[172:175] offset:2048
    v_mfma_f32_16x16x32_bf16 v[180:183], a[104:107], v[72:75], v[180:183]
    v_mfma_f32_16x16x32_bf16 v[180:183], a[124:127], v[76:79], v[180:183]
    s_waitcnt vmcnt(8)
    v_mfma_f32_16x16x32_bf16 v[144:147], a[128:131], v[16:19], 0
    v_mfma_f32_16x16x32_bf16 v[144:147], a[148:151], v[20:23], v[144:147]
    buffer_load_dwordx4 v[64:67], v13, s[8:11], s47 offen offset:0 sc1
    v_mfma_f32_16x16x32_bf16 v[144:147], a[168:171], v[24:27], v[144:147]
    ds_write_b128 v246, v[176:179] offset:3072
    v_mfma_f32_16x16x32_bf16 v[144:147], a[188:191], v[28:31], v[144:147]
    v_mfma_f32_16x16x32_bf16 v[148:151], a[132:135], v[16:19], 0
    v_mfma_f32_16x16x32_bf16 v[148:151], a[152:155], v[20:23], v[148:151]
    ds_write_b128 v246, v[180:183] offset:4096
    v_mfma_f32_16x16x32_bf16 v[148:151], a[172:175], v[24:27], v[148:151]
    buffer_load_dwordx4 v[68:71], v13, s[8:11], s47 offen offset:1024 sc1
    v_mfma_f32_16x16x32_bf16 v[148:151], a[192:195], v[28:31], v[148:151]
    v_mfma_f32_16x16x32_bf16 v[152:155], a[136:139], v[16:19], 0
    v_mfma_f32_16x16x32_bf16 v[152:155], a[156:159], v[20:23], v[152:155]
    v_mfma_f32_16x16x32_bf16 v[152:155], a[176:179], v[24:27], v[152:155]
    v_mfma_f32_16x16x32_bf16 v[152:155], a[196:199], v[28:31], v[152:155]
    buffer_load_dwordx4 v[72:75], v13, s[8:11], s47 offen offset:2048 sc1
    v_mfma_f32_16x16x32_bf16 v[156:159], a[140:143], v[16:19], 0
    v_mfma_f32_16x16x32_bf16 v[156:159], a[160:163], v[20:23], v[156:159]
    v_mfma_f32_16x16x32_bf16 v[156:159], a[180:183], v[24:27], v[156:159]
    v_mfma_f32_16x16x32_bf16 v[156:159], a[200:203], v[28:31], v[156:159]
    v_mfma_f32_16x16x32_bf16 v[160:163], a[144:147], v[16:19], 0
    buffer_load_dwordx4 v[76:79], v13, s[8:11], s47 offen offset:3072 sc1
    v_mfma_f32_16x16x32_bf16 v[160:163], a[164:167], v[20:23], v[160:163]
    s_waitcnt lgkmcnt(0)
    s_barrier
    v_mfma_f32_16x16x32_bf16 v[160:163], a[184:187], v[24:27], v[160:163]
    v_mfma_f32_16x16x32_bf16 v[160:163], a[204:207], v[28:31], v[160:163]
    s_waitcnt vmcnt(8)
    v_mfma_f32_16x16x32_bf16 v[144:147], a[208:211], v[32:35], v[144:147]
    ds_read_b128 v[184:187], v244 offset:0
    v_mfma_f32_16x16x32_bf16 v[144:147], a[228:231], v[36:39], v[144:147]
    buffer_load_dwordx4 v[16:19], v10, s[8:11], s44 offen offset:0 sc1
    v_mfma_f32_16x16x32_bf16 v[144:147], a[248:251], v[40:43], v[144:147]
    ds_read_b128 v[188:191], v244 offset:1024
    v_mfma_f32_16x16x32_bf16 v[144:147], v[92:95], v[44:47], v[144:147]
    ds_read_b128 v[192:195], v244 offset:2048
    v_mfma_f32_16x16x32_bf16 v[148:151], a[212:215], v[32:35], v[148:151]
    ds_read_b128 v[196:199], v244 offset:3072
    v_mfma_f32_16x16x32_bf16 v[148:151], a[232:235], v[36:39], v[148:151]
    ds_read_b128 v[200:203], v244 offset:4096
    v_mfma_f32_16x16x32_bf16 v[148:151], a[252:255], v[40:43], v[148:151]
    buffer_load_dwordx4 v[20:23], v10, s[8:11], s44 offen offset:1024 sc1
    v_mfma_f32_16x16x32_bf16 v[148:151], v[96:99], v[44:47], v[148:151]
    ds_read_b128 v[204:207], v244 offset:5120
    v_mfma_f32_16x16x32_bf16 v[152:155], a[216:219], v[32:35], v[152:155]
    ds_read_b128 v[208:211], v244 offset:6144
    v_mfma_f32_16x16x32_bf16 v[152:155], a[236:239], v[36:39], v[152:155]
    ds_read_b128 v[212:215], v244 offset:7168
    v_mfma_f32_16x16x32_bf16 v[152:155], v[80:83], v[40:43], v[152:155]
    ds_read_b128 v[216:219], v244 offset:8192
    v_mfma_f32_16x16x32_bf16 v[152:155], v[100:103], v[44:47], v[152:155]
    ds_read_b128 v[220:223], v244 offset:9216
    buffer_load_dwordx4 v[24:27], v10, s[8:11], s44 offen offset:2048 sc1
    v_mfma_f32_16x16x32_bf16 v[156:159], a[220:223], v[32:35], v[156:159]
    v_mfma_f32_16x16x32_bf16 v[156:159], a[240:243], v[36:39], v[156:159]
    v_mfma_f32_16x16x32_bf16 v[156:159], v[84:87], v[40:43], v[156:159]
    v_mfma_f32_16x16x32_bf16 v[156:159], v[104:107], v[44:47], v[156:159]
    v_mfma_f32_16x16x32_bf16 v[160:163], a[224:227], v[32:35], v[160:163]
    buffer_load_dwordx4 v[28:31], v10, s[8:11], s44 offen offset:3072 sc1
    v_mfma_f32_16x16x32_bf16 v[160:163], a[244:247], v[36:39], v[160:163]
    v_mfma_f32_16x16x32_bf16 v[160:163], v[88:91], v[40:43], v[160:163]
    v_mfma_f32_16x16x32_bf16 v[160:163], v[108:111], v[44:47], v[160:163]
    s_waitcnt vmcnt(8) lgkmcnt(0)
    v_mfma_f32_16x16x32_bf16 v[144:147], v[112:115], v[48:51], v[144:147]
    v_add_f32 v184, v184, v204
    v_add_f32 v185, v185, v205
    v_mfma_f32_16x16x32_bf16 v[144:147], v[132:135], v[52:55], v[144:147]
    buffer_load_dwordx4 v[32:35], v10, s[8:11], s45 offen offset:0 sc1
    v_mfma_f32_16x16x32_bf16 v[144:147], a[8:11], v[56:59], v[144:147]
    v_add_f32 v186, v186, v206
    v_add_f32 v187, v187, v207
    v_mfma_f32_16x16x32_bf16 v[144:147], a[28:31], v[60:63], v[144:147]
    v_add_f32 v188, v188, v208
    v_add_f32 v189, v189, v209
    v_mfma_f32_16x16x32_bf16 v[148:151], v[116:119], v[48:51], v[148:151]
    v_add_f32 v190, v190, v210
    v_add_f32 v191, v191, v211
    v_mfma_f32_16x16x32_bf16 v[148:151], v[136:139], v[52:55], v[148:151]
    v_add_f32 v192, v192, v212
    v_add_f32 v193, v193, v213
    v_mfma_f32_16x16x32_bf16 v[148:151], a[12:15], v[56:59], v[148:151]
    buffer_load_dwordx4 v[36:39], v10, s[8:11], s45 offen offset:1024 sc1
    v_mfma_f32_16x16x32_bf16 v[148:151], a[32:35], v[60:63], v[148:151]
    v_add_f32 v194, v194, v214
    v_add_f32 v195, v195, v215
    v_mfma_f32_16x16x32_bf16 v[152:155], v[120:123], v[48:51], v[152:155]
    v_add_f32 v196, v196, v216
    v_add_f32 v197, v197, v217
    v_mfma_f32_16x16x32_bf16 v[152:155], v[140:143], v[52:55], v[152:155]
    v_add_f32 v198, v198, v218
    v_add_f32 v199, v199, v219
    v_mfma_f32_16x16x32_bf16 v[152:155], a[16:19], v[56:59], v[152:155]
    v_add_f32 v200, v200, v220
    v_add_f32 v201, v201, v221
    v_mfma_f32_16x16x32_bf16 v[152:155], a[36:39], v[60:63], v[152:155]
    buffer_load_dwordx4 v[40:43], v10, s[8:11], s45 offen offset:2048 sc1
    v_mfma_f32_16x16x32_bf16 v[156:159], v[124:127], v[48:51], v[156:159]
    v_add_f32 v202, v202, v222
    v_add_f32 v203, v203, v223
    v_mfma_f32_16x16x32_bf16 v[156:159], a[0:3], v[52:55], v[156:159]
    v_mfma_f32_16x16x32_bf16 v[156:159], a[20:23], v[56:59], v[156:159]
    v_mfma_f32_16x16x32_bf16 v[156:159], a[40:43], v[60:63], v[156:159]
    v_mfma_f32_16x16x32_bf16 v[160:163], v[128:131], v[48:51], v[160:163]
    buffer_load_dwordx4 v[44:47], v10, s[8:11], s45 offen offset:3072 sc1
    v_mfma_f32_16x16x32_bf16 v[160:163], a[4:7], v[52:55], v[160:163]
    v_mfma_f32_16x16x32_bf16 v[160:163], a[24:27], v[56:59], v[160:163]
    v_mfma_f32_16x16x32_bf16 v[160:163], a[44:47], v[60:63], v[160:163]
    s_waitcnt vmcnt(8)
    v_mfma_f32_16x16x32_bf16 v[144:147], a[48:51], v[64:67], v[144:147]
    v_mfma_f32_16x16x32_bf16 v[144:147], a[68:71], v[68:71], v[144:147]
    buffer_load_dwordx4 v[48:51], v10, s[8:11], s46 offen offset:0 sc1
    v_mfma_f32_16x16x32_bf16 v[144:147], a[88:91], v[72:75], v[144:147]
    v_mfma_f32_16x16x32_bf16 v[144:147], a[108:111], v[76:79], v[144:147]
    v_mfma_f32_16x16x32_bf16 v[148:151], a[52:55], v[64:67], v[148:151]
    v_mfma_f32_16x16x32_bf16 v[148:151], a[72:75], v[68:71], v[148:151]
    v_mfma_f32_16x16x32_bf16 v[148:151], a[92:95], v[72:75], v[148:151]
    buffer_load_dwordx4 v[52:55], v10, s[8:11], s46 offen offset:1024 sc1
    v_mfma_f32_16x16x32_bf16 v[148:151], a[112:115], v[76:79], v[148:151]
    v_mfma_f32_16x16x32_bf16 v[152:155], a[56:59], v[64:67], v[152:155]
    v_mfma_f32_16x16x32_bf16 v[152:155], a[76:79], v[68:71], v[152:155]
    s_nop 0
    ds_write_b128 v247, v[144:147] offset:0
    v_mfma_f32_16x16x32_bf16 v[152:155], a[96:99], v[72:75], v[152:155]
    v_mfma_f32_16x16x32_bf16 v[152:155], a[116:119], v[76:79], v[152:155]
    buffer_load_dwordx4 v[56:59], v10, s[8:11], s46 offen offset:2048 sc1
    v_mfma_f32_16x16x32_bf16 v[156:159], a[60:63], v[64:67], v[156:159]
    v_mfma_f32_16x16x32_bf16 v[156:159], a[80:83], v[68:71], v[156:159]
    ds_write_b128 v247, v[148:151] offset:1024
    v_mfma_f32_16x16x32_bf16 v[156:159], a[100:103], v[72:75], v[156:159]
    v_mfma_f32_16x16x32_bf16 v[156:159], a[120:123], v[76:79], v[156:159]
    v_mfma_f32_16x16x32_bf16 v[160:163], a[64:67], v[64:67], v[160:163]
    buffer_load_dwordx4 v[60:63], v10, s[8:11], s46 offen offset:3072 sc1
    v_mfma_f32_16x16x32_bf16 v[160:163], a[84:87], v[68:71], v[160:163]
    ds_write_b128 v247, v[152:155] offset:2048
    v_mfma_f32_16x16x32_bf16 v[160:163], a[104:107], v[72:75], v[160:163]
    v_mfma_f32_16x16x32_bf16 v[160:163], a[124:127], v[76:79], v[160:163]
    s_waitcnt vmcnt(8)
    v_mfma_f32_16x16x32_bf16 v[164:167], a[128:131], v[16:19], 0
    v_mfma_f32_16x16x32_bf16 v[164:167], a[148:151], v[20:23], v[164:167]
    buffer_load_dwordx4 v[64:67], v10, s[8:11], s47 offen offset:0 sc1
    v_mfma_f32_16x16x32_bf16 v[164:167], a[168:171], v[24:27], v[164:167]
    ds_write_b128 v247, v[156:159] offset:3072
    v_mfma_f32_16x16x32_bf16 v[164:167], a[188:191], v[28:31], v[164:167]
    v_mfma_f32_16x16x32_bf16 v[168:171], a[132:135], v[16:19], 0
    v_mfma_f32_16x16x32_bf16 v[168:171], a[152:155], v[20:23], v[168:171]
    ds_write_b128 v247, v[160:163] offset:4096
    v_mfma_f32_16x16x32_bf16 v[168:171], a[172:175], v[24:27], v[168:171]
    buffer_load_dwordx4 v[68:71], v10, s[8:11], s47 offen offset:1024 sc1
    v_mfma_f32_16x16x32_bf16 v[168:171], a[192:195], v[28:31], v[168:171]
    v_mfma_f32_16x16x32_bf16 v[172:175], a[136:139], v[16:19], 0
    v_mfma_f32_16x16x32_bf16 v[172:175], a[156:159], v[20:23], v[172:175]
    v_mfma_f32_16x16x32_bf16 v[172:175], a[176:179], v[24:27], v[172:175]
    v_mfma_f32_16x16x32_bf16 v[172:175], a[196:199], v[28:31], v[172:175]
    buffer_load_dwordx4 v[72:75], v10, s[8:11], s47 offen offset:2048 sc1
    v_mfma_f32_16x16x32_bf16 v[176:179], a[140:143], v[16:19], 0
    v_mfma_f32_16x16x32_bf16 v[176:179], a[160:163], v[20:23], v[176:179]
    v_mfma_f32_16x16x32_bf16 v[176:179], a[180:183], v[24:27], v[176:179]
    v_mfma_f32_16x16x32_bf16 v[176:179], a[200:203], v[28:31], v[176:179]
    v_mfma_f32_16x16x32_bf16 v[180:183], a[144:147], v[16:19], 0
    buffer_load_dwordx4 v[76:79], v10, s[8:11], s47 offen offset:3072 sc1
    v_mfma_f32_16x16x32_bf16 v[180:183], a[164:167], v[20:23], v[180:183]
    s_waitcnt lgkmcnt(0)
    s_barrier
    v_mfma_f32_16x16x32_bf16 v[180:183], a[184:187], v[24:27], v[180:183]
    v_mfma_f32_16x16x32_bf16 v[180:183], a[204:207], v[28:31], v[180:183]
    s_waitcnt vmcnt(8)
    v_mfma_f32_16x16x32_bf16 v[164:167], a[208:211], v[32:35], v[164:167]
    ds_read_b128 v[204:207], v244 offset:10240
    v_mfma_f32_16x16x32_bf16 v[164:167], a[228:231], v[36:39], v[164:167]
    buffer_load_dwordx4 v[16:19], v11, s[8:11], s48 offen offset:0 sc1
    v_mfma_f32_16x16x32_bf16 v[164:167], a[248:251], v[40:43], v[164:167]
    ds_read_b128 v[208:211], v244 offset:11264
    v_mfma_f32_16x16x32_bf16 v[164:167], v[92:95], v[44:47], v[164:167]
    ds_read_b128 v[212:215], v244 offset:12288
    v_mfma_f32_16x16x32_bf16 v[168:171], a[212:215], v[32:35], v[168:171]
    ds_read_b128 v[216:219], v244 offset:13312
    v_mfma_f32_16x16x32_bf16 v[168:171], a[232:235], v[36:39], v[168:171]
    ds_read_b128 v[220:223], v244 offset:14336
    v_mfma_f32_16x16x32_bf16 v[168:171], a[252:255], v[40:43], v[168:171]
    buffer_load_dwordx4 v[20:23], v11, s[8:11], s48 offen offset:1024 sc1
    v_mfma_f32_16x16x32_bf16 v[168:171], v[96:99], v[44:47], v[168:171]
    v_mfma_f32_16x16x32_bf16 v[172:175], a[216:219], v[32:35], v[172:175]
    v_mfma_f32_16x16x32_bf16 v[172:175], a[236:239], v[36:39], v[172:175]
    v_mfma_f32_16x16x32_bf16 v[172:175], v[80:83], v[40:43], v[172:175]
    v_mfma_f32_16x16x32_bf16 v[172:175], v[100:103], v[44:47], v[172:175]
    buffer_load_dwordx4 v[24:27], v11, s[8:11], s48 offen offset:2048 sc1
    v_mfma_f32_16x16x32_bf16 v[176:179], a[220:223], v[32:35], v[176:179]
    v_mfma_f32_16x16x32_bf16 v[176:179], a[240:243], v[36:39], v[176:179]
    v_mfma_f32_16x16x32_bf16 v[176:179], v[84:87], v[40:43], v[176:179]
    v_mfma_f32_16x16x32_bf16 v[176:179], v[104:107], v[44:47], v[176:179]
    v_mfma_f32_16x16x32_bf16 v[180:183], a[224:227], v[32:35], v[180:183]
    buffer_load_dwordx4 v[28:31], v11, s[8:11], s48 offen offset:3072 sc1
    v_mfma_f32_16x16x32_bf16 v[180:183], a[244:247], v[36:39], v[180:183]
    v_mfma_f32_16x16x32_bf16 v[180:183], v[88:91], v[40:43], v[180:183]
    v_mfma_f32_16x16x32_bf16 v[180:183], v[108:111], v[44:47], v[180:183]
    s_waitcnt vmcnt(8) lgkmcnt(0)
    v_mfma_f32_16x16x32_bf16 v[164:167], v[112:115], v[48:51], v[164:167]
    v_add_f32 v184, v184, v204
    v_add_f32 v185, v185, v205
    v_mfma_f32_16x16x32_bf16 v[164:167], v[132:135], v[52:55], v[164:167]
    buffer_load_dwordx4 v[32:35], v11, s[8:11], s49 offen offset:0 sc1
    v_mfma_f32_16x16x32_bf16 v[164:167], a[8:11], v[56:59], v[164:167]
    v_add_f32 v186, v186, v206
    v_add_f32 v187, v187, v207
    v_mfma_f32_16x16x32_bf16 v[164:167], a[28:31], v[60:63], v[164:167]
    v_add_f32 v188, v188, v208
    v_add_f32 v189, v189, v209
    v_mfma_f32_16x16x32_bf16 v[168:171], v[116:119], v[48:51], v[168:171]
    v_add_f32 v190, v190, v210
    v_add_f32 v191, v191, v211
    v_mfma_f32_16x16x32_bf16 v[168:171], v[136:139], v[52:55], v[168:171]
    v_add_f32 v192, v192, v212
    v_add_f32 v193, v193, v213
    v_mfma_f32_16x16x32_bf16 v[168:171], a[12:15], v[56:59], v[168:171]
    buffer_load_dwordx4 v[36:39], v11, s[8:11], s49 offen offset:1024 sc1
    v_mfma_f32_16x16x32_bf16 v[168:171], a[32:35], v[60:63], v[168:171]
    v_add_f32 v194, v194, v214
    v_add_f32 v195, v195, v215
    v_mfma_f32_16x16x32_bf16 v[172:175], v[120:123], v[48:51], v[172:175]
    v_add_f32 v196, v196, v216
    v_add_f32 v197, v197, v217
    v_mfma_f32_16x16x32_bf16 v[172:175], v[140:143], v[52:55], v[172:175]
    v_add_f32 v198, v198, v218
    v_add_f32 v199, v199, v219
    v_mfma_f32_16x16x32_bf16 v[172:175], a[16:19], v[56:59], v[172:175]
    v_add_f32 v200, v200, v220
    v_add_f32 v201, v201, v221
    v_mfma_f32_16x16x32_bf16 v[172:175], a[36:39], v[60:63], v[172:175]
    buffer_load_dwordx4 v[40:43], v11, s[8:11], s49 offen offset:2048 sc1
    v_mfma_f32_16x16x32_bf16 v[176:179], v[124:127], v[48:51], v[176:179]
    v_add_f32 v202, v202, v222
    v_add_f32 v203, v203, v223
    v_mfma_f32_16x16x32_bf16 v[176:179], a[0:3], v[52:55], v[176:179]
    v_mfma_f32_16x16x32_bf16 v[176:179], a[20:23], v[56:59], v[176:179]
    v_mfma_f32_16x16x32_bf16 v[176:179], a[40:43], v[60:63], v[176:179]
    v_mfma_f32_16x16x32_bf16 v[180:183], v[128:131], v[48:51], v[180:183]
    buffer_load_dwordx4 v[44:47], v11, s[8:11], s49 offen offset:3072 sc1
    v_mfma_f32_16x16x32_bf16 v[180:183], a[4:7], v[52:55], v[180:183]
    v_mfma_f32_16x16x32_bf16 v[180:183], a[24:27], v[56:59], v[180:183]
    v_mfma_f32_16x16x32_bf16 v[180:183], a[44:47], v[60:63], v[180:183]
    s_waitcnt vmcnt(8)
    v_mfma_f32_16x16x32_bf16 v[164:167], a[48:51], v[64:67], v[164:167]
    v_add_u32 v244, 102400, v244
    v_mfma_f32_16x16x32_bf16 v[164:167], a[68:71], v[68:71], v[164:167]
    buffer_load_dwordx4 v[48:51], v11, s[8:11], s50 offen offset:0 sc1
    v_mfma_f32_16x16x32_bf16 v[164:167], a[88:91], v[72:75], v[164:167]
    v_add_u32 v245, 102400, v245
    v_mfma_f32_16x16x32_bf16 v[164:167], a[108:111], v[76:79], v[164:167]
    v_add_u32 v246, 102400, v246
    v_mfma_f32_16x16x32_bf16 v[168:171], a[52:55], v[64:67], v[168:171]
    v_add_u32 v247, 102400, v247
    v_mfma_f32_16x16x32_bf16 v[168:171], a[72:75], v[68:71], v[168:171]
    v_mfma_f32_16x16x32_bf16 v[168:171], a[92:95], v[72:75], v[168:171]
    buffer_load_dwordx4 v[52:55], v11, s[8:11], s50 offen offset:1024 sc1
    v_mfma_f32_16x16x32_bf16 v[168:171], a[112:115], v[76:79], v[168:171]
    v_mfma_f32_16x16x32_bf16 v[172:175], a[56:59], v[64:67], v[172:175]
    v_mfma_f32_16x16x32_bf16 v[172:175], a[76:79], v[68:71], v[172:175]
    v_mfma_f32_16x16x32_bf16 v[172:175], a[96:99], v[72:75], v[172:175]
    v_mfma_f32_16x16x32_bf16 v[172:175], a[116:119], v[76:79], v[172:175]
    buffer_load_dwordx4 v[56:59], v11, s[8:11], s50 offen offset:2048 sc1
    v_mfma_f32_16x16x32_bf16 v[176:179], a[60:63], v[64:67], v[176:179]
    v_mfma_f32_16x16x32_bf16 v[176:179], a[80:83], v[68:71], v[176:179]
    v_mfma_f32_16x16x32_bf16 v[176:179], a[100:103], v[72:75], v[176:179]
    v_mfma_f32_16x16x32_bf16 v[176:179], a[120:123], v[76:79], v[176:179]
    v_mfma_f32_16x16x32_bf16 v[180:183], a[64:67], v[64:67], v[180:183]
    buffer_load_dwordx4 v[60:63], v11, s[8:11], s50 offen offset:3072 sc1
    v_mfma_f32_16x16x32_bf16 v[180:183], a[84:87], v[68:71], v[180:183]
    v_mfma_f32_16x16x32_bf16 v[180:183], a[104:107], v[72:75], v[180:183]
    v_mfma_f32_16x16x32_bf16 v[180:183], a[124:127], v[76:79], v[180:183]
    s_waitcnt vmcnt(8)
    v_mfma_f32_16x16x32_bf16 v[144:147], a[128:131], v[16:19], 0
    v_mfma_f32_16x16x32_bf16 v[144:147], a[148:151], v[20:23], v[144:147]
    buffer_load_dwordx4 v[64:67], v11, s[8:11], s51 offen offset:0 sc1
    v_mfma_f32_16x16x32_bf16 v[144:147], a[168:171], v[24:27], v[144:147]
    v_mfma_f32_16x16x32_bf16 v[144:147], a[188:191], v[28:31], v[144:147]
    v_mfma_f32_16x16x32_bf16 v[148:151], a[132:135], v[16:19], 0
    v_add_f32 v204, v184, v164
    v_add_f32 v205, v185, v165
    v_mfma_f32_16x16x32_bf16 v[148:151], a[152:155], v[20:23], v[148:151]
    v_add_f32 v206, v186, v166
    v_add_f32 v207, v187, v167
    v_mfma_f32_16x16x32_bf16 v[148:151], a[172:175], v[24:27], v[148:151]
    buffer_load_dwordx4 v[68:71], v11, s[8:11], s51 offen offset:1024 sc1
    v_mfma_f32_16x16x32_bf16 v[148:151], a[192:195], v[28:31], v[148:151]
    v_add_f32 v208, v188, v168
    v_add_f32 v209, v189, v169
    v_mfma_f32_16x16x32_bf16 v[152:155], a[136:139], v[16:19], 0
    v_add_f32 v210, v190, v170
    v_add_f32 v211, v191, v171
    v_mfma_f32_16x16x32_bf16 v[152:155], a[156:159], v[20:23], v[152:155]
    v_add_f32 v212, v192, v172
    v_add_f32 v213, v193, v173
    v_mfma_f32_16x16x32_bf16 v[152:155], a[176:179], v[24:27], v[152:155]
    v_add_f32 v214, v194, v174
    v_add_f32 v215, v195, v175
    v_mfma_f32_16x16x32_bf16 v[152:155], a[196:199], v[28:31], v[152:155]
    buffer_load_dwordx4 v[72:75], v11, s[8:11], s51 offen offset:2048 sc1
    v_mfma_f32_16x16x32_bf16 v[156:159], a[140:143], v[16:19], 0
    v_add_f32 v216, v196, v176
    v_add_f32 v217, v197, v177
    v_mfma_f32_16x16x32_bf16 v[156:159], a[160:163], v[20:23], v[156:159]
    v_add_f32 v218, v198, v178
    v_add_f32 v219, v199, v179
    v_mfma_f32_16x16x32_bf16 v[156:159], a[180:183], v[24:27], v[156:159]
    v_add_f32 v220, v200, v180
    v_add_f32 v221, v201, v181
    v_mfma_f32_16x16x32_bf16 v[156:159], a[200:203], v[28:31], v[156:159]
    v_add_f32 v222, v202, v182
    v_add_f32 v223, v203, v183
    v_mfma_f32_16x16x32_bf16 v[160:163], a[144:147], v[16:19], 0
    buffer_load_dwordx4 v[76:79], v11, s[8:11], s51 offen offset:3072 sc1
    v_mfma_f32_16x16x32_bf16 v[160:163], a[164:167], v[20:23], v[160:163]
    v_mfma_f32_16x16x32_bf16 v[160:163], a[184:187], v[24:27], v[160:163]
    v_mfma_f32_16x16x32_bf16 v[160:163], a[204:207], v[28:31], v[160:163]
    s_waitcnt vmcnt(8)
    v_mfma_f32_16x16x32_bf16 v[144:147], a[208:211], v[32:35], v[144:147]
    v_mfma_f32_16x16x32_bf16 v[144:147], a[228:231], v[36:39], v[144:147]
    buffer_load_dwordx4 v[16:19], v12, s[8:11], s48 offen offset:0 sc1
    v_mfma_f32_16x16x32_bf16 v[144:147], a[248:251], v[40:43], v[144:147]
    v_mfma_f32_16x16x32_bf16 v[144:147], v[92:95], v[44:47], v[144:147]
    buffer_load_dwordx4 v[20:23], v12, s[8:11], s48 offen offset:1024 sc1
    v_mfma_f32_16x16x32_bf16 v[148:151], a[212:215], v[32:35], v[148:151]
    v_mfma_f32_16x16x32_bf16 v[148:151], a[232:235], v[36:39], v[148:151]
    buffer_load_dwordx4 v[24:27], v12, s[8:11], s48 offen offset:2048 sc1
    v_mfma_f32_16x16x32_bf16 v[148:151], a[252:255], v[40:43], v[148:151]
    v_mfma_f32_16x16x32_bf16 v[148:151], v[96:99], v[44:47], v[148:151]
    buffer_load_dwordx4 v[28:31], v12, s[8:11], s48 offen offset:3072 sc1
    v_mfma_f32_16x16x32_bf16 v[152:155], a[216:219], v[32:35], v[152:155]
    v_mfma_f32_16x16x32_bf16 v[152:155], a[236:239], v[36:39], v[152:155]
    buffer_store_dwordx4 v[204:207], v5, s[52:55], s20 offen offset:0 sc1
    v_mfma_f32_16x16x32_bf16 v[152:155], v[80:83], v[40:43], v[152:155]
    v_mfma_f32_16x16x32_bf16 v[152:155], v[100:103], v[44:47], v[152:155]
    buffer_store_dwordx4 v[208:211], v5, s[52:55], s20 offen offset:1024 sc1
    v_mfma_f32_16x16x32_bf16 v[156:159], a[220:223], v[32:35], v[156:159]
    v_mfma_f32_16x16x32_bf16 v[156:159], a[240:243], v[36:39], v[156:159]
    buffer_store_dwordx4 v[212:215], v5, s[52:55], s20 offen offset:2048 sc1
    v_mfma_f32_16x16x32_bf16 v[156:159], v[84:87], v[40:43], v[156:159]
    v_mfma_f32_16x16x32_bf16 v[156:159], v[104:107], v[44:47], v[156:159]
    buffer_store_dwordx4 v[216:219], v5, s[52:55], s20 offen offset:3072 sc1
    v_mfma_f32_16x16x32_bf16 v[160:163], a[224:227], v[32:35], v[160:163]
    v_mfma_f32_16x16x32_bf16 v[160:163], a[244:247], v[36:39], v[160:163]
    buffer_store_dwordx4 v[220:223], v15, s[52:55], s20 offen offset:0 sc1
    v_mfma_f32_16x16x32_bf16 v[160:163], v[88:91], v[40:43], v[160:163]
    v_mfma_f32_16x16x32_bf16 v[160:163], v[108:111], v[44:47], v[160:163]
    s_waitcnt vmcnt(13)
    v_mfma_f32_16x16x32_bf16 v[144:147], v[112:115], v[48:51], v[144:147]
    v_mfma_f32_16x16x32_bf16 v[144:147], v[132:135], v[52:55], v[144:147]
    buffer_load_dwordx4 v[32:35], v12, s[8:11], s49 offen offset:0 sc1
    v_mfma_f32_16x16x32_bf16 v[144:147], a[8:11], v[56:59], v[144:147]
    v_mfma_f32_16x16x32_bf16 v[144:147], a[28:31], v[60:63], v[144:147]
    v_mfma_f32_16x16x32_bf16 v[148:151], v[116:119], v[48:51], v[148:151]
    v_mfma_f32_16x16x32_bf16 v[148:151], v[136:139], v[52:55], v[148:151]
    v_mfma_f32_16x16x32_bf16 v[148:151], a[12:15], v[56:59], v[148:151]
    buffer_load_dwordx4 v[36:39], v12, s[8:11], s49 offen offset:1024 sc1
    v_mfma_f32_16x16x32_bf16 v[148:151], a[32:35], v[60:63], v[148:151]
    v_mfma_f32_16x16x32_bf16 v[152:155], v[120:123], v[48:51], v[152:155]
    v_mfma_f32_16x16x32_bf16 v[152:155], v[140:143], v[52:55], v[152:155]
    v_mfma_f32_16x16x32_bf16 v[152:155], a[16:19], v[56:59], v[152:155]
    v_mfma_f32_16x16x32_bf16 v[152:155], a[36:39], v[60:63], v[152:155]
    buffer_load_dwordx4 v[40:43], v12, s[8:11], s49 offen offset:2048 sc1
    v_mfma_f32_16x16x32_bf16 v[156:159], v[124:127], v[48:51], v[156:159]
    v_mfma_f32_16x16x32_bf16 v[156:159], a[0:3], v[52:55], v[156:159]
    v_mfma_f32_16x16x32_bf16 v[156:159], a[20:23], v[56:59], v[156:159]
    v_mfma_f32_16x16x32_bf16 v[156:159], a[40:43], v[60:63], v[156:159]
    v_mfma_f32_16x16x32_bf16 v[160:163], v[128:131], v[48:51], v[160:163]
    buffer_load_dwordx4 v[44:47], v12, s[8:11], s49 offen offset:3072 sc1
    v_mfma_f32_16x16x32_bf16 v[160:163], a[4:7], v[52:55], v[160:163]
    v_mfma_f32_16x16x32_bf16 v[160:163], a[24:27], v[56:59], v[160:163]
    v_mfma_f32_16x16x32_bf16 v[160:163], a[44:47], v[60:63], v[160:163]
    s_waitcnt vmcnt(13)
    v_mfma_f32_16x16x32_bf16 v[144:147], a[48:51], v[64:67], v[144:147]
    v_mfma_f32_16x16x32_bf16 v[144:147], a[68:71], v[68:71], v[144:147]
    buffer_load_dwordx4 v[48:51], v12, s[8:11], s50 offen offset:0 sc1
    v_mfma_f32_16x16x32_bf16 v[144:147], a[88:91], v[72:75], v[144:147]
    v_mfma_f32_16x16x32_bf16 v[144:147], a[108:111], v[76:79], v[144:147]
    v_mfma_f32_16x16x32_bf16 v[148:151], a[52:55], v[64:67], v[148:151]
    v_mfma_f32_16x16x32_bf16 v[148:151], a[72:75], v[68:71], v[148:151]
    v_mfma_f32_16x16x32_bf16 v[148:151], a[92:95], v[72:75], v[148:151]
    buffer_load_dwordx4 v[52:55], v12, s[8:11], s50 offen offset:1024 sc1
    v_mfma_f32_16x16x32_bf16 v[148:151], a[112:115], v[76:79], v[148:151]
    v_mfma_f32_16x16x32_bf16 v[152:155], a[56:59], v[64:67], v[152:155]
    v_mfma_f32_16x16x32_bf16 v[152:155], a[76:79], v[68:71], v[152:155]
    s_nop 0
    ds_write_b128 v245, v[144:147] offset:0
    v_mfma_f32_16x16x32_bf16 v[152:155], a[96:99], v[72:75], v[152:155]
    v_mfma_f32_16x16x32_bf16 v[152:155], a[116:119], v[76:79], v[152:155]
    buffer_load_dwordx4 v[56:59], v12, s[8:11], s50 offen offset:2048 sc1
    v_mfma_f32_16x16x32_bf16 v[156:159], a[60:63], v[64:67], v[156:159]
    v_mfma_f32_16x16x32_bf16 v[156:159], a[80:83], v[68:71], v[156:159]
    ds_write_b128 v245, v[148:151] offset:1024
    v_mfma_f32_16x16x32_bf16 v[156:159], a[100:103], v[72:75], v[156:159]
    v_mfma_f32_16x16x32_bf16 v[156:159], a[120:123], v[76:79], v[156:159]
    v_mfma_f32_16x16x32_bf16 v[160:163], a[64:67], v[64:67], v[160:163]
    buffer_load_dwordx4 v[60:63], v12, s[8:11], s50 offen offset:3072 sc1
    v_mfma_f32_16x16x32_bf16 v[160:163], a[84:87], v[68:71], v[160:163]
    ds_write_b128 v245, v[152:155] offset:2048
    v_mfma_f32_16x16x32_bf16 v[160:163], a[104:107], v[72:75], v[160:163]
    v_mfma_f32_16x16x32_bf16 v[160:163], a[124:127], v[76:79], v[160:163]
    s_waitcnt vmcnt(13)
    v_mfma_f32_16x16x32_bf16 v[164:167], a[128:131], v[16:19], 0
    v_mfma_f32_16x16x32_bf16 v[164:167], a[148:151], v[20:23], v[164:167]
    buffer_load_dwordx4 v[64:67], v12, s[8:11], s51 offen offset:0 sc1
    v_mfma_f32_16x16x32_bf16 v[164:167], a[168:171], v[24:27], v[164:167]
    ds_write_b128 v245, v[156:159] offset:3072
    v_mfma_f32_16x16x32_bf16 v[164:167], a[188:191], v[28:31], v[164:167]
    v_mfma_f32_16x16x32_bf16 v[168:171], a[132:135], v[16:19], 0
    v_mfma_f32_16x16x32_bf16 v[168:171], a[152:155], v[20:23], v[168:171]
    buffer_load_dwordx4 v[68:71], v12, s[8:11], s51 offen offset:1024 sc1
    v_mfma_f32_16x16x32_bf16 v[168:171], a[172:175], v[24:27], v[168:171]
    ds_write_b128 v245, v[160:163] offset:4096
    v_mfma_f32_16x16x32_bf16 v[168:171], a[192:195], v[28:31], v[168:171]
    v_mfma_f32_16x16x32_bf16 v[172:175], a[136:139], v[16:19], 0
    v_mfma_f32_16x16x32_bf16 v[172:175], a[156:159], v[20:23], v[172:175]
    buffer_load_dwordx4 v[72:75], v12, s[8:11], s51 offen offset:2048 sc1
    v_mfma_f32_16x16x32_bf16 v[172:175], a[176:179], v[24:27], v[172:175]
    v_mfma_f32_16x16x32_bf16 v[172:175], a[196:199], v[28:31], v[172:175]
    v_mfma_f32_16x16x32_bf16 v[176:179], a[140:143], v[16:19], 0
    v_mfma_f32_16x16x32_bf16 v[176:179], a[160:163], v[20:23], v[176:179]
    buffer_load_dwordx4 v[76:79], v12, s[8:11], s51 offen offset:3072 sc1
    v_mfma_f32_16x16x32_bf16 v[176:179], a[180:183], v[24:27], v[176:179]
    v_mfma_f32_16x16x32_bf16 v[176:179], a[200:203], v[28:31], v[176:179]
    v_mfma_f32_16x16x32_bf16 v[180:183], a[144:147], v[16:19], 0
    s_waitcnt vmcnt(12)
    v_mfma_f32_16x16x32_bf16 v[180:183], a[164:167], v[20:23], v[180:183]
    buffer_store_dword v8, v9, s[52:55], s21 offen sc1
    v_mfma_f32_16x16x32_bf16 v[180:183], a[184:187], v[24:27], v[180:183]
    v_mfma_f32_16x16x32_bf16 v[180:183], a[204:207], v[28:31], v[180:183]
    s_waitcnt vmcnt(9)
    v_mfma_f32_16x16x32_bf16 v[164:167], a[208:211], v[32:35], v[164:167]
    v_mfma_f32_16x16x32_bf16 v[164:167], a[228:231], v[36:39], v[164:167]
    buffer_load_dwordx4 v[16:19], v13, s[8:11], s48 offen offset:0 sc1
    v_mfma_f32_16x16x32_bf16 v[164:167], a[248:251], v[40:43], v[164:167]
    v_mfma_f32_16x16x32_bf16 v[164:167], v[92:95], v[44:47], v[164:167]
    buffer_load_dwordx4 v[20:23], v13, s[8:11], s48 offen offset:1024 sc1
    v_mfma_f32_16x16x32_bf16 v[168:171], a[212:215], v[32:35], v[168:171]
    v_mfma_f32_16x16x32_bf16 v[168:171], a[232:235], v[36:39], v[168:171]
    buffer_load_dwordx4 v[24:27], v13, s[8:11], s48 offen offset:2048 sc1
    v_mfma_f32_16x16x32_bf16 v[168:171], a[252:255], v[40:43], v[168:171]
    v_mfma_f32_16x16x32_bf16 v[168:171], v[96:99], v[44:47], v[168:171]
    buffer_load_dwordx4 v[28:31], v13, s[8:11], s48 offen offset:3072 sc1
    v_mfma_f32_16x16x32_bf16 v[172:175], a[216:219], v[32:35], v[172:175]
    v_mfma_f32_16x16x32_bf16 v[172:175], a[236:239], v[36:39], v[172:175]
    buffer_load_dwordx2 v[232:233], v232, s[16:19], 0 offen offset:0
    v_mfma_f32_16x16x32_bf16 v[172:175], v[80:83], v[40:43], v[172:175]
    v_mfma_f32_16x16x32_bf16 v[172:175], v[100:103], v[44:47], v[172:175]
    buffer_load_dword v228, v5, s[52:55], s90 offen sc1
    v_mfma_f32_16x16x32_bf16 v[176:179], a[220:223], v[32:35], v[176:179]
    v_mfma_f32_16x16x32_bf16 v[176:179], a[240:243], v[36:39], v[176:179]
    buffer_load_dword v229, v5, s[52:55], s91 offen sc1
    v_mfma_f32_16x16x32_bf16 v[176:179], v[84:87], v[40:43], v[176:179]
    v_mfma_f32_16x16x32_bf16 v[176:179], v[104:107], v[44:47], v[176:179]
    buffer_load_dword v230, v5, s[52:55], s92 offen sc1
    v_mfma_f32_16x16x32_bf16 v[180:183], a[224:227], v[32:35], v[180:183]
    v_mfma_f32_16x16x32_bf16 v[180:183], a[244:247], v[36:39], v[180:183]
    buffer_load_dword v231, v5, s[52:55], s93 offen sc1
    v_mfma_f32_16x16x32_bf16 v[180:183], v[88:91], v[40:43], v[180:183]
    v_mfma_f32_16x16x32_bf16 v[180:183], v[108:111], v[44:47], v[180:183]
    s_waitcnt vmcnt(14)
    v_mfma_f32_16x16x32_bf16 v[164:167], v[112:115], v[48:51], v[164:167]
    v_mfma_f32_16x16x32_bf16 v[164:167], v[132:135], v[52:55], v[164:167]
    buffer_load_dwordx4 v[32:35], v13, s[8:11], s49 offen offset:0 sc1
    v_mfma_f32_16x16x32_bf16 v[164:167], a[8:11], v[56:59], v[164:167]
    v_mfma_f32_16x16x32_bf16 v[164:167], a[28:31], v[60:63], v[164:167]
    v_mfma_f32_16x16x32_bf16 v[168:171], v[116:119], v[48:51], v[168:171]
    v_mfma_f32_16x16x32_bf16 v[168:171], v[136:139], v[52:55], v[168:171]
    v_mfma_f32_16x16x32_bf16 v[168:171], a[12:15], v[56:59], v[168:171]
    buffer_load_dwordx4 v[36:39], v13, s[8:11], s49 offen offset:1024 sc1
    v_mfma_f32_16x16x32_bf16 v[168:171], a[32:35], v[60:63], v[168:171]
    v_mfma_f32_16x16x32_bf16 v[172:175], v[120:123], v[48:51], v[172:175]
    v_mfma_f32_16x16x32_bf16 v[172:175], v[140:143], v[52:55], v[172:175]
    v_mfma_f32_16x16x32_bf16 v[172:175], a[16:19], v[56:59], v[172:175]
    v_mfma_f32_16x16x32_bf16 v[172:175], a[36:39], v[60:63], v[172:175]
    buffer_load_dwordx4 v[40:43], v13, s[8:11], s49 offen offset:2048 sc1
    v_mfma_f32_16x16x32_bf16 v[176:179], v[124:127], v[48:51], v[176:179]
    v_mfma_f32_16x16x32_bf16 v[176:179], a[0:3], v[52:55], v[176:179]
    v_mfma_f32_16x16x32_bf16 v[176:179], a[20:23], v[56:59], v[176:179]
    v_mfma_f32_16x16x32_bf16 v[176:179], a[40:43], v[60:63], v[176:179]
    v_mfma_f32_16x16x32_bf16 v[180:183], v[128:131], v[48:51], v[180:183]
    buffer_load_dwordx4 v[44:47], v13, s[8:11], s49 offen offset:3072 sc1
    v_mfma_f32_16x16x32_bf16 v[180:183], a[4:7], v[52:55], v[180:183]
    v_mfma_f32_16x16x32_bf16 v[180:183], a[24:27], v[56:59], v[180:183]
    v_mfma_f32_16x16x32_bf16 v[180:183], a[44:47], v[60:63], v[180:183]
    s_waitcnt vmcnt(14)
    v_mfma_f32_16x16x32_bf16 v[164:167], a[48:51], v[64:67], v[164:167]
    v_mfma_f32_16x16x32_bf16 v[164:167], a[68:71], v[68:71], v[164:167]
    buffer_load_dwordx4 v[48:51], v13, s[8:11], s50 offen offset:0 sc1
    v_mfma_f32_16x16x32_bf16 v[164:167], a[88:91], v[72:75], v[164:167]
    v_mfma_f32_16x16x32_bf16 v[164:167], a[108:111], v[76:79], v[164:167]
    v_mfma_f32_16x16x32_bf16 v[168:171], a[52:55], v[64:67], v[168:171]
    v_mfma_f32_16x16x32_bf16 v[168:171], a[72:75], v[68:71], v[168:171]
    v_mfma_f32_16x16x32_bf16 v[168:171], a[92:95], v[72:75], v[168:171]
    buffer_load_dwordx4 v[52:55], v13, s[8:11], s50 offen offset:1024 sc1
    v_mfma_f32_16x16x32_bf16 v[168:171], a[112:115], v[76:79], v[168:171]
    v_mfma_f32_16x16x32_bf16 v[172:175], a[56:59], v[64:67], v[172:175]
    v_mfma_f32_16x16x32_bf16 v[172:175], a[76:79], v[68:71], v[172:175]
    s_nop 0
    ds_write_b128 v246, v[164:167] offset:0
    v_mfma_f32_16x16x32_bf16 v[172:175], a[96:99], v[72:75], v[172:175]
    v_mfma_f32_16x16x32_bf16 v[172:175], a[116:119], v[76:79], v[172:175]
    buffer_load_dwordx4 v[56:59], v13, s[8:11], s50 offen offset:2048 sc1
    v_mfma_f32_16x16x32_bf16 v[176:179], a[60:63], v[64:67], v[176:179]
    v_mfma_f32_16x16x32_bf16 v[176:179], a[80:83], v[68:71], v[176:179]
    ds_write_b128 v246, v[168:171] offset:1024
    v_mfma_f32_16x16x32_bf16 v[176:179], a[100:103], v[72:75], v[176:179]
    v_mfma_f32_16x16x32_bf16 v[176:179], a[120:123], v[76:79], v[176:179]
    v_mfma_f32_16x16x32_bf16 v[180:183], a[64:67], v[64:67], v[180:183]
    buffer_load_dwordx4 v[60:63], v13, s[8:11], s50 offen offset:3072 sc1
    v_mfma_f32_16x16x32_bf16 v[180:183], a[84:87], v[68:71], v[180:183]
    ds_write_b128 v246, v[172:175] offset:2048
    v_mfma_f32_16x16x32_bf16 v[180:183], a[104:107], v[72:75], v[180:183]
    v_mfma_f32_16x16x32_bf16 v[180:183], a[124:127], v[76:79], v[180:183]
    s_waitcnt vmcnt(13)
    v_mfma_f32_16x16x32_bf16 v[144:147], a[128:131], v[16:19], 0
    v_mfma_f32_16x16x32_bf16 v[144:147], a[148:151], v[20:23], v[144:147]
    buffer_load_dwordx4 v[64:67], v13, s[8:11], s51 offen offset:0 sc1
    v_mfma_f32_16x16x32_bf16 v[144:147], a[168:171], v[24:27], v[144:147]
    s_waitcnt vmcnt(9)
    ds_write_b128 v246, v[176:179] offset:3072
    v_mfma_f32_16x16x32_bf16 v[144:147], a[188:191], v[28:31], v[144:147]
    v_xor_b32 v228, s3, v228
    v_mfma_f32_16x16x32_bf16 v[148:151], a[132:135], v[16:19], 0
    v_xor_b32 v229, s3, v229
    v_mfma_f32_16x16x32_bf16 v[148:151], a[152:155], v[20:23], v[148:151]
    ds_write_b128 v246, v[180:183] offset:4096
    v_xor_b32 v230, s3, v230
    v_mfma_f32_16x16x32_bf16 v[148:151], a[172:175], v[24:27], v[148:151]
    buffer_load_dwordx4 v[68:71], v13, s[8:11], s51 offen offset:1024 sc1
    v_mfma_f32_16x16x32_bf16 v[148:151], a[192:195], v[28:31], v[148:151]
    v_xor_b32 v231, s3, v231
    v_mfma_f32_16x16x32_bf16 v[152:155], a[136:139], v[16:19], 0
    v_or3_b32 v228, v228, v229, v230
    v_mfma_f32_16x16x32_bf16 v[152:155], a[156:159], v[20:23], v[152:155]
    v_or_b32 v228, v228, v231
    v_mfma_f32_16x16x32_bf16 v[152:155], a[176:179], v[24:27], v[152:155]
    v_cmp_ne_u32 vcc, 0, v228
    v_mfma_f32_16x16x32_bf16 v[152:155], a[196:199], v[28:31], v[152:155]
    buffer_load_dwordx4 v[72:75], v13, s[8:11], s51 offen offset:2048 sc1
    v_mfma_f32_16x16x32_bf16 v[156:159], a[140:143], v[16:19], 0
    v_mfma_f32_16x16x32_bf16 v[156:159], a[160:163], v[20:23], v[156:159]
    s_cbranch_vccnz Lf1
Lf1_back:
    v_mfma_f32_16x16x32_bf16 v[156:159], a[180:183], v[24:27], v[156:159]
    v_mfma_f32_16x16x32_bf16 v[156:159], a[200:203], v[28:31], v[156:159]
    v_mfma_f32_16x16x32_bf16 v[160:163], a[144:147], v[16:19], 0
    buffer_load_dwordx4 v[76:79], v13, s[8:11], s51 offen offset:3072 sc1
    v_mfma_f32_16x16x32_bf16 v[160:163], a[164:167], v[20:23], v[160:163]
    s_waitcnt lgkmcnt(0)
    s_barrier
    v_mfma_f32_16x16x32_bf16 v[160:163], a[184:187], v[24:27], v[160:163]
    v_mfma_f32_16x16x32_bf16 v[160:163], a[204:207], v[28:31], v[160:163]
    s_waitcnt vmcnt(8)
    v_mfma_f32_16x16x32_bf16 v[144:147], a[208:211], v[32:35], v[144:147]
    ds_read_b128 v[184:187], v244 offset:0
    v_mfma_f32_16x16x32_bf16 v[144:147], a[228:231], v[36:39], v[144:147]
    buffer_load_dwordx4 v[16:19], v10, s[8:11], s49 offen offset:0 sc1
    v_mfma_f32_16x16x32_bf16 v[144:147], a[248:251], v[40:43], v[144:147]
    ds_read_b128 v[188:191], v244 offset:1024
    v_mfma_f32_16x16x32_bf16 v[144:147], v[92:95], v[44:47], v[144:147]
    ds_read_b128 v[192:195], v244 offset:2048
    v_mfma_f32_16x16x32_bf16 v[148:151], a[212:215], v[32:35], v[148:151]
    ds_read_b128 v[196:199], v244 offset:3072
    v_mfma_f32_16x16x32_bf16 v[148:151], a[232:235], v[36:39], v[148:151]
    ds_read_b128 v[200:203], v244 offset:4096
    v_mfma_f32_16x16x32_bf16 v[148:151], a[252:255], v[40:43], v[148:151]
    buffer_load_dwordx4 v[20:23], v10, s[8:11], s49 offen offset:1024 sc1
    v_mfma_f32_16x16x32_bf16 v[148:151], v[96:99], v[44:47], v[148:151]
    ds_read_b128 v[204:207], v244 offset:5120
    v_mfma_f32_16x16x32_bf16 v[152:155], a[216:219], v[32:35], v[152:155]
    ds_read_b128 v[208:211], v244 offset:6144
    v_mfma_f32_16x16x32_bf16 v[152:155], a[236:239], v[36:39], v[152:155]
    ds_read_b128 v[212:215], v244 offset:7168
    v_mfma_f32_16x16x32_bf16 v[152:155], v[80:83], v[40:43], v[152:155]
    ds_read_b128 v[216:219], v244 offset:8192
    v_mfma_f32_16x16x32_bf16 v[152:155], v[100:103], v[44:47], v[152:155]
    ds_read_b128 v[220:223], v244 offset:9216
    buffer_load_dwordx4 v[24:27], v10, s[8:11], s49 offen offset:2048 sc1
    v_mfma_f32_16x16x32_bf16 v[156:159], a[220:223], v[32:35], v[156:159]
    v_mfma_f32_16x16x32_bf16 v[156:159], a[240:243], v[36:39], v[156:159]
    v_mfma_f32_16x16x32_bf16 v[156:159], v[84:87], v[40:43], v[156:159]
    v_mfma_f32_16x16x32_bf16 v[156:159], v[104:107], v[44:47], v[156:159]
    v_mfma_f32_16x16x32_bf16 v[160:163], a[224:227], v[32:35], v[160:163]
    buffer_load_dwordx4 v[28:31], v10, s[8:11], s49 offen offset:3072 sc1
    v_mfma_f32_16x16x32_bf16 v[160:163], a[244:247], v[36:39], v[160:163]
    v_mfma_f32_16x16x32_bf16 v[160:163], v[88:91], v[40:43], v[160:163]
    v_mfma_f32_16x16x32_bf16 v[160:163], v[108:111], v[44:47], v[160:163]
    s_waitcnt vmcnt(8) lgkmcnt(0)
    v_mfma_f32_16x16x32_bf16 v[144:147], v[112:115], v[48:51], v[144:147]
    v_add_f32 v184, v184, v204
    v_add_f32 v185, v185, v205
    v_mfma_f32_16x16x32_bf16 v[144:147], v[132:135], v[52:55], v[144:147]
    buffer_load_dwordx4 v[32:35], v10, s[8:11], s50 offen offset:0 sc1
    v_mfma_f32_16x16x32_bf16 v[144:147], a[8:11], v[56:59], v[144:147]
    v_add_f32 v186, v186, v206
    v_add_f32 v187, v187, v207
    v_mfma_f32_16x16x32_bf16 v[144:147], a[28:31], v[60:63], v[144:147]
    v_add_f32 v188, v188, v208
    v_add_f32 v189, v189, v209
    v_mfma_f32_16x16x32_bf16 v[148:151], v[116:119], v[48:51], v[148:151]
    v_add_f32 v190, v190, v210
    v_add_f32 v191, v191, v211
    v_mfma_f32_16x16x32_bf16 v[148:151], v[136:139], v[52:55], v[148:151]
    buffer_load_dwordx4 v[36:39], v10, s[8:11], s50 offen offset:1024 sc1
    v_mfma_f32_16x16x32_bf16 v[148:151], a[12:15], v[56:59], v[148:151]
    v_add_f32 v192, v192, v212
    v_add_f32 v193, v193, v213
    v_mfma_f32_16x16x32_bf16 v[148:151], a[32:35], v[60:63], v[148:151]
    v_add_f32 v194, v194, v214
    v_add_f32 v195, v195, v215
    v_mfma_f32_16x16x32_bf16 v[152:155], v[120:123], v[48:51], v[152:155]
    v_add_f32 v196, v196, v216
    v_add_f32 v197, v197, v217
    v_mfma_f32_16x16x32_bf16 v[152:155], v[140:143], v[52:55], v[152:155]
    buffer_load_dwordx4 v[40:43], v10, s[8:11], s50 offen offset:2048 sc1
    v_mfma_f32_16x16x32_bf16 v[152:155], a[16:19], v[56:59], v[152:155]
    v_add_f32 v198, v198, v218
    v_add_f32 v199, v199, v219
    v_mfma_f32_16x16x32_bf16 v[152:155], a[36:39], v[60:63], v[152:155]
    v_add_f32 v200, v200, v220
    v_add_f32 v201, v201, v221
    v_mfma_f32_16x16x32_bf16 v[156:159], v[124:127], v[48:51], v[156:159]
    v_add_f32 v202, v202, v222
    v_add_f32 v203, v203, v223
    v_mfma_f32_16x16x32_bf16 v[156:159], a[0:3], v[52:55], v[156:159]
    buffer_load_dwordx4 v[44:47], v10, s[8:11], s50 offen offset:3072 sc1
    v_mfma_f32_16x16x32_bf16 v[156:159], a[20:23], v[56:59], v[156:159]
    v_mfma_f32_16x16x32_bf16 v[156:159], a[40:43], v[60:63], v[156:159]
    v_mfma_f32_16x16x32_bf16 v[160:163], v[128:131], v[48:51], v[160:163]
    v_mfma_f32_16x16x32_bf16 v[160:163], a[4:7], v[52:55], v[160:163]
    buffer_load_dword v14, v9, s[52:55], s23 offen sc1
    v_mfma_f32_16x16x32_bf16 v[160:163], a[24:27], v[56:59], v[160:163]
    v_mfma_f32_16x16x32_bf16 v[160:163], a[44:47], v[60:63], v[160:163]
    s_waitcnt vmcnt(9)
    v_mfma_f32_16x16x32_bf16 v[144:147], a[48:51], v[64:67], v[144:147]
    v_mfma_f32_16x16x32_bf16 v[144:147], a[68:71], v[68:71], v[144:147]
    buffer_load_dwordx4 v[48:51], v10, s[8:11], s48 offen offset:0 sc1
    v_mfma_f32_16x16x32_bf16 v[144:147], a[88:91], v[72:75], v[144:147]
    v_mfma_f32_16x16x32_bf16 v[144:147], a[108:111], v[76:79], v[144:147]
    v_mfma_f32_16x16x32_bf16 v[148:151], a[52:55], v[64:67], v[148:151]
    v_mfma_f32_16x16x32_bf16 v[148:151], a[72:75], v[68:71], v[148:151]
    v_mfma_f32_16x16x32_bf16 v[148:151], a[92:95], v[72:75], v[148:151]
    buffer_load_dwordx4 v[52:55], v10, s[8:11], s48 offen offset:1024 sc1
    v_mfma_f32_16x16x32_bf16 v[148:151], a[112:115], v[76:79], v[148:151]
    v_mfma_f32_16x16x32_bf16 v[152:155], a[56:59], v[64:67], v[152:155]
    v_mfma_f32_16x16x32_bf16 v[152:155], a[76:79], v[68:71], v[152:155]
    s_nop 0
    ds_write_b128 v247, v[144:147] offset:0
    v_mfma_f32_16x16x32_bf16 v[152:155], a[96:99], v[72:75], v[152:155]
    v_mfma_f32_16x16x32_bf16 v[152:155], a[116:119], v[76:79], v[152:155]
    buffer_load_dwordx4 v[56:59], v10, s[8:11], s48 offen offset:2048 sc1
    v_mfma_f32_16x16x32_bf16 v[156:159], a[60:63], v[64:67], v[156:159]
    v_mfma_f32_16x16x32_bf16 v[156:159], a[80:83], v[68:71], v[156:159]
    ds_write_b128 v247, v[148:151] offset:1024
    v_mfma_f32_16x16x32_bf16 v[156:159], a[100:103], v[72:75], v[156:159]
    v_mfma_f32_16x16x32_bf16 v[156:159], a[120:123], v[76:79], v[156:159]
    v_mfma_f32_16x16x32_bf16 v[160:163], a[64:67], v[64:67], v[160:163]
    buffer_load_dwordx4 v[60:63], v10, s[8:11], s48 offen offset:3072 sc1
    v_mfma_f32_16x16x32_bf16 v[160:163], a[84:87], v[68:71], v[160:163]
    ds_write_b128 v247, v[152:155] offset:2048
    v_mfma_f32_16x16x32_bf16 v[160:163], a[104:107], v[72:75], v[160:163]
    v_mfma_f32_16x16x32_bf16 v[160:163], a[124:127], v[76:79], v[160:163]
    s_waitcnt vmcnt(9)
    v_mfma_f32_16x16x32_bf16 v[164:167], a[208:211], v[16:19], 0
    v_mfma_f32_16x16x32_bf16 v[164:167], a[228:231], v[20:23], v[164:167]
    buffer_load_dwordx4 v[64:67], v10, s[8:11], s51 offen offset:0 sc1
    v_mfma_f32_16x16x32_bf16 v[164:167], a[248:251], v[24:27], v[164:167]
    ds_write_b128 v247, v[156:159] offset:3072
    v_mfma_f32_16x16x32_bf16 v[164:167], v[92:95], v[28:31], v[164:167]
    v_mfma_f32_16x16x32_bf16 v[168:171], a[212:215], v[16:19], 0
    v_mfma_f32_16x16x32_bf16 v[168:171], a[232:235], v[20:23], v[168:171]
    ds_write_b128 v247, v[160:163] offset:4096
    v_mfma_f32_16x16x32_bf16 v[168:171], a[252:255], v[24:27], v[168:171]
    buffer_load_dwordx4 v[68:71], v10, s[8:11], s51 offen offset:1024 sc1
    v_mfma_f32_16x16x32_bf16 v[168:171], v[96:99], v[28:31], v[168:171]
    v_mfma_f32_16x16x32_bf16 v[172:175], a[216:219], v[16:19], 0
    v_mfma_f32_16x16x32_bf16 v[172:175], a[236:239], v[20:23], v[172:175]
    v_mfma_f32_16x16x32_bf16 v[172:175], v[80:83], v[24:27], v[172:175]
    v_mfma_f32_16x16x32_bf16 v[172:175], v[100:103], v[28:31], v[172:175]
    buffer_load_dwordx4 v[72:75], v10, s[8:11], s51 offen offset:2048 sc1
    v_mfma_f32_16x16x32_bf16 v[176:179], a[220:223], v[16:19], 0
    s_waitcnt vmcnt(7)
    v_mfma_f32_16x16x32_bf16 v[176:179], a[240:243], v[20:23], v[176:179]
    v_cmp_ne_u32 vcc, s3, v14
    v_mfma_f32_16x16x32_bf16 v[176:179], v[84:87], v[24:27], v[176:179]
    v_mfma_f32_16x16x32_bf16 v[176:179], v[104:107], v[28:31], v[176:179]
    v_mfma_f32_16x16x32_bf16 v[180:183], a[224:227], v[16:19], 0
    buffer_load_dwordx4 v[76:79], v10, s[8:11], s51 offen offset:3072 sc1
    v_mfma_f32_16x16x32_bf16 v[180:183], a[244:247], v[20:23], v[180:183]
    s_waitcnt lgkmcnt(0)
    s_barrier
    v_mfma_f32_16x16x32_bf16 v[180:183], v[88:91], v[24:27], v[180:183]
    s_cbranch_vccnz Lpx
Lpx_back:
    v_mfma_f32_16x16x32_bf16 v[180:183], v[108:111], v[28:31], v[180:183]
    s_waitcnt vmcnt(9)
    v_mfma_f32_16x16x32_bf16 v[164:167], v[112:115], v[32:35], v[164:167]
    ds_read_b128 v[204:207], v244 offset:10240
    v_mfma_f32_16x16x32_bf16 v[164:167], v[132:135], v[36:39], v[164:167]
    buffer_load_dwordx4 v[144:147], v5, s[52:55], s22 offen offset:0 sc1
    v_mfma_f32_16x16x32_bf16 v[164:167], a[8:11], v[40:43], v[164:167]
    s_mov_b32 s44, 0
    ds_read_b128 v[208:211], v244 offset:11264
    v_mfma_f32_16x16x32_bf16 v[164:167], a[28:31], v[44:47], v[164:167]
    s_mov_b32 s45, 4096
    ds_read_b128 v[212:215], v244 offset:12288
    v_mfma_f32_16x16x32_bf16 v[168:171], v[116:119], v[32:35], v[168:171]
    s_mov_b32 s46, 8192
    ds_read_b128 v[216:219], v244 offset:13312
    v_mfma_f32_16x16x32_bf16 v[168:171], v[136:139], v[36:39], v[168:171]
    s_mov_b32 s47, 12288
    buffer_load_dwordx4 v[148:151], v5, s[52:55], s22 offen offset:1024 sc1
    v_mfma_f32_16x16x32_bf16 v[168:171], a[12:15], v[40:43], v[168:171]
    s_mov_b32 s48, 16384
    ds_read_b128 v[220:223], v244 offset:14336
    v_mfma_f32_16x16x32_bf16 v[168:171], a[32:35], v[44:47], v[168:171]
    s_mov_b32 s49, 20480
    v_mfma_f32_16x16x32_bf16 v[172:175], v[120:123], v[32:35], v[172:175]
    s_mov_b32 s50, 24576
    v_mfma_f32_16x16x32_bf16 v[172:175], v[140:143], v[36:39], v[172:175]
    s_mov_b32 s51, 28672
    buffer_load_dwordx4 v[152:155], v5, s[52:55], s22 offen offset:2048 sc1
    v_mfma_f32_16x16x32_bf16 v[172:175], a[16:19], v[40:43], v[172:175]
    v_mfma_f32_16x16x32_bf16 v[172:175], a[36:39], v[44:47], v[172:175]
    v_mfma_f32_16x16x32_bf16 v[176:179], v[124:127], v[32:35], v[176:179]
    v_mfma_f32_16x16x32_bf16 v[176:179], a[0:3], v[36:39], v[176:179]
    buffer_load_dwordx4 v[156:159], v5, s[52:55], s22 offen offset:3072 sc1
    v_mfma_f32_16x16x32_bf16 v[176:179], a[20:23], v[40:43], v[176:179]
    v_mfma_f32_16x16x32_bf16 v[176:179], a[40:43], v[44:47], v[176:179]
    v_mfma_f32_16x16x32_bf16 v[180:183], v[128:131], v[32:35], v[180:183]
    v_mfma_f32_16x16x32_bf16 v[180:183], a[4:7], v[36:39], v[180:183]
    buffer_load_dwordx4 v[160:163], v15, s[52:55], s22 offen offset:0 sc1
    v_mfma_f32_16x16x32_bf16 v[180:183], a[24:27], v[40:43], v[180:183]
    v_mfma_f32_16x16x32_bf16 v[180:183], a[44:47], v[44:47], v[180:183]
    s_waitcnt vmcnt(9) lgkmcnt(0)
    v_mfma_f32_16x16x32_bf16 v[164:167], a[128:131], v[48:51], v[164:167]
    s_mov_b32 s41, 0
    s_add_u32 m0, s37, 0
    v_add_f32 v184, v184, v204
    v_add_f32 v185, v185, v205
    v_mfma_f32_16x16x32_bf16 v[164:167], a[148:151], v[52:55], v[164:167]
    buffer_load_dwordx4 v248, s[12:15], s41 offen offset:0 sc1 lds
    v_mfma_f32_16x16x32_bf16 v[164:167], a[168:171], v[56:59], v[164:167]
    v_add_f32 v186, v186, v206
    v_add_f32 v187, v187, v207
    v_mfma_f32_16x16x32_bf16 v[164:167], a[188:191], v[60:63], v[164:167]
    v_add_f32 v188, v188, v208
    v_add_f32 v189, v189, v209
    v_mfma_f32_16x16x32_bf16 v[168:171], a[132:135], v[48:51], v[168:171]
    v_add_f32 v190, v190, v210
    v_add_f32 v191, v191, v211
    v_mfma_f32_16x16x32_bf16 v[168:171], a[152:155], v[52:55], v[168:171]
    v_add_f32 v192, v192, v212
    v_add_f32 v193, v193, v213
    v_mfma_f32_16x16x32_bf16 v[168:171], a[172:175], v[56:59], v[168:171]
    buffer_load_dwordx4 v248, s[12:15], s41 offen offset:1024 sc1 lds
    v_mfma_f32_16x16x32_bf16 v[168:171], a[192:195], v[60:63], v[168:171]
    v_add_f32 v194, v194, v214
    v_add_f32 v195, v195, v215
    v_mfma_f32_16x16x32_bf16 v[172:175], a[136:139], v[48:51], v[172:175]
    v_add_f32 v196, v196, v216
    v_add_f32 v197, v197, v217
    v_mfma_f32_16x16x32_bf16 v[172:175], a[156:159], v[52:55], v[172:175]
    v_add_f32 v198, v198, v218
    v_add_f32 v199, v199, v219
    v_mfma_f32_16x16x32_bf16 v[172:175], a[176:179], v[56:59], v[172:175]
    v_add_f32 v200, v200, v220
    v_add_f32 v201, v201, v221
    v_mfma_f32_16x16x32_bf16 v[172:175], a[196:199], v[60:63], v[172:175]
    buffer_load_dwordx4 v248, s[12:15], s41 offen offset:2048 sc1 lds
    v_mfma_f32_16x16x32_bf16 v[176:179], a[140:143], v[48:51], v[176:179]
    v_add_f32 v202, v202, v222
    v_add_f32 v203, v203, v223
    v_mfma_f32_16x16x32_bf16 v[176:179], a[160:163], v[52:55], v[176:179]
    ds_read_b128 v[80:83], v254 offset:0
    v_lshlrev_b32 v120, 16, v234
    v_mfma_f32_16x16x32_bf16 v[176:179], a[180:183], v[56:59], v[176:179]
    ds_read_b128 v[100:103], v254 offset:1024
    v_and_b32 v121, 0xffff0000, v234
    v_mfma_f32_16x16x32_bf16 v[176:179], a[200:203], v[60:63], v[176:179]
    ds_read_b128 v[84:87], v254 offset:64
    v_lshlrev_b32 v122, 16, v235
    v_mfma_f32_16x16x32_bf16 v[180:183], a[144:147], v[48:51], v[180:183]
    buffer_load_dwordx4 v248, s[12:15], s41 offen offset:3072 sc1 lds
    v_mfma_f32_16x16x32_bf16 v[180:183], a[164:167], v[52:55], v[180:183]
    ds_read_b128 v[104:107], v254 offset:1088
    v_and_b32 v123, 0xffff0000, v235
    v_mfma_f32_16x16x32_bf16 v[180:183], a[184:187], v[56:59], v[180:183]
    ds_read_b128 v[88:91], v254 offset:128
    v_lshlrev_b32 v124, 16, v236
    v_mfma_f32_16x16x32_bf16 v[180:183], a[204:207], v[60:63], v[180:183]
    s_waitcnt vmcnt(9)
    ds_read_b128 v[108:111], v254 offset:1152
    v_and_b32 v125, 0xffff0000, v236
    v_mfma_f32_16x16x32_bf16 v[164:167], a[48:51], v[64:67], v[164:167]
    s_add_u32 m0, s37, 4096
    ds_read_b128 v[92:95], v254 offset:192
    v_lshlrev_b32 v126, 16, v237
    v_mfma_f32_16x16x32_bf16 v[164:167], a[68:71], v[68:71], v[164:167]
    buffer_load_dwordx4 v249, s[12:15], s41 offen offset:0 sc1 lds
    v_mfma_f32_16x16x32_bf16 v[164:167], a[88:91], v[72:75], v[164:167]
    ds_read_b128 v[112:115], v254 offset:1216
    v_and_b32 v127, 0xffff0000, v237
    v_mfma_f32_16x16x32_bf16 v[164:167], a[108:111], v[76:79], v[164:167]
    ds_read_b128 v[96:99], v255 offset:0
    v_lshlrev_b32 v128, 16, v238
    v_mfma_f32_16x16x32_bf16 v[168:171], a[52:55], v[64:67], v[168:171]
    ds_read_b128 v[116:119], v255 offset:1024
    v_and_b32 v129, 0xffff0000, v238
    v_mfma_f32_16x16x32_bf16 v[168:171], a[72:75], v[68:71], v[168:171]
    v_lshlrev_b32 v130, 16, v239
    v_and_b32 v131, 0xffff0000, v239
    v_mfma_f32_16x16x32_bf16 v[168:171], a[92:95], v[72:75], v[168:171]
    buffer_load_dwordx4 v249, s[12:15], s41 offen offset:1024 sc1 lds
    v_mfma_f32_16x16x32_bf16 v[168:171], a[112:115], v[76:79], v[168:171]
    v_lshlrev_b32 v132, 16, v240
    v_and_b32 v133, 0xffff0000, v240
    v_mfma_f32_16x16x32_bf16 v[172:175], a[56:59], v[64:67], v[172:175]
    v_lshlrev_b32 v134, 16, v241
    v_and_b32 v135, 0xffff0000, v241
    v_mfma_f32_16x16x32_bf16 v[172:175], a[76:79], v[68:71], v[172:175]
    v_lshlrev_b32 v136, 16, v242
    v_and_b32 v137, 0xffff0000, v242
    v_mfma_f32_16x16x32_bf16 v[172:175], a[96:99], v[72:75], v[172:175]
    v_lshlrev_b32 v138, 16, v243
    v_and_b32 v139, 0xffff0000, v243
    v_mfma_f32_16x16x32_bf16 v[172:175], a[116:119], v[76:79], v[172:175]
    buffer_load_dwordx4 v249, s[12:15], s41 offen offset:2048 sc1 lds
    v_mfma_f32_16x16x32_bf16 v[176:179], a[60:63], v[64:67], v[176:179]
    v_mfma_f32_16x16x32_bf16 v[176:179], a[80:83], v[68:71], v[176:179]
    v_mfma_f32_16x16x32_bf16 v[176:179], a[100:103], v[72:75], v[176:179]
    v_mfma_f32_16x16x32_bf16 v[176:179], a[120:123], v[76:79], v[176:179]
    s_mov_b32 s41, 28672
    s_add_u32 m0, s37, 28672
    v_mfma_f32_16x16x32_bf16 v[180:183], a[64:67], v[64:67], v[180:183]
    buffer_load_dwordx4 v248, s[12:15], s41 offen offset:0 sc1 lds
    v_mfma_f32_16x16x32_bf16 v[180:183], a[84:87], v[68:71], v[180:183]
    v_mfma_f32_16x16x32_bf16 v[180:183], a[104:107], v[72:75], v[180:183]
    v_mfma_f32_16x16x32_bf16 v[180:183], a[124:127], v[76:79], v[180:183]
Lp2e:
    s_waitcnt vmcnt(8) lgkmcnt(0)
    v_pk_add_f32 v[184:185], v[184:185], v[144:145]
    v_pk_add_f32 v[186:187], v[186:187], v[146:147]
    v_pk_add_f32 v[188:189], v[188:189], v[148:149]
    v_pk_add_f32 v[190:191], v[190:191], v[150:151]
    v_pk_add_f32 v[192:193], v[192:193], v[152:153]
    v_pk_add_f32 v[194:195], v[194:195], v[154:155]
    v_pk_add_f32 v[196:197], v[196:197], v[156:157]
    v_pk_add_f32 v[198:199], v[198:199], v[158:159]
    buffer_load_dwordx4 v248, s[12:15], s41 offen offset:1024 sc1 lds
    v_pk_add_f32 v[200:201], v[200:201], v[160:161]
    v_pk_add_f32 v[202:203], v[202:203], v[162:163]
    v_pk_add_f32 v[164:165], v[164:165], v[184:185]
    v_pk_add_f32 v[166:167], v[166:167], v[186:187]
    v_pk_add_f32 v[168:169], v[168:169], v[188:189]
    v_pk_add_f32 v[170:171], v[170:171], v[190:191]
    v_pk_add_f32 v[172:173], v[172:173], v[192:193]
    v_pk_add_f32 v[174:175], v[174:175], v[194:195]
    buffer_load_dwordx4 v248, s[12:15], s41 offen offset:2048 sc1 lds
    v_pk_add_f32 v[176:177], v[176:177], v[196:197]
    v_pk_add_f32 v[178:179], v[178:179], v[198:199]
    v_pk_add_f32 v[180:181], v[180:181], v[200:201]
    v_pk_add_f32 v[182:183], v[182:183], v[202:203]
    v_pk_fma_f32 v[164:165], v[164:165], v[80:81], v[120:121]
    v_pk_fma_f32 v[166:167], v[166:167], v[82:83], v[122:123]
    v_pk_fma_f32 v[168:169], v[168:169], v[84:85], v[124:125]
    v_pk_fma_f32 v[170:171], v[170:171], v[86:87], v[126:127]
    buffer_load_dwordx4 v248, s[12:15], s41 offen offset:3072 sc1 lds
    v_pk_fma_f32 v[172:173], v[172:173], v[88:89], v[128:129]
    v_pk_fma_f32 v[174:175], v[174:175], v[90:91], v[130:131]
    v_pk_fma_f32 v[176:177], v[176:177], v[92:93], v[132:133]
    v_pk_fma_f32 v[178:179], v[178:179], v[94:95], v[134:135]
    v_pk_fma_f32 v[180:181], v[180:181], v[96:97], v[136:137]
    v_pk_fma_f32 v[182:183], v[182:183], v[98:99], v[138:139]
    v_cvt_pk_bf16_f32 v234, v164, v165
    v_cvt_pk_bf16_f32 v235, v166, v167
    s_add_u32 m0, s37, 32768
    s_nop 0
    buffer_load_dwordx4 v249, s[12:15], s41 offen offset:0 sc1 lds
    v_cvt_pk_bf16_f32 v236, v168, v169
    v_cvt_pk_bf16_f32 v237, v170, v171
    v_cvt_pk_bf16_f32 v238, v172, v173
    v_cvt_pk_bf16_f32 v239, v174, v175
    v_cvt_pk_bf16_f32 v240, v176, v177
    v_cvt_pk_bf16_f32 v241, v178, v179
    v_cvt_pk_bf16_f32 v242, v180, v181
    v_cvt_pk_bf16_f32 v243, v182, v183
    buffer_load_dwordx4 v249, s[12:15], s41 offen offset:1024 sc1 lds
    v_lshlrev_b32 v164, 16, v234
    v_and_b32 v165, 0xffff0000, v234
    v_lshlrev_b32 v166, 16, v235
    v_and_b32 v167, 0xffff0000, v235
    v_lshlrev_b32 v168, 16, v236
    v_and_b32 v169, 0xffff0000, v236
    v_lshlrev_b32 v170, 16, v237
    v_and_b32 v171, 0xffff0000, v237
    buffer_load_dwordx4 v249, s[12:15], s41 offen offset:2048 sc1 lds
    v_lshlrev_b32 v172, 16, v238
    v_and_b32 v173, 0xffff0000, v238
    v_lshlrev_b32 v174, 16, v239
    v_and_b32 v175, 0xffff0000, v239
    v_lshlrev_b32 v176, 16, v240
    v_and_b32 v177, 0xffff0000, v240
    v_lshlrev_b32 v178, 16, v241
    v_and_b32 v179, 0xffff0000, v241
    s_mov_b32 s41, 57344
    s_add_u32 m0, s37, 57344
    s_nop 0
    buffer_load_dwordx4 v248, s[12:15], s41 offen offset:0 sc1 lds
    v_lshlrev_b32 v180, 16, v242
    v_and_b32 v181, 0xffff0000, v242
    v_lshlrev_b32 v182, 16, v243
    v_and_b32 v183, 0xffff0000, v243
    v_pk_mul_f32 v[164:165], v[164:165], v[100:101]
    v_pk_mul_f32 v[166:167], v[166:167], v[102:103]
    v_pk_mul_f32 v[168:169], v[168:169], v[104:105]
    v_pk_mul_f32 v[170:171], v[170:171], v[106:107]
    buffer_load_dwordx4 v248, s[12:15], s41 offen offset:1024 sc1 lds
    v_pk_mul_f32 v[172:173], v[172:173], v[108:109]
    v_pk_mul_f32 v[174:175], v[174:175], v[110:111]
    v_pk_mul_f32 v[176:177], v[176:177], v[112:113]
    v_pk_mul_f32 v[178:179], v[178:179], v[114:115]
    v_pk_mul_f32 v[180:181], v[180:181], v[116:117]
    v_pk_mul_f32 v[182:183], v[182:183], v[118:119]
    v_cvt_pk_bf16_f32 v16, v164, v165
    v_cvt_pk_bf16_f32 v17, v166, v167
    buffer_load_dwordx4 v248, s[12:15], s41 offen offset:2048 sc1 lds
    v_cvt_pk_bf16_f32 v18, v168, v169
    v_cvt_pk_bf16_f32 v19, v170, v171
    v_cvt_pk_bf16_f32 v20, v172, v173
    v_cvt_pk_bf16_f32 v21, v174, v175
    v_cvt_pk_bf16_f32 v22, v176, v177
    v_cvt_pk_bf16_f32 v23, v178, v179
    v_cvt_pk_bf16_f32 v24, v180, v181
    v_cvt_pk_bf16_f32 v25, v182, v183
    buffer_load_dwordx4 v248, s[12:15], s41 offen offset:3072 sc1 lds
    s_lshl_b32 s38, s57, 2
    s_add_u32 s38, s38, s28
    s_mul_i32 s38, s38, 20480
    s_add_u32 s38, s38, 2883584
    s_lshr_b32 s39, s56, 1
    s_mul_i32 s39, s39, 5120
    s_add_u32 s38, s38, s39
    s_mul_i32 s39, s95, 3072
    s_add_u32 m0, s37, 61440
    s_nop 0
    buffer_load_dwordx4 v249, s[12:15], s41 offen offset:0 sc1 lds
    s_add_u32 s36, s38, s39
    s_lshl_b32 s39, s95, 9
    s_add_u32 s38, s38, s39
    v_lshrrev_b32 v7, 1, v5
    buffer_store_dwordx4 v[16:19], v5, s[52:55], s36 offen sc1
    buffer_store_dwordx4 v[20:23], v5, s[52:55], s36 offen offset:1024 sc1
    buffer_store_dwordx2 v[24:25], v7, s[52:55], s38 offen offset:2048 sc1
    v_mov_b32 v7, 0x3f803f80
    buffer_load_dwordx4 v249, s[12:15], s41 offen offset:1024 sc1 lds
    v_dot2_f32_bf16 v8, v234, v7, 0
    v_dot2_f32_bf16 v9, v234, v234, 0
    v_dot2_f32_bf16 v8, v235, v7, v8
    v_dot2_f32_bf16 v9, v235, v235, v9
    v_dot2_f32_bf16 v8, v236, v7, v8
    v_dot2_f32_bf16 v9, v236, v236, v9
    v_dot2_f32_bf16 v8, v237, v7, v8
    v_dot2_f32_bf16 v9, v237, v237, v9
    buffer_load_dwordx4 v249, s[12:15], s41 offen offset:2048 sc1 lds
    v_dot2_f32_bf16 v8, v238, v7, v8
    v_dot2_f32_bf16 v9, v238, v238, v9
    v_dot2_f32_bf16 v8, v239, v7, v8
    v_dot2_f32_bf16 v9, v239, v239, v9
    v_dot2_f32_bf16 v8, v240, v7, v8
    v_dot2_f32_bf16 v9, v240, v240, v9
    v_dot2_f32_bf16 v8, v241, v7, v8
    v_dot2_f32_bf16 v9, v241, v241, v9
    v_dot2_f32_bf16 v8, v242, v7, v8
    v_dot2_f32_bf16 v9, v242, v242, v9
    v_dot2_f32_bf16 v8, v243, v7, v8
    v_dot2_f32_bf16 v9, v243, v243, v9
    v_accvgpr_write_b32 a240, v234
    v_accvgpr_write_b32 a241, v235
    v_accvgpr_write_b32 a242, v236
    v_accvgpr_write_b32 a243, v237
    v_accvgpr_write_b32 a244, v238
    v_accvgpr_write_b32 a245, v239
    v_accvgpr_write_b32 a246, v240
    v_accvgpr_write_b32 a247, v241
    v_accvgpr_write_b32 a248, v242
    v_accvgpr_write_b32 a249, v243
    v_permlane32_swap_b32 v8, v9
    v_add_f32 v8, v8, v9
    v_mov_b32 v9, v8
    s_nop 1
    v_permlane16_swap_b32 v8, v9
    v_add_f32 v8, v8, v9
    v_lshl_add_u32 v9, v2, 4, v3
    v_lshlrev_b32 v9, 3, v9
    v_lshrrev_b32 v7, 5, v1
    v_lshl_add_u32 v9, v7, 2, v9
    s_lshl_b32 s38, s57, 12
    s_lshl_b32 s39, s56, 9
    s_add_u32 s38, s38, s39
    s_add_u32 s38, s38, 2686976
    buffer_store_dword v8, v9, s[52:55], s38 offen sc1
    s_lshl_b32 s36, s57, 2
    s_add_u32 s36, s36, s28
    s_lshl_b32 s36, s36, 3
    s_add_u32 s36, s36, s56
    s_lshl_b32 s36, s36, 7
    s_add_u32 s36, s36, 48627712
    v_mov_b32 v8, s3
    v_and_b32 v9, 31, v1
    v_lshlrev_b32 v9, 2, v9
    s_waitcnt vmcnt(0)
    buffer_store_dword v8, v9, s[52:55], s36 offen sc1
    s_waitcnt vmcnt(2)
    s_barrier
    ds_read_b128 a[0:3], v5 offset:0
    ds_read_b128 a[4:7], v5 offset:1024
    ds_read_b128 a[8:11], v5 offset:2048
    ds_read_b128 a[12:15], v5 offset:3072
    ds_read_b128 a[16:19], v5 offset:4096
    ds_read_b128 a[20:23], v5 offset:5120
    ds_read_b128 a[24:27], v5 offset:6144
    ds_read_b128 a[28:31], v5 offset:7168
    v_mul_u32_u24 v7, 40960, v2
    v_add_u32 v252, v7, v5
    v_add_u32 v253, 20480, v252
    s_mul_i32 s39, s59, 163840
    s_add_u32 s39, s39, 2883584
    s_add_u32 s20, s42, s39
    s_addc_u32 s21, s43, 0
    s_mov_b32 s22, 163840
    s_mov_b32 s23, 0x20000
    s_mul_i32 s39, s59, 442368
    s_add_u32 s39, s39, 8388608
    s_add_u32 s24, s42, s39
    s_addc_u32 s25, s43, 0
    s_mov_b32 s26, 442368
    s_mov_b32 s27, 0x20000
    v_add_u32 v251, 57344, v5
    v_add_u32 v254, 114688, v5
    v_lshrrev_b32 v8, 1, v2
    v_lshlrev_b32 v8, 12, v8
    v_lshl_add_u32 v8, v4, 10, v8
    v_and_b32 v9, 1, v2
    v_lshl_add_u32 v8, v9, 8, v8
    v_lshl_add_u32 v14, v3, 3, v8
    v_lshrrev_b32 v8, 1, v5
    v_sub_u32 v10, v252, v8
    v_sub_u32 v11, v253, v8
    s_lshl_b32 s94, s59, 13
    s_add_u32 s94, s94, 2686976
    v_lshlrev_b32 v255, 7, v3
    s_lshl_b32 s36, s59, 2
    s_add_u32 s36, s36, s28
    s_lshl_b32 s36, s36, 11
    s_add_u32 s36, s36, 48627712
    s_mul_i32 s90, s58, 448
    s_mul_i32 s91, s28, 6912
    s_add_u32 s90, s90, s91
    s_add_u32 s90, s90, 2658304
    s_lshl_b32 s91, s28, 10
    s_lshl_b32 s39, s95, 6
    s_add_u32 s39, s39, 143360
    v_add_u32 v12, s39, v6
    s_mul_i32 s39, s96, 96
    s_add_u32 s39, s39, 143360
    v_add_u32 v13, s39, v6
    v_mul_u32_u24 v7, 573440, v2
    v_add_u32 v7, v7, v5
    s_lshl_b32 s39, s95, 10
    v_add_u32 v8, s39, v7
    s_lshl_b32 s39, s96, 10
    v_add_u32 v9, s39, v7
    s_mul_i32 s39, s56, 5120
    s_add_u32 s38, s39, 39845888
    s_sub_u32 s18, 2211840, s39
    s_mov_b32 s19, 0x20000
    s_add_u32 s16, s42, s38
    s_addc_u32 s17, s43, 0
    s_add_u32 m0, s91, 143360
    v_lshlrev_b32 v7, 2, v0
    buffer_load_dwordx4 v5, s[52:55], s90 offen sc1 lds
    s_lshr_b32 s91, s91, 2
    s_add_u32 m0, s91, 147456
    s_nop 0
    buffer_load_dword v7, s[52:55], s62 offen sc1 lds
    s_mov_b32 s41, 86016
    s_add_u32 m0, s37, 86016
    s_nop 0
    buffer_load_dwordx4 v248, s[12:15], s41 offen offset:0 sc1 lds
    buffer_load_dwordx4 v248, s[12:15], s41 offen offset:1024 sc1 lds
    buffer_load_dwordx4 v248, s[12:15], s41 offen offset:2048 sc1 lds
    buffer_load_dwordx4 v248, s[12:15], s41 offen offset:3072 sc1 lds
    s_add_u32 m0, s37, 90112
    s_nop 0
    buffer_load_dwordx4 v249, s[12:15], s41 offen offset:0 sc1 lds
    buffer_load_dwordx4 v249, s[12:15], s41 offen offset:1024 sc1 lds
    buffer_load_dwordx4 v249, s[12:15], s41 offen offset:2048 sc1 lds
    s_mov_b32 s41, 114688
    s_add_u32 m0, s37, 114688
    s_nop 0
    buffer_load_dwordx4 v248, s[12:15], s41 offen offset:0 sc1 lds
    buffer_load_dwordx4 v248, s[12:15], s41 offen offset:1024 sc1 lds
    buffer_load_dwordx4 v248, s[12:15], s41 offen offset:2048 sc1 lds
    buffer_load_dwordx4 v248, s[12:15], s41 offen offset:3072 sc1 lds
    s_add_u32 m0, s37, 118784
    s_nop 0
    buffer_load_dwordx4 v249, s[12:15], s41 offen offset:0 sc1 lds
    buffer_load_dwordx4 v249, s[12:15], s41 offen offset:1024 sc1 lds
    buffer_load_dwordx4 v249, s[12:15], s41 offen offset:2048 sc1 lds
    s_mov_b32 s34, 0
    buffer_load_dwordx4 a[208:211], v8, s[16:19], s34 offen offset:0 sc1
    buffer_load_dwordx4 a[212:215], v8, s[16:19], s34 offen offset:1024 sc1
    buffer_load_dwordx4 a[216:219], v8, s[16:19], s34 offen offset:2048 sc1
    buffer_load_dwordx4 a[220:223], v8, s[16:19], s34 offen offset:3072 sc1
    buffer_load_dword v15, v255, s[52:55], s36 offen sc1
    buffer_load_dwordx4 a[224:227], v9, s[16:19], s34 offen offset:0 sc1
    s_mov_b32 s35, 40960
    buffer_load_dwordx4 a[228:231], v8, s[16:19], s35 offen offset:0 sc1
    buffer_load_dwordx4 a[232:235], v8, s[16:19], s35 offen offset:1024 sc1
    buffer_load_dwordx4 a[236:239], v8, s[16:19], s35 offen offset:2048 sc1
    buffer_load_dwordx4 v[160:163], v8, s[16:19], s35 offen offset:3072 sc1
    buffer_load_dwordx4 v[164:167], v9, s[16:19], s35 offen offset:0 sc1
    s_mov_b32 s34, 163840
    buffer_load_dwordx4 v[168:171], v8, s[16:19], s34 offen offset:0 sc1
    buffer_load_dwordx4 v[172:175], v8, s[16:19], s34 offen offset:1024 sc1
    buffer_load_dwordx4 v[176:179], v8, s[16:19], s34 offen offset:2048 sc1
    buffer_load_dwordx4 v[180:183], v8, s[16:19], s34 offen offset:3072 sc1
    s_waitcnt vmcnt(10)
    v_cmp_ne_u32 vcc, s3, v15
    s_nop 1
    s_cbranch_vccz Lp2_ok
    s_mov_b32 s33, 0
Lp2:
    buffer_load_dword v15, v255, s[52:55], s36 offen sc1
    s_add_u32 s33, s33, 1
    s_waitcnt vmcnt(0)
    v_cmp_ne_u32 vcc, s3, v15
    s_nop 1
    s_cbranch_vccz Lp2_ok
    s_cmp_gt_u32 s33, 0x10000
    s_cbranch_scc1 Lp2_ok
    s_branch Lp2
Lp2_ok:
    buffer_load_dwordx4 a[48:51], v252, s[20:23], s44 offen offset:0 sc1
    buffer_load_dwordx4 a[52:55], v253, s[20:23], s44 offen offset:0 sc1
    buffer_load_dwordx4 a[56:59], v252, s[20:23], s44 offen offset:1024 sc1
    buffer_load_dwordx4 a[60:63], v253, s[20:23], s44 offen offset:1024 sc1
    buffer_load_dwordx2 v[240:241], v14, s[52:55], s94 offen offset:0 sc1
    buffer_load_dwordx2 v[242:243], v14, s[52:55], s94 offen offset:512 sc1
    buffer_load_dwordx2 v[244:245], v14, s[52:55], s94 offen offset:128 sc1
    buffer_load_dwordx2 v[246:247], v14, s[52:55], s94 offen offset:640 sc1
    buffer_load_dwordx2 a[64:65], v10, s[20:23], s44 offen offset:2048 sc1
    buffer_load_dwordx2 a[66:67], v10, s[20:23], s44 offen offset:2560 sc1
    buffer_load_dwordx2 a[68:69], v11, s[20:23], s44 offen offset:2048 sc1
    buffer_load_dwordx2 a[70:71], v11, s[20:23], s44 offen offset:2560 sc1
    buffer_load_dwordx4 a[72:75], v252, s[20:23], s44 offen offset:3072 sc1
    buffer_load_dwordx4 a[76:79], v253, s[20:23], s44 offen offset:3072 sc1
    buffer_load_dwordx4 a[80:83], v252, s[20:23], s45 offen offset:0 sc1
    buffer_load_dwordx4 a[84:87], v253, s[20:23], s45 offen offset:0 sc1
    buffer_load_dwordx4 a[88:91], v252, s[20:23], s45 offen offset:1024 sc1
    buffer_load_dwordx4 a[92:95], v253, s[20:23], s45 offen offset:1024 sc1
    s_waitcnt vmcnt(14) lgkmcnt(0)
    v_mfma_f32_16x16x32_bf16 v[16:19], a[0:3], a[48:51], 0
    ds_read_b128 a[32:35], v5 offset:8192
    v_mfma_f32_16x16x32_bf16 v[16:19], a[4:7], a[56:59], v[16:19]
    v_mfma_f32_16x16x32_bf16 v[48:51], a[4:7], a[60:63], 0
    ds_read_b128 a[36:39], v5 offset:9216
    v_mfma_f32_16x16x32_bf16 v[48:51], a[0:3], a[52:55], v[48:51]
    s_waitcnt lgkmcnt(15)
    v_mfma_f32_16x16x32_bf16 v[20:23], a[8:11], a[48:51], 0
    ds_read_b128 a[40:43], v5 offset:10240
    v_mfma_f32_16x16x32_bf16 v[20:23], a[12:15], a[56:59], v[20:23]
    buffer_load_dwordx4 a[96:99], v252, s[20:23], s45 offen offset:2048 sc1
    v_mfma_f32_16x16x32_bf16 v[52:55], a[12:15], a[60:63], 0
    ds_read_b128 a[44:47], v5 offset:11264
    v_mfma_f32_16x16x32_bf16 v[52:55], a[8:11], a[52:55], v[52:55]
    s_waitcnt lgkmcnt(15)
    v_mfma_f32_16x16x32_bf16 v[24:27], a[16:19], a[48:51], 0
    ds_read_b128 a[0:3], v5 offset:12288
    v_mfma_f32_16x16x32_bf16 v[24:27], a[20:23], a[56:59], v[24:27]
    buffer_load_dwordx4 a[100:103], v253, s[20:23], s45 offen offset:2048 sc1
    v_mfma_f32_16x16x32_bf16 v[56:59], a[20:23], a[60:63], 0
    ds_read_b128 a[4:7], v5 offset:13312
    v_mfma_f32_16x16x32_bf16 v[56:59], a[16:19], a[52:55], v[56:59]
    s_waitcnt lgkmcnt(15)
    v_mfma_f32_16x16x32_bf16 v[28:31], a[24:27], a[48:51], 0
    ds_read_b128 a[8:11], v5 offset:14336
    v_mfma_f32_16x16x32_bf16 v[28:31], a[28:31], a[56:59], v[28:31]
    buffer_load_dwordx2 a[104:105], v10, s[20:23], s45 offen offset:3072 sc1
    v_mfma_f32_16x16x32_bf16 v[60:63], a[28:31], a[60:63], 0
    ds_read_b128 a[12:15], v5 offset:15360
    v_mfma_f32_16x16x32_bf16 v[60:63], a[24:27], a[52:55], v[60:63]
    s_waitcnt lgkmcnt(6)
    v_mfma_f32_16x16x32_bf16 v[32:35], a[32:35], a[48:51], 0
    ds_read_b128 a[16:19], v5 offset:16384
    v_mfma_f32_16x16x32_bf16 v[32:35], a[36:39], a[56:59], v[32:35]
    v_mfma_f32_16x16x32_bf16 v[64:67], a[36:39], a[60:63], 0
    ds_read_b128 a[20:23], v5 offset:17408
    v_mfma_f32_16x16x32_bf16 v[64:67], a[32:35], a[52:55], v[64:67]
    s_waitcnt lgkmcnt(6)
    v_mfma_f32_16x16x32_bf16 v[36:39], a[40:43], a[48:51], 0
    ds_read_b128 a[24:27], v5 offset:18432
    v_mfma_f32_16x16x32_bf16 v[36:39], a[44:47], a[56:59], v[36:39]
    buffer_load_dwordx2 a[106:107], v10, s[20:23], s45 offen offset:3584 sc1
    v_mfma_f32_16x16x32_bf16 v[68:71], a[44:47], a[60:63], 0
    ds_read_b128 a[28:31], v5 offset:19456
    v_mfma_f32_16x16x32_bf16 v[68:71], a[40:43], a[52:55], v[68:71]
    s_waitcnt lgkmcnt(6)
    v_mfma_f32_16x16x32_bf16 v[40:43], a[0:3], a[48:51], 0
    ds_read_b128 a[32:35], v5 offset:20480
    v_mfma_f32_16x16x32_bf16 v[40:43], a[4:7], a[56:59], v[40:43]
    buffer_load_dwordx2 a[108:109], v11, s[20:23], s45 offen offset:3072 sc1
    v_mfma_f32_16x16x32_bf16 v[72:75], a[4:7], a[60:63], 0
    ds_read_b128 a[36:39], v5 offset:21504
    v_mfma_f32_16x16x32_bf16 v[72:75], a[0:3], a[52:55], v[72:75]
    s_waitcnt lgkmcnt(6)
    v_mfma_f32_16x16x32_bf16 v[44:47], a[8:11], a[48:51], 0
    ds_read_b128 a[40:43], v5 offset:22528
    v_mfma_f32_16x16x32_bf16 v[44:47], a[12:15], a[56:59], v[44:47]
    buffer_load_dwordx2 a[110:111], v11, s[20:23], s45 offen offset:3584 sc1
    v_mfma_f32_16x16x32_bf16 v[76:79], a[12:15], a[60:63], 0
    ds_read_b128 a[44:47], v5 offset:23552
    v_mfma_f32_16x16x32_bf16 v[76:79], a[8:11], a[52:55], v[76:79]
    s_waitcnt vmcnt(10) lgkmcnt(6)
    v_mfma_f32_16x16x32_bf16 v[16:19], a[16:19], a[64:67], v[16:19]
    ds_read_b128 a[0:3], v5 offset:24576
    v_add_f32 v240, v240, v242
    v_mfma_f32_16x16x32_bf16 v[16:19], a[20:23], a[72:75], v[16:19]
    v_add_f32 v241, v241, v243
    v_mfma_f32_16x16x32_bf16 v[48:51], a[20:23], a[76:79], v[48:51]
    ds_read_b128 a[4:7], v5 offset:25600
    v_mov_b32 v242, v240
    v_mfma_f32_16x16x32_bf16 v[48:51], a[16:19], a[68:71], v[48:51]
    s_waitcnt lgkmcnt(6)
    v_mov_b32 v243, v241
    v_mfma_f32_16x16x32_bf16 v[20:23], a[24:27], a[64:67], v[20:23]
    ds_read_b128 a[8:11], v5 offset:26624
    v_mfma_f32_16x16x32_bf16 v[20:23], a[28:31], a[72:75], v[20:23]
    buffer_load_dwordx4 a[112:115], v252, s[20:23], s46 offen offset:0 sc1
    v_mfma_f32_16x16x32_bf16 v[52:55], a[28:31], a[76:79], v[52:55]
    ds_read_b128 a[12:15], v5 offset:27648
    v_permlane32_swap_b32 v240, v242
    v_mfma_f32_16x16x32_bf16 v[52:55], a[24:27], a[68:71], v[52:55]
    s_waitcnt lgkmcnt(6)
    v_mfma_f32_16x16x32_bf16 v[24:27], a[32:35], a[64:67], v[24:27]
    ds_read_b128 a[16:19], v5 offset:28672
    v_permlane32_swap_b32 v241, v243
    v_mfma_f32_16x16x32_bf16 v[24:27], a[36:39], a[72:75], v[24:27]
    buffer_load_dwordx4 a[116:119], v253, s[20:23], s46 offen offset:0 sc1
    v_mfma_f32_16x16x32_bf16 v[56:59], a[36:39], a[76:79], v[56:59]
    ds_read_b128 a[20:23], v5 offset:29696
    v_add_f32 v240, v240, v242
    v_mfma_f32_16x16x32_bf16 v[56:59], a[32:35], a[68:71], v[56:59]
    s_waitcnt lgkmcnt(6)
    v_add_f32 v241, v241, v243
    v_mfma_f32_16x16x32_bf16 v[28:31], a[40:43], a[64:67], v[28:31]
    ds_read_b128 a[24:27], v5 offset:30720
    v_mov_b32 v242, v240
    v_mfma_f32_16x16x32_bf16 v[28:31], a[44:47], a[72:75], v[28:31]
    buffer_load_dwordx4 a[120:123], v252, s[20:23], s46 offen offset:1024 sc1
    v_mfma_f32_16x16x32_bf16 v[60:63], a[44:47], a[76:79], v[60:63]
    ds_read_b128 a[28:31], v5 offset:31744
    v_mov_b32 v243, v241
    v_mfma_f32_16x16x32_bf16 v[60:63], a[40:43], a[68:71], v[60:63]
    s_waitcnt lgkmcnt(6)
    v_mfma_f32_16x16x32_bf16 v[32:35], a[0:3], a[64:67], v[32:35]
    ds_read_b128 a[32:35], v5 offset:32768
    v_permlane16_swap_b32 v240, v242
    v_mfma_f32_16x16x32_bf16 v[32:35], a[4:7], a[72:75], v[32:35]
    v_mfma_f32_16x16x32_bf16 v[64:67], a[4:7], a[76:79], v[64:67]
    ds_read_b128 a[36:39], v5 offset:33792
    v_permlane16_swap_b32 v241, v243
    v_mfma_f32_16x16x32_bf16 v[64:67], a[0:3], a[68:71], v[64:67]
    s_waitcnt lgkmcnt(6)
    s_barrier
    v_add_f32 v240, v240, v242
    v_mfma_f32_16x16x32_bf16 v[36:39], a[8:11], a[64:67], v[36:39]
    ds_read_b128 a[40:43], v5 offset:34816
    v_add_f32 v241, v241, v243
    v_mfma_f32_16x16x32_bf16 v[36:39], a[12:15], a[72:75], v[36:39]
    buffer_load_dwordx4 a[124:127], v253, s[20:23], s46 offen offset:1024 sc1
    v_mfma_f32_16x16x32_bf16 v[68:71], a[12:15], a[76:79], v[68:71]
    ds_read_b128 a[44:47], v5 offset:35840
    v_mul_f32 v240, 0xbacccccd, v240
    v_mfma_f32_16x16x32_bf16 v[68:71], a[8:11], a[68:71], v[68:71]
    s_waitcnt lgkmcnt(6)
    v_mul_f32 v241, 0x3acccccd, v241
    v_mfma_f32_16x16x32_bf16 v[40:43], a[16:19], a[64:67], v[40:43]
    ds_read_b128 a[0:3], v5 offset:36864
    v_fma_f32 v241, -v240, v240, v241
    v_mfma_f32_16x16x32_bf16 v[40:43], a[20:23], a[72:75], v[40:43]
    buffer_load_dwordx4 a[128:131], v252, s[20:23], s46 offen offset:2048 sc1
    v_mfma_f32_16x16x32_bf16 v[72:75], a[20:23], a[76:79], v[72:75]
    ds_read_b128 a[4:7], v5 offset:37888
    v_max_f32 v241, 0, v241
    v_mfma_f32_16x16x32_bf16 v[72:75], a[16:19], a[68:71], v[72:75]
    s_waitcnt lgkmcnt(6)
    v_add_f32 v241, 0x3727c5ac, v241
    v_mfma_f32_16x16x32_bf16 v[44:47], a[24:27], a[64:67], v[44:47]
    ds_read_b128 a[8:11], v5 offset:38912
    v_mfma_f32_16x16x32_bf16 v[44:47], a[28:31], a[72:75], v[44:47]
    buffer_load_dwordx4 a[132:135], v253, s[20:23], s46 offen offset:2048 sc1
    v_mfma_f32_16x16x32_bf16 v[76:79], a[28:31], a[76:79], v[76:79]
    ds_read_b128 a[12:15], v5 offset:39936
    v_mfma_f32_16x16x32_bf16 v[76:79], a[24:27], a[68:71], v[76:79]
    s_waitcnt vmcnt(12) lgkmcnt(6)
    v_rcp_f32 v242, v241
    v_mfma_f32_16x16x32_bf16 v[16:19], a[32:35], a[80:83], v[16:19]
    ds_read_b128 a[16:19], v5 offset:40960
    v_mfma_f32_16x16x32_bf16 v[16:19], a[36:39], a[88:91], v[16:19]
    v_sqrt_f32 v243, v241
    v_mfma_f32_16x16x32_bf16 v[48:51], a[36:39], a[92:95], v[48:51]
    ds_read_b128 a[20:23], v5 offset:41984
    v_add_f32 v244, v244, v246
    v_mfma_f32_16x16x32_bf16 v[48:51], a[32:35], a[84:87], v[48:51]
    s_waitcnt lgkmcnt(6)
    v_add_f32 v245, v245, v247
    v_mfma_f32_16x16x32_bf16 v[20:23], a[40:43], a[80:83], v[20:23]
    ds_read_b128 a[24:27], v5 offset:43008
    v_mov_b32 v246, v244
    v_mfma_f32_16x16x32_bf16 v[20:23], a[44:47], a[88:91], v[20:23]
    buffer_load_dwordx4 a[136:139], v252, s[20:23], s46 offen offset:3072 sc1
    v_mfma_f32_16x16x32_bf16 v[52:55], a[44:47], a[92:95], v[52:55]
    ds_read_b128 a[28:31], v5 offset:44032
    v_mov_b32 v247, v245
    v_mfma_f32_16x16x32_bf16 v[52:55], a[40:43], a[84:87], v[52:55]
    s_waitcnt lgkmcnt(6)
    v_mfma_f32_16x16x32_bf16 v[24:27], a[0:3], a[80:83], v[24:27]
    ds_read_b128 a[32:35], v5 offset:45056
    v_permlane32_swap_b32 v244, v246
    v_mfma_f32_16x16x32_bf16 v[24:27], a[4:7], a[88:91], v[24:27]
    ds_read_b128 v[144:147], v12 offset:256
    v_mfma_f32_16x16x32_bf16 v[56:59], a[4:7], a[92:95], v[56:59]
    ds_read_b128 a[36:39], v5 offset:46080
    v_permlane32_swap_b32 v245, v247
    v_mfma_f32_16x16x32_bf16 v[56:59], a[0:3], a[84:87], v[56:59]
    s_waitcnt lgkmcnt(7)
    ds_read_b128 v[148:151], v12 offset:2304
    v_add_f32 v244, v244, v246
    v_mfma_f32_16x16x32_bf16 v[28:31], a[8:11], a[80:83], v[28:31]
    ds_read_b128 a[40:43], v5 offset:47104
    v_add_f32 v245, v245, v247
    v_mfma_f32_16x16x32_bf16 v[28:31], a[12:15], a[88:91], v[28:31]
    buffer_load_dwordx4 a[140:143], v253, s[20:23], s46 offen offset:3072 sc1
    v_mfma_f32_16x16x32_bf16 v[60:63], a[12:15], a[92:95], v[60:63]
    ds_read_b128 a[44:47], v5 offset:48128
    v_mov_b32 v246, v244
    v_mfma_f32_16x16x32_bf16 v[60:63], a[8:11], a[84:87], v[60:63]
    s_waitcnt lgkmcnt(8)
    buffer_load_dwordx2 a[144:145], v10, s[20:23], s47 offen offset:0 sc1
    v_mfma_f32_16x16x32_bf16 v[32:35], a[16:19], a[80:83], v[32:35]
    ds_read_b128 a[0:3], v5 offset:49152
    v_mov_b32 v247, v245
    v_mfma_f32_16x16x32_bf16 v[32:35], a[20:23], a[88:91], v[32:35]
    ds_read_b128 v[128:131], v12 offset:0
    v_mfma_f32_16x16x32_bf16 v[64:67], a[20:23], a[92:95], v[64:67]
    ds_read_b128 a[4:7], v5 offset:50176
    v_permlane16_swap_b32 v244, v246
    v_mfma_f32_16x16x32_bf16 v[64:67], a[16:19], a[84:87], v[64:67]
    s_waitcnt lgkmcnt(9)
    ds_read_b128 v[132:135], v12 offset:2048
    v_mfma_f32_16x16x32_bf16 v[36:39], a[24:27], a[80:83], v[36:39]
    ds_read_b128 a[8:11], v5 offset:51200
    v_permlane16_swap_b32 v245, v247
    v_mfma_f32_16x16x32_bf16 v[36:39], a[28:31], a[88:91], v[36:39]
    buffer_load_dwordx2 a[146:147], v10, s[20:23], s47 offen offset:512 sc1
    v_mfma_f32_16x16x32_bf16 v[68:71], a[28:31], a[92:95], v[68:71]
    ds_read_b128 a[12:15], v5 offset:52224
    v_add_f32 v244, v244, v246
    v_mfma_f32_16x16x32_bf16 v[68:71], a[24:27], a[84:87], v[68:71]
    s_waitcnt lgkmcnt(9)
    v_add_f32 v245, v245, v247
    v_mfma_f32_16x16x32_bf16 v[40:43], a[32:35], a[80:83], v[40:43]
    ds_read_b128 a[16:19], v5 offset:53248
    v_mul_f32 v244, 0xbacccccd, v244
    v_mfma_f32_16x16x32_bf16 v[40:43], a[36:39], a[88:91], v[40:43]
    buffer_load_dwordx2 a[148:149], v11, s[20:23], s47 offen offset:0 sc1
    v_mfma_f32_16x16x32_bf16 v[72:75], a[36:39], a[92:95], v[72:75]
    ds_read_b128 a[20:23], v5 offset:54272
    v_mul_f32 v245, 0x3acccccd, v245
    v_mfma_f32_16x16x32_bf16 v[72:75], a[32:35], a[84:87], v[72:75]
    s_waitcnt lgkmcnt(8)
    v_fma_f32 v245, -v244, v244, v245
    v_mfma_f32_16x16x32_bf16 v[44:47], a[40:43], a[80:83], v[44:47]
    ds_read_b128 a[24:27], v5 offset:55296
    v_max_f32 v245, 0, v245
    v_mfma_f32_16x16x32_bf16 v[44:47], a[44:47], a[88:91], v[44:47]
    buffer_load_dwordx2 a[150:151], v11, s[20:23], s47 offen offset:512 sc1
    v_mfma_f32_16x16x32_bf16 v[76:79], a[44:47], a[92:95], v[76:79]
    ds_read_b128 a[28:31], v5 offset:56320
    v_add_f32 v245, 0x3727c5ac, v245
    v_mfma_f32_16x16x32_bf16 v[76:79], a[40:43], a[84:87], v[76:79]
    s_waitcnt vmcnt(12) lgkmcnt(7)
    v_rcp_f32 v246, v245
    v_mfma_f32_16x16x32_bf16 v[16:19], a[0:3], a[96:99], v[16:19]
    ds_read_b128 a[32:35], v251 offset:0
    v_sqrt_f32 v247, v245
    v_mfma_f32_16x16x32_bf16 v[16:19], a[4:7], a[104:107], v[16:19]
    v_mul_f32 v80, v144, v240
    v_mul_f32 v81, v145, v240
    v_mfma_f32_16x16x32_bf16 v[48:51], a[4:7], a[108:111], v[48:51]
    ds_read_b128 a[36:39], v251 offset:1024
    v_mul_f32 v82, v146, v240
    v_mfma_f32_16x16x32_bf16 v[48:51], a[0:3], a[100:103], v[48:51]
    s_waitcnt lgkmcnt(6)
    v_mul_f32 v83, v147, v240
    v_mul_f32 v104, v144, v244
    v_mfma_f32_16x16x32_bf16 v[20:23], a[8:11], a[96:99], v[20:23]
    ds_read_b128 a[40:43], v251 offset:2048
    v_mul_f32 v105, v145, v244
    v_mfma_f32_16x16x32_bf16 v[20:23], a[12:15], a[104:107], v[20:23]
    buffer_load_dwordx4 a[152:155], v252, s[20:23], s47 offen offset:1024 sc1
    v_mfma_f32_16x16x32_bf16 v[52:55], a[12:15], a[108:111], v[52:55]
    ds_read_b128 a[44:47], v251 offset:3072
    v_mul_f32 v106, v146, v244
    v_mfma_f32_16x16x32_bf16 v[52:55], a[8:11], a[100:103], v[52:55]
    s_waitcnt lgkmcnt(6)
    v_mul_f32 v107, v147, v244
    v_fmac_f32 v80, v148, v243
    v_mfma_f32_16x16x32_bf16 v[24:27], a[16:19], a[96:99], v[24:27]
    ds_read_b128 a[0:3], v251 offset:4096
    v_fmac_f32 v16, v128, v240
    v_mfma_f32_16x16x32_bf16 v[24:27], a[20:23], a[104:107], v[24:27]
    buffer_load_dwordx4 a[156:159], v253, s[20:23], s47 offen offset:1024 sc1
    v_mfma_f32_16x16x32_bf16 v[56:59], a[20:23], a[108:111], v[56:59]
    ds_read_b128 a[4:7], v251 offset:5120
    v_fmac_f32 v17, v129, v240
    v_mfma_f32_16x16x32_bf16 v[56:59], a[16:19], a[100:103], v[56:59]
    s_waitcnt lgkmcnt(6)
    s_barrier
    v_fmac_f32 v18, v130, v240
    v_fmac_f32 v19, v131, v240
    v_mfma_f32_16x16x32_bf16 v[28:31], a[24:27], a[96:99], v[28:31]
    ds_read_b128 a[8:11], v251 offset:6144
    v_fmac_f32 v48, v128, v244
    v_mfma_f32_16x16x32_bf16 v[28:31], a[28:31], a[104:107], v[28:31]
    ds_read_b128 v[136:139], v12 offset:1216
    v_fmac_f32 v49, v129, v244
    v_mfma_f32_16x16x32_bf16 v[60:63], a[28:31], a[108:111], v[60:63]
    ds_read_b128 a[12:15], v251 offset:7168
    v_fmac_f32 v50, v130, v244
    v_mfma_f32_16x16x32_bf16 v[60:63], a[24:27], a[100:103], v[60:63]
    s_waitcnt lgkmcnt(7)
    ds_read_b128 v[140:143], v12 offset:3264
    v_fmac_f32 v51, v131, v244
    v_mfma_f32_16x16x32_bf16 v[32:35], a[32:35], a[96:99], v[32:35]
    ds_read_b128 a[16:19], v251 offset:8192
    v_fmac_f32 v16, v132, v243
    v_mfma_f32_16x16x32_bf16 v[32:35], a[36:39], a[104:107], v[32:35]
    ds_read_b128 v[152:155], v12 offset:320
    v_fmac_f32 v17, v133, v243
    v_mfma_f32_16x16x32_bf16 v[64:67], a[36:39], a[108:111], v[64:67]
    ds_read_b128 a[20:23], v251 offset:9216
    v_fmac_f32 v18, v134, v243
    v_mfma_f32_16x16x32_bf16 v[64:67], a[32:35], a[100:103], v[64:67]
    s_waitcnt lgkmcnt(9)
    ds_read_b128 v[156:159], v12 offset:2368
    v_fmac_f32 v19, v135, v243
    v_mfma_f32_16x16x32_bf16 v[36:39], a[40:43], a[96:99], v[36:39]
    s_mov_b32 s41, 143360
    s_add_u32 m0, s37, 0
    ds_read_b128 a[24:27], v251 offset:10240
    v_fmac_f32 v48, v132, v247
    v_mfma_f32_16x16x32_bf16 v[36:39], a[44:47], a[104:107], v[36:39]
    buffer_load_dwordx4 v248, s[12:15], s41 offen offset:0 sc1 lds
    v_mfma_f32_16x16x32_bf16 v[68:71], a[44:47], a[108:111], v[68:71]
    ds_read_b128 a[28:31], v251 offset:11264
    v_fmac_f32 v49, v133, v247
    v_mfma_f32_16x16x32_bf16 v[68:71], a[40:43], a[100:103], v[68:71]
    s_waitcnt lgkmcnt(10)
    buffer_load_dwordx4 v248, s[12:15], s41 offen offset:1024 sc1 lds
    v_mfma_f32_16x16x32_bf16 v[40:43], a[0:3], a[96:99], v[40:43]
    ds_read_b128 a[32:35], v251 offset:12288
    v_fmac_f32 v50, v134, v247
    v_mfma_f32_16x16x32_bf16 v[40:43], a[4:7], a[104:107], v[40:43]
    v_fmac_f32 v51, v135, v247
    v_fmac_f32 v81, v149, v243
    v_mfma_f32_16x16x32_bf16 v[72:75], a[4:7], a[108:111], v[72:75]
    ds_read_b128 a[36:39], v251 offset:13312
    v_fmac_f32 v82, v150, v243
    v_mfma_f32_16x16x32_bf16 v[72:75], a[0:3], a[100:103], v[72:75]
    s_waitcnt lgkmcnt(9)
    v_fmac_f32 v83, v151, v243
    v_fmac_f32 v104, v148, v247
    v_mfma_f32_16x16x32_bf16 v[44:47], a[8:11], a[96:99], v[44:47]
    ds_read_b128 a[40:43], v251 offset:14336
    v_fmac_f32 v105, v149, v247
    v_mfma_f32_16x16x32_bf16 v[44:47], a[12:15], a[104:107], v[44:47]
    buffer_load_dwordx4 v248, s[12:15], s41 offen offset:2048 sc1 lds
    v_mfma_f32_16x16x32_bf16 v[76:79], a[12:15], a[108:111], v[76:79]
    ds_read_b128 a[44:47], v251 offset:15360
    v_fmac_f32 v106, v150, v247
    v_mfma_f32_16x16x32_bf16 v[76:79], a[8:11], a[100:103], v[76:79]
    s_waitcnt vmcnt(13) lgkmcnt(7)
    v_fmac_f32 v107, v151, v247
    v_mfma_f32_16x16x32_bf16 v[16:19], a[16:19], a[112:115], v[16:19]
    ds_read_b128 a[0:3], v251 offset:16384
    v_mfma_f32_16x16x32_bf16 v[16:19], a[20:23], a[120:123], v[16:19]
    buffer_load_dwordx4 v248, s[12:15], s41 offen offset:3072 sc1 lds
    v_mfma_f32_16x16x32_bf16 v[48:51], a[20:23], a[124:127], v[48:51]
    ds_read_b128 a[4:7], v251 offset:17408
    v_mfma_f32_16x16x32_bf16 v[48:51], a[16:19], a[116:119], v[48:51]
    s_waitcnt lgkmcnt(6)
    v_mfma_f32_16x16x32_bf16 v[20:23], a[24:27], a[112:115], v[20:23]
    s_add_u32 m0, s37, 4096
    ds_read_b128 a[8:11], v251 offset:18432
    v_fmac_f32 v44, v136, v240
    v_mfma_f32_16x16x32_bf16 v[20:23], a[28:31], a[120:123], v[20:23]
    buffer_load_dwordx4 v249, s[12:15], s41 offen offset:0 sc1 lds
    v_mfma_f32_16x16x32_bf16 v[52:55], a[28:31], a[124:127], v[52:55]
    ds_read_b128 a[12:15], v251 offset:19456
    v_fmac_f32 v45, v137, v240
    v_mfma_f32_16x16x32_bf16 v[52:55], a[24:27], a[116:119], v[52:55]
    s_waitcnt lgkmcnt(6)
    v_fmac_f32 v46, v138, v240
    v_fmac_f32 v47, v139, v240
    v_mfma_f32_16x16x32_bf16 v[24:27], a[32:35], a[112:115], v[24:27]
    ds_read_b128 a[16:19], v251 offset:20480
    v_fmac_f32 v76, v136, v244
    v_mfma_f32_16x16x32_bf16 v[24:27], a[36:39], a[120:123], v[24:27]
    ds_read_b128 v[128:131], v12 offset:1152
    v_fmac_f32 v77, v137, v244
    v_mfma_f32_16x16x32_bf16 v[56:59], a[36:39], a[124:127], v[56:59]
    ds_read_b128 a[20:23], v251 offset:21504
    v_fmac_f32 v78, v138, v244
    v_mfma_f32_16x16x32_bf16 v[56:59], a[32:35], a[116:119], v[56:59]
    s_waitcnt lgkmcnt(7)
    ds_read_b128 v[132:135], v12 offset:3200
    v_fmac_f32 v79, v139, v244
    v_mfma_f32_16x16x32_bf16 v[28:31], a[40:43], a[112:115], v[28:31]
    ds_read_b128 a[24:27], v251 offset:22528
    v_fmac_f32 v44, v140, v243
    v_mfma_f32_16x16x32_bf16 v[28:31], a[44:47], a[120:123], v[28:31]
    buffer_load_dwordx4 v249, s[12:15], s41 offen offset:1024 sc1 lds
    v_mfma_f32_16x16x32_bf16 v[60:63], a[44:47], a[124:127], v[60:63]
    ds_read_b128 a[28:31], v251 offset:23552
    v_fmac_f32 v45, v141, v243
    v_mfma_f32_16x16x32_bf16 v[60:63], a[40:43], a[116:119], v[60:63]
    s_waitcnt lgkmcnt(8)
    v_fmac_f32 v46, v142, v243
    v_fmac_f32 v47, v143, v243
    v_mfma_f32_16x16x32_bf16 v[32:35], a[0:3], a[112:115], v[32:35]
    ds_read_b128 a[32:35], v251 offset:24576
    v_fmac_f32 v76, v140, v247
    v_mfma_f32_16x16x32_bf16 v[32:35], a[4:7], a[120:123], v[32:35]
    ds_read_b128 v[144:147], v13 offset:0
    v_fmac_f32 v77, v141, v247
    v_mfma_f32_16x16x32_bf16 v[64:67], a[4:7], a[124:127], v[64:67]
    ds_read_b128 a[36:39], v251 offset:25600
    v_fmac_f32 v78, v142, v247
    v_mfma_f32_16x16x32_bf16 v[64:67], a[0:3], a[116:119], v[64:67]
    s_waitcnt lgkmcnt(9)
    ds_read_b128 v[148:151], v13 offset:2048
    v_fmac_f32 v79, v143, v247
    v_mfma_f32_16x16x32_bf16 v[36:39], a[8:11], a[112:115], v[36:39]
    ds_read_b128 a[40:43], v251 offset:26624
    v_mul_f32 v84, v152, v240
    v_mfma_f32_16x16x32_bf16 v[36:39], a[12:15], a[120:123], v[36:39]
    buffer_load_dwordx4 v249, s[12:15], s41 offen offset:2048 sc1 lds
    v_mfma_f32_16x16x32_bf16 v[68:71], a[12:15], a[124:127], v[68:71]
    ds_read_b128 a[44:47], v251 offset:27648
    v_mul_f32 v85, v153, v240
    v_mfma_f32_16x16x32_bf16 v[68:71], a[8:11], a[116:119], v[68:71]
    s_waitcnt lgkmcnt(9)
    buffer_load_dwordx4 a[160:163], v252, s[20:23], s47 offen offset:2048 sc1
    v_mfma_f32_16x16x32_bf16 v[40:43], a[16:19], a[112:115], v[40:43]
    ds_read_b128 a[0:3], v251 offset:28672
    v_mul_f32 v86, v154, v240
    v_mfma_f32_16x16x32_bf16 v[40:43], a[20:23], a[120:123], v[40:43]
    v_mul_f32 v87, v155, v240
    v_mul_f32 v108, v152, v244
    v_mfma_f32_16x16x32_bf16 v[72:75], a[20:23], a[124:127], v[72:75]
    ds_read_b128 a[4:7], v251 offset:29696
    v_mul_f32 v109, v153, v244
    v_mfma_f32_16x16x32_bf16 v[72:75], a[16:19], a[116:119], v[72:75]
    s_waitcnt lgkmcnt(8)
    v_mul_f32 v110, v154, v244
    v_mul_f32 v111, v155, v244
    v_mfma_f32_16x16x32_bf16 v[44:47], a[24:27], a[112:115], v[44:47]
    ds_read_b128 a[8:11], v251 offset:30720
    v_fmac_f32 v84, v156, v243
    v_mfma_f32_16x16x32_bf16 v[44:47], a[28:31], a[120:123], v[44:47]
    buffer_load_dwordx4 a[164:167], v253, s[20:23], s47 offen offset:2048 sc1
    v_mfma_f32_16x16x32_bf16 v[76:79], a[28:31], a[124:127], v[76:79]
    ds_read_b128 a[12:15], v251 offset:31744
    v_fmac_f32 v85, v157, v243
    v_mfma_f32_16x16x32_bf16 v[76:79], a[24:27], a[116:119], v[76:79]
    s_waitcnt vmcnt(15) lgkmcnt(7)
    buffer_load_dwordx4 a[168:171], v252, s[20:23], s47 offen offset:3072 sc1
    v_mfma_f32_16x16x32_bf16 v[16:19], a[32:35], a[128:131], v[16:19]
    ds_read_b128 a[16:19], v251 offset:32768
    v_fmac_f32 v86, v158, v243
    v_mfma_f32_16x16x32_bf16 v[16:19], a[36:39], a[136:139], v[16:19]
    buffer_load_dwordx4 a[172:175], v253, s[20:23], s47 offen offset:3072 sc1
    v_mfma_f32_16x16x32_bf16 v[48:51], a[36:39], a[140:143], v[48:51]
    ds_read_b128 a[20:23], v251 offset:33792
    v_fmac_f32 v87, v159, v243
    v_mfma_f32_16x16x32_bf16 v[48:51], a[32:35], a[132:135], v[48:51]
    s_waitcnt lgkmcnt(6)
    s_barrier
    v_fmac_f32 v108, v156, v247
    v_fmac_f32 v109, v157, v247
    v_mfma_f32_16x16x32_bf16 v[20:23], a[40:43], a[128:131], v[20:23]
    ds_read_b128 a[24:27], v251 offset:34816
    v_fmac_f32 v110, v158, v247
    v_mfma_f32_16x16x32_bf16 v[20:23], a[44:47], a[136:139], v[20:23]
    ds_read_b128 v[136:139], v12 offset:1088
    v_fmac_f32 v111, v159, v247
    v_mfma_f32_16x16x32_bf16 v[52:55], a[44:47], a[140:143], v[52:55]
    ds_read_b128 a[28:31], v251 offset:35840
    v_fmac_f32 v40, v128, v240
    v_mfma_f32_16x16x32_bf16 v[52:55], a[40:43], a[132:135], v[52:55]
    s_waitcnt lgkmcnt(7)
    ds_read_b128 v[140:143], v12 offset:3136
    v_fmac_f32 v41, v129, v240
    v_mfma_f32_16x16x32_bf16 v[24:27], a[0:3], a[128:131], v[24:27]
    ds_read_b128 a[32:35], v251 offset:36864
    v_fmac_f32 v42, v130, v240
    v_mfma_f32_16x16x32_bf16 v[24:27], a[4:7], a[136:139], v[24:27]
    v_fmac_f32 v43, v131, v240
    v_fmac_f32 v72, v128, v244
    v_mfma_f32_16x16x32_bf16 v[56:59], a[4:7], a[140:143], v[56:59]
    ds_read_b128 a[36:39], v251 offset:37888
    v_fmac_f32 v73, v129, v244
    v_mfma_f32_16x16x32_bf16 v[56:59], a[0:3], a[132:135], v[56:59]
    s_waitcnt lgkmcnt(8)
    v_fmac_f32 v74, v130, v244
    v_fmac_f32 v75, v131, v244
    v_mfma_f32_16x16x32_bf16 v[28:31], a[8:11], a[128:131], v[28:31]
    ds_read_b128 a[40:43], v251 offset:38912
    v_fmac_f32 v40, v132, v243
    v_mfma_f32_16x16x32_bf16 v[28:31], a[12:15], a[136:139], v[28:31]
    buffer_load_dwordx4 a[176:179], v252, s[20:23], s48 offen offset:0 sc1
    v_mfma_f32_16x16x32_bf16 v[60:63], a[12:15], a[140:143], v[60:63]
    ds_read_b128 a[44:47], v251 offset:39936
    v_fmac_f32 v41, v133, v243
    v_mfma_f32_16x16x32_bf16 v[60:63], a[8:11], a[132:135], v[60:63]
    s_waitcnt lgkmcnt(8)
    v_fmac_f32 v42, v134, v243
    v_fmac_f32 v43, v135, v243
    v_mfma_f32_16x16x32_bf16 v[32:35], a[16:19], a[128:131], v[32:35]
    ds_read_b128 a[0:3], v251 offset:40960
    v_fmac_f32 v72, v132, v247
    v_mfma_f32_16x16x32_bf16 v[32:35], a[20:23], a[136:139], v[32:35]
    buffer_load_dwordx4 a[180:183], v253, s[20:23], s48 offen offset:0 sc1
    v_mfma_f32_16x16x32_bf16 v[64:67], a[20:23], a[140:143], v[64:67]
    ds_read_b128 a[4:7], v251 offset:41984
    v_fmac_f32 v73, v133, v247
    v_mfma_f32_16x16x32_bf16 v[64:67], a[16:19], a[132:135], v[64:67]
    s_waitcnt lgkmcnt(7)
    v_fmac_f32 v74, v134, v247
    v_fmac_f32 v75, v135, v247
    v_mfma_f32_16x16x32_bf16 v[36:39], a[24:27], a[128:131], v[36:39]
    ds_read_b128 a[8:11], v251 offset:43008
    v_mul_f32 v88, v144, v240
    v_mfma_f32_16x16x32_bf16 v[36:39], a[28:31], a[136:139], v[36:39]
    ds_read_b128 v[152:155], v12 offset:1280
    v_mul_f32 v89, v145, v240
    v_mfma_f32_16x16x32_bf16 v[68:71], a[28:31], a[140:143], v[68:71]
    ds_read_b128 a[12:15], v251 offset:44032
    v_mul_f32 v90, v146, v240
    v_mfma_f32_16x16x32_bf16 v[68:71], a[24:27], a[132:135], v[68:71]
    s_waitcnt lgkmcnt(7)
    ds_read_b128 v[156:159], v12 offset:3328
    v_mul_f32 v91, v147, v240
    v_mfma_f32_16x16x32_bf16 v[40:43], a[32:35], a[128:131], v[40:43]
    ds_read_b128 a[16:19], v251 offset:45056
    v_mul_f32 v112, v144, v244
    v_mfma_f32_16x16x32_bf16 v[40:43], a[36:39], a[136:139], v[40:43]
    buffer_load_dwordx2 a[184:185], v10, s[20:23], s48 offen offset:1024 sc1
    v_mfma_f32_16x16x32_bf16 v[72:75], a[36:39], a[140:143], v[72:75]
    ds_read_b128 a[20:23], v251 offset:46080
    v_mul_f32 v113, v145, v244
    v_mfma_f32_16x16x32_bf16 v[72:75], a[32:35], a[132:135], v[72:75]
    s_waitcnt lgkmcnt(8)
    v_mul_f32 v114, v146, v244
    v_mul_f32 v115, v147, v244
    v_mfma_f32_16x16x32_bf16 v[44:47], a[40:43], a[128:131], v[44:47]
    ds_read_b128 a[24:27], v251 offset:47104
    v_fmac_f32 v36, v136, v240
    v_mfma_f32_16x16x32_bf16 v[44:47], a[44:47], a[136:139], v[44:47]
    buffer_load_dwordx2 a[186:187], v10, s[20:23], s48 offen offset:1536 sc1
    v_mfma_f32_16x16x32_bf16 v[76:79], a[44:47], a[140:143], v[76:79]
    ds_read_b128 a[28:31], v251 offset:48128
    v_fmac_f32 v37, v137, v240
    v_mfma_f32_16x16x32_bf16 v[76:79], a[40:43], a[132:135], v[76:79]
    s_waitcnt vmcnt(15) lgkmcnt(8)
    buffer_load_dwordx2 a[188:189], v11, s[20:23], s48 offen offset:1024 sc1
    v_mfma_f32_16x16x32_bf16 v[16:19], a[0:3], a[144:147], v[16:19]
    ds_read_b128 a[32:35], v251 offset:49152
    v_fmac_f32 v38, v138, v240
    v_mfma_f32_16x16x32_bf16 v[16:19], a[4:7], a[152:155], v[16:19]
    ds_read_b128 v[128:131], v12 offset:1024
    v_fmac_f32 v39, v139, v240
    v_mfma_f32_16x16x32_bf16 v[48:51], a[4:7], a[156:159], v[48:51]
    ds_read_b128 a[36:39], v251 offset:50176
    v_fmac_f32 v68, v136, v244
    v_mfma_f32_16x16x32_bf16 v[48:51], a[0:3], a[148:151], v[48:51]
    s_waitcnt lgkmcnt(8)
    ds_read_b128 v[132:135], v12 offset:3072
    v_fmac_f32 v69, v137, v244
    v_mfma_f32_16x16x32_bf16 v[20:23], a[8:11], a[144:147], v[20:23]
    ds_read_b128 a[40:43], v251 offset:51200
    v_fmac_f32 v70, v138, v244
    v_mfma_f32_16x16x32_bf16 v[20:23], a[12:15], a[152:155], v[20:23]
    buffer_load_dwordx2 a[190:191], v11, s[20:23], s48 offen offset:1536 sc1
    v_mfma_f32_16x16x32_bf16 v[52:55], a[12:15], a[156:159], v[52:55]
    ds_read_b128 a[44:47], v251 offset:52224
    v_fmac_f32 v71, v139, v244
    v_mfma_f32_16x16x32_bf16 v[52:55], a[8:11], a[148:151], v[52:55]
    s_waitcnt lgkmcnt(8)
    v_fmac_f32 v36, v140, v243
    v_fmac_f32 v37, v141, v243
    v_mfma_f32_16x16x32_bf16 v[24:27], a[16:19], a[144:147], v[24:27]
    ds_read_b128 a[0:3], v251 offset:53248
    v_fmac_f32 v38, v142, v243
    v_mfma_f32_16x16x32_bf16 v[24:27], a[20:23], a[152:155], v[24:27]
    v_fmac_f32 v39, v143, v243
    v_fmac_f32 v68, v140, v247
    v_mfma_f32_16x16x32_bf16 v[56:59], a[20:23], a[156:159], v[56:59]
    ds_read_b128 a[4:7], v251 offset:54272
    v_fmac_f32 v69, v141, v247
    v_mfma_f32_16x16x32_bf16 v[56:59], a[16:19], a[148:151], v[56:59]
    s_waitcnt lgkmcnt(8)
    v_fmac_f32 v70, v142, v247
    v_fmac_f32 v71, v143, v247
    v_mfma_f32_16x16x32_bf16 v[28:31], a[24:27], a[144:147], v[28:31]
    s_mov_b32 s41, 172032
    s_add_u32 m0, s37, 28672
    ds_read_b128 a[8:11], v251 offset:55296
    v_fmac_f32 v88, v148, v243
    v_mfma_f32_16x16x32_bf16 v[28:31], a[28:31], a[152:155], v[28:31]
    buffer_load_dwordx4 v248, s[12:15], s41 offen offset:0 sc1 lds
    v_mfma_f32_16x16x32_bf16 v[60:63], a[28:31], a[156:159], v[60:63]
    ds_read_b128 a[12:15], v251 offset:56320
    v_fmac_f32 v89, v149, v243
    v_mfma_f32_16x16x32_bf16 v[60:63], a[24:27], a[148:151], v[60:63]
    s_waitcnt lgkmcnt(7)
    buffer_load_dwordx4 v248, s[12:15], s41 offen offset:1024 sc1 lds
    v_mfma_f32_16x16x32_bf16 v[32:35], a[32:35], a[144:147], v[32:35]
    ds_read_b128 a[16:19], v254 offset:0
    v_fmac_f32 v90, v150, v243
    v_mfma_f32_16x16x32_bf16 v[32:35], a[36:39], a[152:155], v[32:35]
    buffer_load_dwordx4 v248, s[12:15], s41 offen offset:2048 sc1 lds
    v_mfma_f32_16x16x32_bf16 v[64:67], a[36:39], a[156:159], v[64:67]
    ds_read_b128 a[20:23], v254 offset:1024
    v_fmac_f32 v91, v151, v243
    v_mfma_f32_16x16x32_bf16 v[64:67], a[32:35], a[148:151], v[64:67]
    s_waitcnt lgkmcnt(6)
    buffer_load_dwordx4 v248, s[12:15], s41 offen offset:3072 sc1 lds
    v_mfma_f32_16x16x32_bf16 v[36:39], a[40:43], a[144:147], v[36:39]
    s_add_u32 m0, s37, 32768
    ds_read_b128 a[24:27], v254 offset:2048
    v_fmac_f32 v112, v148, v247
    v_mfma_f32_16x16x32_bf16 v[36:39], a[44:47], a[152:155], v[36:39]
    buffer_load_dwordx4 v249, s[12:15], s41 offen offset:0 sc1 lds
    v_mfma_f32_16x16x32_bf16 v[68:71], a[44:47], a[156:159], v[68:71]
    ds_read_b128 a[28:31], v254 offset:3072
    v_fmac_f32 v113, v149, v247
    v_fmac_f32 v114, v150, v247
    v_fmac_f32 v115, v151, v247
    v_mfma_f32_16x16x32_bf16 v[68:71], a[40:43], a[148:151], v[68:71]
    s_waitcnt lgkmcnt(6)
    buffer_load_dwordx4 v249, s[12:15], s41 offen offset:1024 sc1 lds
    v_mfma_f32_16x16x32_bf16 v[40:43], a[0:3], a[144:147], v[40:43]
    ds_read_b128 a[32:35], v254 offset:4096
    v_fmac_f32 v32, v128, v240
    v_mfma_f32_16x16x32_bf16 v[40:43], a[4:7], a[152:155], v[40:43]
    ds_read_b128 v[144:147], v12 offset:1344
    v_fmac_f32 v33, v129, v240
    v_mfma_f32_16x16x32_bf16 v[72:75], a[4:7], a[156:159], v[72:75]
    ds_read_b128 a[36:39], v254 offset:5120
    v_fmac_f32 v34, v130, v240
    v_mfma_f32_16x16x32_bf16 v[72:75], a[0:3], a[148:151], v[72:75]
    s_waitcnt vmcnt(16) lgkmcnt(7)
    s_barrier
    ds_read_b128 v[148:151], v12 offset:3392
    v_fmac_f32 v35, v131, v240
    v_mfma_f32_16x16x32_bf16 v[44:47], a[8:11], a[144:147], v[44:47]
    ds_read_b128 a[40:43], v254 offset:6144
    v_fmac_f32 v64, v128, v244
    v_mfma_f32_16x16x32_bf16 v[44:47], a[12:15], a[152:155], v[44:47]
    ds_read_b128 v[136:139], v12 offset:192
    v_fmac_f32 v65, v129, v244
    v_mfma_f32_16x16x32_bf16 v[76:79], a[12:15], a[156:159], v[76:79]
    ds_read_b128 a[44:47], v254 offset:7168
    v_fmac_f32 v66, v130, v244
    v_mfma_f32_16x16x32_bf16 v[76:79], a[8:11], a[148:151], v[76:79]
    s_waitcnt vmcnt(12) lgkmcnt(9)
    ds_read_b128 v[140:143], v12 offset:2240
    v_fmac_f32 v67, v131, v244
    v_mfma_f32_16x16x32_bf16 v[16:19], a[16:19], a[160:163], v[16:19]
    ds_read_b128 a[0:3], v254 offset:8192
    v_fmac_f32 v32, v132, v243
    v_mfma_f32_16x16x32_bf16 v[16:19], a[20:23], a[168:171], v[16:19]
    buffer_load_dwordx4 v249, s[12:15], s41 offen offset:2048 sc1 lds
    v_mfma_f32_16x16x32_bf16 v[48:51], a[20:23], a[172:175], v[48:51]
    ds_read_b128 a[4:7], v254 offset:9216
    v_fmac_f32 v33, v133, v243
    v_mfma_f32_16x16x32_bf16 v[48:51], a[16:19], a[164:167], v[48:51]
    s_waitcnt lgkmcnt(10)
    buffer_load_dwordx4 a[192:195], v252, s[20:23], s48 offen offset:2048 sc1
    v_mfma_f32_16x16x32_bf16 v[20:23], a[24:27], a[160:163], v[20:23]
    ds_read_b128 a[8:11], v254 offset:10240
    v_fmac_f32 v34, v134, v243
    v_mfma_f32_16x16x32_bf16 v[20:23], a[28:31], a[168:171], v[20:23]
    buffer_load_dwordx4 a[196:199], v253, s[20:23], s48 offen offset:2048 sc1
    v_mfma_f32_16x16x32_bf16 v[52:55], a[28:31], a[172:175], v[52:55]
    ds_read_b128 a[12:15], v254 offset:11264
    v_fmac_f32 v35, v135, v243
    v_mfma_f32_16x16x32_bf16 v[52:55], a[24:27], a[164:167], v[52:55]
    s_waitcnt lgkmcnt(9)
    buffer_load_dwordx4 a[200:203], v252, s[20:23], s48 offen offset:3072 sc1
    v_mfma_f32_16x16x32_bf16 v[24:27], a[32:35], a[160:163], v[24:27]
    ds_read_b128 a[16:19], v254 offset:12288
    v_fmac_f32 v64, v132, v247
    v_mfma_f32_16x16x32_bf16 v[24:27], a[36:39], a[168:171], v[24:27]
    buffer_load_dwordx4 a[204:207], v253, s[20:23], s48 offen offset:3072 sc1
    v_mfma_f32_16x16x32_bf16 v[56:59], a[36:39], a[172:175], v[56:59]
    ds_read_b128 a[20:23], v254 offset:13312
    v_fmac_f32 v65, v133, v247
    v_mfma_f32_16x16x32_bf16 v[56:59], a[32:35], a[164:167], v[56:59]
    s_waitcnt lgkmcnt(7)
    v_fmac_f32 v66, v134, v247
    v_fmac_f32 v67, v135, v247
    v_mfma_f32_16x16x32_bf16 v[28:31], a[40:43], a[160:163], v[28:31]
    ds_read_b128 a[24:27], v254 offset:14336
    v_mul_f32 v92, v152, v240
    v_mfma_f32_16x16x32_bf16 v[28:31], a[44:47], a[168:171], v[28:31]
    v_mul_f32 v93, v153, v240
    v_mul_f32 v94, v154, v240
    v_mfma_f32_16x16x32_bf16 v[60:63], a[44:47], a[172:175], v[60:63]
    ds_read_b128 a[28:31], v254 offset:15360
    v_mul_f32 v95, v155, v240
    v_mfma_f32_16x16x32_bf16 v[60:63], a[40:43], a[164:167], v[60:63]
    s_waitcnt lgkmcnt(6)
    v_mul_f32 v116, v152, v244
    v_mul_f32 v117, v153, v244
    v_mfma_f32_16x16x32_bf16 v[32:35], a[0:3], a[160:163], v[32:35]
    ds_read_b128 a[32:35], v254 offset:16384
    v_mul_f32 v118, v154, v244
    v_mfma_f32_16x16x32_bf16 v[32:35], a[4:7], a[168:171], v[32:35]
    v_mul_f32 v119, v155, v244
    v_fmac_f32 v92, v156, v243
    v_mfma_f32_16x16x32_bf16 v[64:67], a[4:7], a[172:175], v[64:67]
    ds_read_b128 a[36:39], v254 offset:17408
    v_fmac_f32 v93, v157, v243
    v_mfma_f32_16x16x32_bf16 v[64:67], a[0:3], a[164:167], v[64:67]
    s_waitcnt lgkmcnt(6)
    v_fmac_f32 v94, v158, v243
    v_fmac_f32 v95, v159, v243
    v_mfma_f32_16x16x32_bf16 v[36:39], a[8:11], a[160:163], v[36:39]
    ds_read_b128 a[40:43], v254 offset:18432
    v_fmac_f32 v116, v156, v247
    v_mfma_f32_16x16x32_bf16 v[36:39], a[12:15], a[168:171], v[36:39]
    v_fmac_f32 v117, v157, v247
    v_fmac_f32 v118, v158, v247
    v_mfma_f32_16x16x32_bf16 v[68:71], a[12:15], a[172:175], v[68:71]
    ds_read_b128 a[44:47], v254 offset:19456
    v_fmac_f32 v119, v159, v247
    v_mfma_f32_16x16x32_bf16 v[68:71], a[8:11], a[164:167], v[68:71]
    s_waitcnt lgkmcnt(6)
    v_fmac_f32 v28, v136, v240
    v_fmac_f32 v29, v137, v240
    v_mfma_f32_16x16x32_bf16 v[40:43], a[16:19], a[160:163], v[40:43]
    ds_read_b128 a[0:3], v254 offset:20480
    v_fmac_f32 v30, v138, v240
    v_mfma_f32_16x16x32_bf16 v[40:43], a[20:23], a[168:171], v[40:43]
    ds_read_b128 v[128:131], v12 offset:128
    v_fmac_f32 v31, v139, v240
    v_mfma_f32_16x16x32_bf16 v[72:75], a[20:23], a[172:175], v[72:75]
    ds_read_b128 a[4:7], v254 offset:21504
    v_fmac_f32 v60, v136, v244
    v_mfma_f32_16x16x32_bf16 v[72:75], a[16:19], a[164:167], v[72:75]
    s_waitcnt lgkmcnt(7)
    ds_read_b128 v[132:135], v12 offset:2176
    v_fmac_f32 v61, v137, v244
    v_mfma_f32_16x16x32_bf16 v[44:47], a[24:27], a[160:163], v[44:47]
    ds_read_b128 a[8:11], v254 offset:22528
    v_fmac_f32 v62, v138, v244
    v_mfma_f32_16x16x32_bf16 v[44:47], a[28:31], a[168:171], v[44:47]
    ds_read_b128 v[152:155], v13 offset:1024
    v_fmac_f32 v63, v139, v244
    v_mfma_f32_16x16x32_bf16 v[76:79], a[28:31], a[172:175], v[76:79]
    ds_read_b128 a[12:15], v254 offset:23552
    v_fmac_f32 v28, v140, v243
    v_mfma_f32_16x16x32_bf16 v[76:79], a[24:27], a[164:167], v[76:79]
    s_waitcnt vmcnt(11) lgkmcnt(9)
    ds_read_b128 v[156:159], v13 offset:3072
    v_fmac_f32 v29, v141, v243
    v_mfma_f32_16x16x32_bf16 v[16:19], a[32:35], a[176:179], v[16:19]
    ds_read_b128 a[16:19], v254 offset:24576
    v_fmac_f32 v30, v142, v243
    v_mfma_f32_16x16x32_bf16 v[16:19], a[36:39], a[184:187], v[16:19]
    v_fmac_f32 v31, v143, v243
    v_fmac_f32 v60, v140, v247
    v_mfma_f32_16x16x32_bf16 v[48:51], a[36:39], a[188:191], v[48:51]
    ds_read_b128 a[20:23], v254 offset:25600
    v_fmac_f32 v61, v141, v247
    v_mfma_f32_16x16x32_bf16 v[48:51], a[32:35], a[180:183], v[48:51]
    s_waitcnt lgkmcnt(10)
    v_fmac_f32 v62, v142, v247
    v_fmac_f32 v63, v143, v247
    v_mfma_f32_16x16x32_bf16 v[20:23], a[40:43], a[176:179], v[20:23]
    s_mov_b32 s41, 200704
    s_add_u32 m0, s37, 57344
    ds_read_b128 a[24:27], v254 offset:26624
    v_mul_f32 v96, v144, v240
    v_mfma_f32_16x16x32_bf16 v[20:23], a[44:47], a[184:187], v[20:23]
    buffer_load_dwordx4 v248, s[12:15], s41 offen offset:0 sc1 lds
    v_mfma_f32_16x16x32_bf16 v[52:55], a[44:47], a[188:191], v[52:55]
    ds_read_b128 a[28:31], v254 offset:27648
    v_mul_f32 v97, v145, v240
    v_mfma_f32_16x16x32_bf16 v[52:55], a[40:43], a[180:183], v[52:55]
    s_waitcnt lgkmcnt(9)
    buffer_load_dwordx4 v248, s[12:15], s41 offen offset:1024 sc1 lds
    v_mfma_f32_16x16x32_bf16 v[24:27], a[0:3], a[176:179], v[24:27]
    ds_read_b128 a[32:35], v5 offset:0
    v_mul_f32 v98, v146, v240
    v_mfma_f32_16x16x32_bf16 v[24:27], a[4:7], a[184:187], v[24:27]
    buffer_load_dwordx4 v248, s[12:15], s41 offen offset:2048 sc1 lds
    v_mfma_f32_16x16x32_bf16 v[56:59], a[4:7], a[188:191], v[56:59]
    ds_read_b128 a[36:39], v5 offset:1024
    v_mul_f32 v99, v147, v240
    v_mfma_f32_16x16x32_bf16 v[56:59], a[0:3], a[180:183], v[56:59]
    s_waitcnt lgkmcnt(7)
    buffer_load_dwordx4 v248, s[12:15], s41 offen offset:3072 sc1 lds
    v_mfma_f32_16x16x32_bf16 v[28:31], a[8:11], a[176:179], v[28:31]
    s_add_u32 m0, s37, 61440
    ds_read_b128 a[40:43], v5 offset:2048
    v_mul_f32 v120, v144, v244
    v_mfma_f32_16x16x32_bf16 v[28:31], a[12:15], a[184:187], v[28:31]
    buffer_load_dwordx4 v249, s[12:15], s41 offen offset:0 sc1 lds
    v_mfma_f32_16x16x32_bf16 v[60:63], a[12:15], a[188:191], v[60:63]
    ds_read_b128 a[44:47], v5 offset:3072
    v_mul_f32 v121, v145, v244
    v_mfma_f32_16x16x32_bf16 v[60:63], a[8:11], a[180:183], v[60:63]
    s_waitcnt lgkmcnt(6)
    buffer_load_dwordx4 v249, s[12:15], s41 offen offset:1024 sc1 lds
    v_mfma_f32_16x16x32_bf16 v[32:35], a[16:19], a[176:179], v[32:35]
    ds_read_b128 a[0:3], v5 offset:4096
    v_mul_f32 v122, v146, v244
    v_mfma_f32_16x16x32_bf16 v[32:35], a[20:23], a[184:187], v[32:35]
    buffer_load_dwordx4 v249, s[12:15], s41 offen offset:2048 sc1 lds
    v_mfma_f32_16x16x32_bf16 v[64:67], a[20:23], a[188:191], v[64:67]
    ds_read_b128 a[4:7], v5 offset:5120
    v_mul_f32 v123, v147, v244
    v_mfma_f32_16x16x32_bf16 v[64:67], a[16:19], a[180:183], v[64:67]
    s_waitcnt vmcnt(11) lgkmcnt(6)
    s_barrier
    v_fmac_f32 v96, v148, v243
    v_fmac_f32 v97, v149, v243
    v_mfma_f32_16x16x32_bf16 v[36:39], a[24:27], a[176:179], v[36:39]
    ds_read_b128 a[8:11], v5 offset:6144
    v_fmac_f32 v98, v150, v243
    v_mfma_f32_16x16x32_bf16 v[36:39], a[28:31], a[184:187], v[36:39]
    ds_read_b128 v[136:139], v12 offset:64
    v_fmac_f32 v99, v151, v243
    v_mfma_f32_16x16x32_bf16 v[68:71], a[28:31], a[188:191], v[68:71]
    ds_read_b128 a[12:15], v5 offset:7168
    v_fmac_f32 v120, v148, v247
    v_mfma_f32_16x16x32_bf16 v[68:71], a[24:27], a[180:183], v[68:71]
    s_waitcnt lgkmcnt(7)
    ds_read_b128 v[140:143], v12 offset:2112
    v_fmac_f32 v121, v149, v247
    v_mfma_f32_16x16x32_bf16 v[40:43], a[32:35], a[176:179], v[40:43]
    ds_read_b128 a[16:19], v5 offset:8192
    v_fmac_f32 v122, v150, v247
    v_mfma_f32_16x16x32_bf16 v[40:43], a[36:39], a[184:187], v[40:43]
    v_fmac_f32 v123, v151, v247
    v_fmac_f32 v24, v128, v240
    v_mfma_f32_16x16x32_bf16 v[72:75], a[36:39], a[188:191], v[72:75]
    ds_read_b128 a[20:23], v5 offset:9216
    v_fmac_f32 v25, v129, v240
    v_mfma_f32_16x16x32_bf16 v[72:75], a[32:35], a[180:183], v[72:75]
    s_waitcnt lgkmcnt(8)
    v_fmac_f32 v26, v130, v240
    v_fmac_f32 v27, v131, v240
    v_mfma_f32_16x16x32_bf16 v[44:47], a[40:43], a[176:179], v[44:47]
    ds_read_b128 a[24:27], v5 offset:10240
    v_fmac_f32 v56, v128, v244
    v_mfma_f32_16x16x32_bf16 v[44:47], a[44:47], a[184:187], v[44:47]
    v_fmac_f32 v57, v129, v244
    v_fmac_f32 v58, v130, v244
    v_mfma_f32_16x16x32_bf16 v[76:79], a[44:47], a[188:191], v[76:79]
    ds_read_b128 a[28:31], v5 offset:11264
    v_fmac_f32 v59, v131, v244
    v_mfma_f32_16x16x32_bf16 v[76:79], a[40:43], a[180:183], v[76:79]
    s_waitcnt vmcnt(7) lgkmcnt(8)
    v_fmac_f32 v24, v132, v243
    v_fmac_f32 v25, v133, v243
    v_mfma_f32_16x16x32_bf16 v[16:19], a[0:3], a[192:195], v[16:19]
    ds_read_b128 a[32:35], v5 offset:12288
    v_fmac_f32 v26, v134, v243
    v_mfma_f32_16x16x32_bf16 v[16:19], a[4:7], a[200:203], v[16:19]
    v_fmac_f32 v27, v135, v243
    v_fmac_f32 v56, v132, v247
    v_mfma_f32_16x16x32_bf16 v[48:51], a[4:7], a[204:207], v[48:51]
    ds_read_b128 a[36:39], v5 offset:13312
    v_fmac_f32 v57, v133, v247
    v_mfma_f32_16x16x32_bf16 v[48:51], a[0:3], a[196:199], v[48:51]
    s_waitcnt lgkmcnt(7)
    v_fmac_f32 v58, v134, v247
    v_fmac_f32 v59, v135, v247
    v_mfma_f32_16x16x32_bf16 v[20:23], a[8:11], a[192:195], v[20:23]
    ds_read_b128 a[40:43], v5 offset:14336
    v_mul_f32 v100, v152, v240
    v_mfma_f32_16x16x32_bf16 v[20:23], a[12:15], a[200:203], v[20:23]
    v_mul_f32 v101, v153, v240
    v_mul_f32 v102, v154, v240
    v_mfma_f32_16x16x32_bf16 v[52:55], a[12:15], a[204:207], v[52:55]
    ds_read_b128 a[44:47], v5 offset:15360
    v_mul_f32 v103, v155, v240
    v_mfma_f32_16x16x32_bf16 v[52:55], a[8:11], a[196:199], v[52:55]
    s_waitcnt lgkmcnt(6)
    v_mul_f32 v124, v152, v244
    v_mul_f32 v125, v153, v244
    v_mfma_f32_16x16x32_bf16 v[24:27], a[16:19], a[192:195], v[24:27]
    ds_read_b128 a[0:3], v5 offset:16384
    v_mul_f32 v126, v154, v244
    v_mfma_f32_16x16x32_bf16 v[24:27], a[20:23], a[200:203], v[24:27]
    v_mul_f32 v127, v155, v244
    v_fmac_f32 v100, v156, v243
    v_mfma_f32_16x16x32_bf16 v[56:59], a[20:23], a[204:207], v[56:59]
    ds_read_b128 a[4:7], v5 offset:17408
    v_fmac_f32 v101, v157, v243
    v_mfma_f32_16x16x32_bf16 v[56:59], a[16:19], a[196:199], v[56:59]
    s_waitcnt lgkmcnt(6)
    v_fmac_f32 v102, v158, v243
    v_fmac_f32 v103, v159, v243
    v_mfma_f32_16x16x32_bf16 v[28:31], a[24:27], a[192:195], v[28:31]
    s_mov_b32 s41, 229376
    s_add_u32 m0, s37, 86016
    ds_read_b128 a[8:11], v5 offset:18432
    v_fmac_f32 v124, v156, v247
    v_mfma_f32_16x16x32_bf16 v[28:31], a[28:31], a[200:203], v[28:31]
    buffer_load_dwordx4 v248, s[12:15], s41 offen offset:0 sc1 lds
    v_mfma_f32_16x16x32_bf16 v[60:63], a[28:31], a[204:207], v[60:63]
    ds_read_b128 a[12:15], v5 offset:19456
    v_fmac_f32 v125, v157, v247
    v_mfma_f32_16x16x32_bf16 v[60:63], a[24:27], a[196:199], v[60:63]
    s_waitcnt lgkmcnt(6)
    v_fmac_f32 v126, v158, v247
    v_fmac_f32 v127, v159, v247
    v_mfma_f32_16x16x32_bf16 v[32:35], a[32:35], a[192:195], v[32:35]
    ds_read_b128 a[16:19], v5 offset:20480
    v_mul_u32_u24 v14, 110592, v2
    v_mfma_f32_16x16x32_bf16 v[32:35], a[36:39], a[200:203], v[32:35]
    buffer_load_dwordx4 v248, s[12:15], s41 offen offset:1024 sc1 lds
    v_mfma_f32_16x16x32_bf16 v[64:67], a[36:39], a[204:207], v[64:67]
    ds_read_b128 a[20:23], v5 offset:21504
    v_add_u32 v14, v14, v5
    v_mfma_f32_16x16x32_bf16 v[64:67], a[32:35], a[196:199], v[64:67]
    s_waitcnt lgkmcnt(6)
    v_add_u32 v15, 55296, v14
    v_fmac_f32 v20, v136, v240
    v_mfma_f32_16x16x32_bf16 v[36:39], a[40:43], a[192:195], v[36:39]
    s_lshr_b32 s39, s58, 1
    ds_read_b128 a[24:27], v5 offset:22528
    v_fmac_f32 v21, v137, v240
    v_mfma_f32_16x16x32_bf16 v[36:39], a[44:47], a[200:203], v[36:39]
    s_mul_i32 s39, s39, 7168
    buffer_load_dwordx4 v248, s[12:15], s41 offen offset:2048 sc1 lds
    v_mfma_f32_16x16x32_bf16 v[68:71], a[44:47], a[204:207], v[68:71]
    s_lshl_b32 s38, s95, 12
    ds_read_b128 a[28:31], v5 offset:23552
    v_fmac_f32 v22, v138, v240
    v_mfma_f32_16x16x32_bf16 v[68:71], a[40:43], a[196:199], v[68:71]
    s_waitcnt lgkmcnt(6)
    v_fmac_f32 v23, v139, v240
    v_fmac_f32 v52, v136, v244
    v_mfma_f32_16x16x32_bf16 v[40:43], a[0:3], a[192:195], v[40:43]
    s_add_u32 s90, s39, s38
    ds_read_b128 a[32:35], v5 offset:24576
    v_fmac_f32 v53, v137, v244
    v_mfma_f32_16x16x32_bf16 v[40:43], a[4:7], a[200:203], v[40:43]
    s_cmp_eq_u32 s58, 15
    s_cselect_b32 s91, 67108864, s90
    v_fmac_f32 v54, v138, v244
    v_fmac_f32 v55, v139, v244
    v_mfma_f32_16x16x32_bf16 v[72:75], a[4:7], a[204:207], v[72:75]
    s_lshl_b32 s38, s95, 9
    ds_read_b128 a[36:39], v5 offset:25600
    v_fmac_f32 v20, v140, v243
    v_mfma_f32_16x16x32_bf16 v[72:75], a[0:3], a[196:199], v[72:75]
    s_waitcnt lgkmcnt(6)
    v_fmac_f32 v21, v141, v243
    v_fmac_f32 v22, v142, v243
    v_mfma_f32_16x16x32_bf16 v[44:47], a[8:11], a[192:195], v[44:47]
    s_add_u32 s92, s38, s39
    ds_read_b128 a[40:43], v5 offset:26624
    v_fmac_f32 v23, v143, v243
    v_mfma_f32_16x16x32_bf16 v[44:47], a[12:15], a[200:203], v[44:47]
    s_lshl_b32 s93, s59, 2
    buffer_load_dwordx4 v248, s[12:15], s41 offen offset:3072 sc1 lds
    v_mfma_f32_16x16x32_bf16 v[76:79], a[12:15], a[204:207], v[76:79]
    s_add_u32 s93, s93, s28
    s_add_u32 m0, s37, 90112
    ds_read_b128 a[44:47], v5 offset:27648
    v_fmac_f32 v52, v140, v247
    v_mfma_f32_16x16x32_bf16 v[76:79], a[8:11], a[196:199], v[76:79]
    s_lshl_b32 s93, s93, 4
    s_waitcnt lgkmcnt(6)
    buffer_load_dwordx4 v249, s[12:15], s41 offen offset:0 sc1 lds
    v_mfma_f32_16x16x32_bf16 v[80:83], a[16:19], a[48:51], v[80:83]
    s_add_u32 s93, s93, s58
    ds_read_b128 a[0:3], v5 offset:28672
    v_fmac_f32 v53, v141, v247
    v_fmac_f32 v54, v142, v247
    v_fmac_f32 v55, v143, v247
    v_mfma_f32_16x16x32_bf16 v[80:83], a[20:23], a[56:59], v[80:83]
    s_lshl_b32 s93, s93, 7
    buffer_load_dwordx4 v249, s[12:15], s41 offen offset:1024 sc1 lds
    v_mfma_f32_16x16x32_bf16 v[104:107], a[20:23], a[60:63], v[104:107]
    s_add_u32 s94, s93, 48758784
    ds_read_b128 a[4:7], v5 offset:29696
    v_mov_b32 v12, s3
    v_mfma_f32_16x16x32_bf16 v[104:107], a[16:19], a[52:55], v[104:107]
    s_add_u32 s93, s93, 49020928
    s_waitcnt lgkmcnt(6)
    buffer_load_dwordx4 v249, s[12:15], s41 offen offset:2048 sc1 lds
    v_mfma_f32_16x16x32_bf16 v[84:87], a[24:27], a[48:51], v[84:87]
    ds_read_b128 a[8:11], v5 offset:30720
    v_and_b32 v7, 3, v1
    v_mfma_f32_16x16x32_bf16 v[84:87], a[28:31], a[56:59], v[84:87]
    v_bfe_u32 v255, v1, 2, 1
    v_max_f32 v16, 0, v16
    v_mfma_f32_16x16x32_bf16 v[108:111], a[28:31], a[60:63], v[108:111]
    ds_read_b128 a[12:15], v5 offset:31744
    v_lshl_add_u32 v7, v255, 4, v7
    v_mfma_f32_16x16x32_bf16 v[108:111], a[24:27], a[52:55], v[108:111]
    s_waitcnt lgkmcnt(6)
    v_lshlrev_b32 v255, 7, v7
    v_mul_f32 v32, v32, v242
    v_mfma_f32_16x16x32_bf16 v[88:91], a[32:35], a[48:51], v[88:91]
    s_lshl_b32 s36, s57, 3
    ds_read_b128 a[16:19], v5 offset:32768
    v_max_f32 v17, 0, v17
    v_mfma_f32_16x16x32_bf16 v[88:91], a[36:39], a[56:59], v[88:91]
    s_add_u32 s36, s36, s28
    v_mul_f32 v33, v33, v242
    v_max_f32 v18, 0, v18
    v_mfma_f32_16x16x32_bf16 v[112:115], a[36:39], a[60:63], v[112:115]
    s_lshl_b32 s36, s36, 9
    ds_read_b128 a[20:23], v5 offset:33792
    v_mul_f32 v34, v34, v242
    v_mfma_f32_16x16x32_bf16 v[112:115], a[32:35], a[52:55], v[112:115]
    s_add_u32 s40, s36, 48758784
    s_waitcnt vmcnt(7) lgkmcnt(6)
    s_barrier
    v_max_f32 v19, 0, v19
    v_mul_f32 v35, v35, v242
    v_mfma_f32_16x16x32_bf16 v[92:95], a[40:43], a[48:51], v[92:95]
    s_add_u32 s36, s36, 49020928
    s_mov_b32 s41, 258048
    s_add_u32 m0, s37, 114688
    ds_read_b128 a[24:27], v5 offset:34816
    v_max_f32 v20, 0, v20
    v_mfma_f32_16x16x32_bf16 v[92:95], a[44:47], a[56:59], v[92:95]
    buffer_load_dwordx4 v248, s[12:15], s41 offen offset:0 sc1 lds
    v_mfma_f32_16x16x32_bf16 v[116:119], a[44:47], a[60:63], v[116:119]
    ds_read_b128 a[28:31], v5 offset:35840
    v_mul_f32 v36, v36, v242
    v_mfma_f32_16x16x32_bf16 v[116:119], a[40:43], a[52:55], v[116:119]
    s_waitcnt lgkmcnt(6)
    v_max_f32 v21, 0, v21
    v_mul_f32 v37, v37, v242
    v_mfma_f32_16x16x32_bf16 v[96:99], a[0:3], a[48:51], v[96:99]
    ds_read_b128 a[32:35], v5 offset:36864
    v_max_f32 v22, 0, v22
    v_mfma_f32_16x16x32_bf16 v[96:99], a[4:7], a[56:59], v[96:99]
    buffer_load_dwordx4 v248, s[12:15], s41 offen offset:1024 sc1 lds
    v_mfma_f32_16x16x32_bf16 v[120:123], a[4:7], a[60:63], v[120:123]
    ds_read_b128 a[36:39], v5 offset:37888
    v_mul_f32 v38, v38, v242
    v_mfma_f32_16x16x32_bf16 v[120:123], a[0:3], a[52:55], v[120:123]
    s_waitcnt lgkmcnt(6)
    v_max_f32 v23, 0, v23
    v_mul_f32 v39, v39, v242
    v_mul_f32 v16, v16, v32
    v_mul_f32 v17, v17, v33
    v_mul_f32 v18, v18, v34
    v_mul_f32 v19, v19, v35
    v_mul_f32 v20, v20, v36
    v_mul_f32 v21, v21, v37
    v_mul_f32 v22, v22, v38
    v_mul_f32 v23, v23, v39
    v_cvt_pk_bf16_f32 v32, v16, v17
    v_cvt_pk_bf16_f32 v33, v18, v19
    v_cvt_pk_bf16_f32 v34, v20, v21
    v_cvt_pk_bf16_f32 v35, v22, v23
    v_mfma_f32_16x16x32_bf16 v[100:103], a[8:11], a[48:51], v[100:103]
    ds_read_b128 a[40:43], v5 offset:38912
    v_max_f32 v48, 0, v48
    v_mfma_f32_16x16x32_bf16 v[100:103], a[12:15], a[56:59], v[100:103]
    buffer_store_dwordx4 v[32:35], v14, s[24:27], s90 offen offset:0 sc1
    v_mfma_f32_16x16x32_bf16 v[124:127], a[12:15], a[60:63], v[124:127]
    ds_read_b128 a[44:47], v5 offset:39936
    v_mul_f32 v64, v64, v246
    v_mfma_f32_16x16x32_bf16 v[124:127], a[8:11], a[52:55], v[124:127]
    s_waitcnt lgkmcnt(6)
    v_max_f32 v49, 0, v49
    v_mul_f32 v65, v65, v246
    v_mfma_f32_16x16x32_bf16 v[80:83], a[16:19], a[64:67], v[80:83]
    ds_read_b128 a[0:3], v5 offset:40960
    v_max_f32 v50, 0, v50
    v_mfma_f32_16x16x32_bf16 v[80:83], a[20:23], a[72:75], v[80:83]
    buffer_load_dwordx4 v248, s[12:15], s41 offen offset:2048 sc1 lds
    v_mfma_f32_16x16x32_bf16 v[104:107], a[20:23], a[76:79], v[104:107]
    ds_read_b128 a[4:7], v5 offset:41984
    v_mul_f32 v66, v66, v246
    v_mfma_f32_16x16x32_bf16 v[104:107], a[16:19], a[68:71], v[104:107]
    s_waitcnt lgkmcnt(6)
    v_max_f32 v51, 0, v51
    v_mul_f32 v67, v67, v246
    v_mfma_f32_16x16x32_bf16 v[84:87], a[24:27], a[64:67], v[84:87]
    ds_read_b128 a[8:11], v5 offset:43008
    v_max_f32 v52, 0, v52
    v_mfma_f32_16x16x32_bf16 v[84:87], a[28:31], a[72:75], v[84:87]
    buffer_load_dwordx4 v248, s[12:15], s41 offen offset:3072 sc1 lds
    v_mfma_f32_16x16x32_bf16 v[108:111], a[28:31], a[76:79], v[108:111]
    ds_read_b128 a[12:15], v5 offset:44032
    v_mul_f32 v68, v68, v246
    v_mfma_f32_16x16x32_bf16 v[108:111], a[24:27], a[68:71], v[108:111]
    s_waitcnt lgkmcnt(6)
    v_max_f32 v53, 0, v53
    v_mul_f32 v69, v69, v246
    v_mfma_f32_16x16x32_bf16 v[88:91], a[32:35], a[64:67], v[88:91]
    s_add_u32 m0, s37, 118784
    ds_read_b128 a[16:19], v5 offset:45056
    v_max_f32 v54, 0, v54
    v_mfma_f32_16x16x32_bf16 v[88:91], a[36:39], a[72:75], v[88:91]
    buffer_load_dwordx4 v249, s[12:15], s41 offen offset:0 sc1 lds
    v_mfma_f32_16x16x32_bf16 v[112:115], a[36:39], a[76:79], v[112:115]
    ds_read_b128 a[20:23], v5 offset:46080
    v_mul_f32 v70, v70, v246
    v_mfma_f32_16x16x32_bf16 v[112:115], a[32:35], a[68:71], v[112:115]
    s_waitcnt lgkmcnt(6)
    v_max_f32 v55, 0, v55
    v_mul_f32 v71, v71, v246
    v_mul_f32 v48, v48, v64
    v_mul_f32 v49, v49, v65
    v_mul_f32 v50, v50, v66
    v_mul_f32 v51, v51, v67
    v_mul_f32 v52, v52, v68
    v_mul_f32 v53, v53, v69
    v_mul_f32 v54, v54, v70
    v_mul_f32 v55, v55, v71
    v_cvt_pk_bf16_f32 v64, v48, v49
    v_cvt_pk_bf16_f32 v65, v50, v51
    v_cvt_pk_bf16_f32 v66, v52, v53
    v_cvt_pk_bf16_f32 v67, v54, v55
    v_mfma_f32_16x16x32_bf16 v[92:95], a[40:43], a[64:67], v[92:95]
    ds_read_b128 a[24:27], v5 offset:47104
    v_max_f32 v24, 0, v24
    v_mfma_f32_16x16x32_bf16 v[92:95], a[44:47], a[72:75], v[92:95]
    buffer_store_dwordx4 v[64:67], v15, s[24:27], s90 offen offset:0 sc1
    v_mfma_f32_16x16x32_bf16 v[116:119], a[44:47], a[76:79], v[116:119]
    ds_read_b128 a[28:31], v5 offset:48128
    v_mul_f32 v40, v40, v242
    v_mfma_f32_16x16x32_bf16 v[116:119], a[40:43], a[68:71], v[116:119]
    s_waitcnt lgkmcnt(6)
    v_max_f32 v25, 0, v25
    v_mul_f32 v41, v41, v242
    v_mfma_f32_16x16x32_bf16 v[96:99], a[0:3], a[64:67], v[96:99]
    ds_read_b128 a[32:35], v5 offset:49152
    v_max_f32 v26, 0, v26
    v_mfma_f32_16x16x32_bf16 v[96:99], a[4:7], a[72:75], v[96:99]
    buffer_load_dwordx4 v249, s[12:15], s41 offen offset:1024 sc1 lds
    v_mfma_f32_16x16x32_bf16 v[120:123], a[4:7], a[76:79], v[120:123]
    ds_read_b128 a[36:39], v5 offset:50176
    v_mul_f32 v42, v42, v242
    v_mfma_f32_16x16x32_bf16 v[120:123], a[0:3], a[68:71], v[120:123]
    s_waitcnt lgkmcnt(6)
    v_max_f32 v27, 0, v27
    v_mul_f32 v43, v43, v242
    v_mfma_f32_16x16x32_bf16 v[100:103], a[8:11], a[64:67], v[100:103]
    ds_read_b128 a[40:43], v5 offset:51200
    v_max_f32 v28, 0, v28
    v_mfma_f32_16x16x32_bf16 v[100:103], a[12:15], a[72:75], v[100:103]
    buffer_load_dwordx4 v249, s[12:15], s41 offen offset:2048 sc1 lds
    v_mfma_f32_16x16x32_bf16 v[124:127], a[12:15], a[76:79], v[124:127]
    ds_read_b128 a[44:47], v5 offset:52224
    v_mul_f32 v44, v44, v242
    v_mfma_f32_16x16x32_bf16 v[124:127], a[8:11], a[68:71], v[124:127]
    s_waitcnt lgkmcnt(6)
    v_max_f32 v29, 0, v29
    v_mul_f32 v45, v45, v242
    v_mfma_f32_16x16x32_bf16 v[80:83], a[16:19], a[80:83], v[80:83]
    ds_read_b128 a[0:3], v5 offset:53248
    v_max_f32 v30, 0, v30
    v_mfma_f32_16x16x32_bf16 v[80:83], a[20:23], a[88:91], v[80:83]
    buffer_load_dwordx4 v[184:187], v9, s[16:19], s34 offen offset:0 sc1
    v_mfma_f32_16x16x32_bf16 v[104:107], a[20:23], a[92:95], v[104:107]
    ds_read_b128 a[4:7], v5 offset:54272
    v_mul_f32 v46, v46, v242
    v_mfma_f32_16x16x32_bf16 v[104:107], a[16:19], a[84:87], v[104:107]
    s_waitcnt lgkmcnt(6)
    v_max_f32 v31, 0, v31
    v_mul_f32 v47, v47, v242
    v_mul_f32 v24, v24, v40
    v_mul_f32 v25, v25, v41
    v_mul_f32 v26, v26, v42
    v_mul_f32 v27, v27, v43
    v_mul_f32 v28, v28, v44
    v_mul_f32 v29, v29, v45
    v_mul_f32 v30, v30, v46
    v_mul_f32 v31, v31, v47
    v_cvt_pk_bf16_f32 v40, v24, v25
    v_cvt_pk_bf16_f32 v41, v26, v27
    v_cvt_pk_bf16_f32 v42, v28, v29
    v_cvt_pk_bf16_f32 v43, v30, v31
    v_mfma_f32_16x16x32_bf16 v[84:87], a[24:27], a[80:83], v[84:87]
    ds_read_b128 a[8:11], v5 offset:55296
    v_max_f32 v56, 0, v56
    v_mfma_f32_16x16x32_bf16 v[84:87], a[28:31], a[88:91], v[84:87]
    buffer_store_dwordx4 v[40:43], v14, s[24:27], s91 offen offset:1024 sc1
    v_mfma_f32_16x16x32_bf16 v[108:111], a[28:31], a[92:95], v[108:111]
    ds_read_b128 a[12:15], v5 offset:56320
    v_mul_f32 v72, v72, v246
    v_mfma_f32_16x16x32_bf16 v[108:111], a[24:27], a[84:87], v[108:111]
    s_waitcnt lgkmcnt(6)
    v_max_f32 v57, 0, v57
    v_mul_f32 v73, v73, v246
    v_mfma_f32_16x16x32_bf16 v[88:91], a[32:35], a[80:83], v[88:91]
    s_mov_b32 s35, 204800
    ds_read_b128 a[16:19], v251 offset:0
    v_max_f32 v58, 0, v58
    v_mfma_f32_16x16x32_bf16 v[88:91], a[36:39], a[88:91], v[88:91]
    buffer_load_dwordx4 v[188:191], v8, s[16:19], s35 offen offset:0 sc1
    v_mfma_f32_16x16x32_bf16 v[112:115], a[36:39], a[92:95], v[112:115]
    ds_read_b128 a[20:23], v251 offset:1024
    v_mul_f32 v74, v74, v246
    v_mfma_f32_16x16x32_bf16 v[112:115], a[32:35], a[84:87], v[112:115]
    s_waitcnt lgkmcnt(6)
    v_max_f32 v59, 0, v59
    v_mul_f32 v75, v75, v246
    v_mfma_f32_16x16x32_bf16 v[92:95], a[40:43], a[80:83], v[92:95]
    ds_read_b128 a[24:27], v251 offset:2048
    v_max_f32 v60, 0, v60
    v_mfma_f32_16x16x32_bf16 v[92:95], a[44:47], a[88:91], v[92:95]
    buffer_load_dwordx4 v[192:195], v8, s[16:19], s35 offen offset:1024 sc1
    v_mfma_f32_16x16x32_bf16 v[116:119], a[44:47], a[92:95], v[116:119]
    ds_read_b128 a[28:31], v251 offset:3072
    v_mul_f32 v76, v76, v246
    v_mfma_f32_16x16x32_bf16 v[116:119], a[40:43], a[84:87], v[116:119]
    s_waitcnt lgkmcnt(6)
    v_max_f32 v61, 0, v61
    v_mul_f32 v77, v77, v246
    v_mfma_f32_16x16x32_bf16 v[96:99], a[0:3], a[80:83], v[96:99]
    ds_read_b128 a[32:35], v251 offset:4096
    v_max_f32 v62, 0, v62
    v_mfma_f32_16x16x32_bf16 v[96:99], a[4:7], a[88:91], v[96:99]
    buffer_load_dwordx4 v[196:199], v8, s[16:19], s35 offen offset:2048 sc1
    v_mfma_f32_16x16x32_bf16 v[120:123], a[4:7], a[92:95], v[120:123]
    ds_read_b128 a[36:39], v251 offset:5120
    v_mul_f32 v78, v78, v246
    v_mfma_f32_16x16x32_bf16 v[120:123], a[0:3], a[84:87], v[120:123]
    s_waitcnt vmcnt(14) lgkmcnt(6)
    s_barrier
    v_max_f32 v63, 0, v63
    v_mul_f32 v79, v79, v246
    v_mul_f32 v56, v56, v72
    v_mul_f32 v57, v57, v73
    v_mul_f32 v58, v58, v74
    v_mul_f32 v59, v59, v75
    v_mul_f32 v60, v60, v76
    v_mul_f32 v61, v61, v77
    v_mul_f32 v62, v62, v78
    v_mul_f32 v63, v63, v79
    v_cvt_pk_bf16_f32 v72, v56, v57
    v_cvt_pk_bf16_f32 v73, v58, v59
    v_cvt_pk_bf16_f32 v74, v60, v61
    v_cvt_pk_bf16_f32 v75, v62, v63
    v_mfma_f32_16x16x32_bf16 v[100:103], a[8:11], a[80:83], v[100:103]
    ds_read_b128 a[40:43], v251 offset:6144
    v_and_b32 v13, 31, v1
    v_mfma_f32_16x16x32_bf16 v[100:103], a[12:15], a[88:91], v[100:103]
    buffer_store_dwordx4 v[72:75], v15, s[24:27], s91 offen offset:1024 sc1
    v_mfma_f32_16x16x32_bf16 v[124:127], a[12:15], a[92:95], v[124:127]
    ds_read_b128 a[44:47], v251 offset:7168
    v_lshlrev_b32 v13, 2, v13
    v_mfma_f32_16x16x32_bf16 v[124:127], a[8:11], a[84:87], v[124:127]
    s_waitcnt lgkmcnt(6)
    v_mfma_f32_16x16x32_bf16 v[80:83], a[16:19], a[96:99], v[80:83]
    ds_read_b128 a[0:3], v251 offset:8192
    v_mfma_f32_16x16x32_bf16 v[80:83], a[20:23], a[104:107], v[80:83]
    buffer_load_dwordx4 v[200:203], v8, s[16:19], s35 offen offset:3072 sc1
    v_mfma_f32_16x16x32_bf16 v[104:107], a[20:23], a[108:111], v[104:107]
    ds_read_b128 a[4:7], v251 offset:9216
    v_mfma_f32_16x16x32_bf16 v[104:107], a[16:19], a[100:103], v[104:107]
    s_waitcnt lgkmcnt(6)
    v_mfma_f32_16x16x32_bf16 v[84:87], a[24:27], a[96:99], v[84:87]
    ds_read_b128 a[8:11], v251 offset:10240
    v_mfma_f32_16x16x32_bf16 v[84:87], a[28:31], a[104:107], v[84:87]
    buffer_load_dwordx4 v[204:207], v9, s[16:19], s35 offen offset:0 sc1
    v_mfma_f32_16x16x32_bf16 v[108:111], a[28:31], a[108:111], v[108:111]
    ds_read_b128 a[12:15], v251 offset:11264
    v_mfma_f32_16x16x32_bf16 v[108:111], a[24:27], a[100:103], v[108:111]
    s_waitcnt lgkmcnt(6)
    v_mfma_f32_16x16x32_bf16 v[88:91], a[32:35], a[96:99], v[88:91]
    s_mov_b32 s34, 286720
    ds_read_b128 a[16:19], v251 offset:12288
    v_mfma_f32_16x16x32_bf16 v[88:91], a[36:39], a[104:107], v[88:91]
    buffer_load_dwordx4 v[208:211], v8, s[16:19], s34 offen offset:0 sc1
    v_mfma_f32_16x16x32_bf16 v[112:115], a[36:39], a[108:111], v[112:115]
    ds_read_b128 a[20:23], v251 offset:13312
    v_mfma_f32_16x16x32_bf16 v[112:115], a[32:35], a[100:103], v[112:115]
    s_waitcnt lgkmcnt(6)
    v_mfma_f32_16x16x32_bf16 v[92:95], a[40:43], a[96:99], v[92:95]
    ds_read_b128 a[24:27], v251 offset:14336
    v_mfma_f32_16x16x32_bf16 v[92:95], a[44:47], a[104:107], v[92:95]
    buffer_load_dwordx4 v[212:215], v8, s[16:19], s34 offen offset:1024 sc1
    v_mfma_f32_16x16x32_bf16 v[116:119], a[44:47], a[108:111], v[116:119]
    ds_read_b128 a[28:31], v251 offset:15360
    v_mfma_f32_16x16x32_bf16 v[116:119], a[40:43], a[100:103], v[116:119]
    s_waitcnt lgkmcnt(6)
    v_mfma_f32_16x16x32_bf16 v[96:99], a[0:3], a[96:99], v[96:99]
    ds_read_b128 a[32:35], v251 offset:16384
    v_mfma_f32_16x16x32_bf16 v[96:99], a[4:7], a[104:107], v[96:99]
    buffer_load_dwordx4 v[216:219], v8, s[16:19], s34 offen offset:2048 sc1
    v_mfma_f32_16x16x32_bf16 v[120:123], a[4:7], a[108:111], v[120:123]
    ds_read_b128 a[36:39], v251 offset:17408
    v_mfma_f32_16x16x32_bf16 v[120:123], a[0:3], a[100:103], v[120:123]
    s_waitcnt lgkmcnt(6)
    v_mfma_f32_16x16x32_bf16 v[100:103], a[8:11], a[96:99], v[100:103]
    ds_read_b128 a[40:43], v251 offset:18432
    v_mfma_f32_16x16x32_bf16 v[100:103], a[12:15], a[104:107], v[100:103]
    buffer_load_dwordx4 v[220:223], v8, s[16:19], s34 offen offset:3072 sc1
    v_mfma_f32_16x16x32_bf16 v[124:127], a[12:15], a[108:111], v[124:127]
    ds_read_b128 a[44:47], v251 offset:19456
    v_mfma_f32_16x16x32_bf16 v[124:127], a[8:11], a[100:103], v[124:127]
    s_waitcnt lgkmcnt(6)
    v_mfma_f32_16x16x32_bf16 v[80:83], a[16:19], a[112:115], v[80:83]
    ds_read_b128 a[0:3], v251 offset:20480
    v_mfma_f32_16x16x32_bf16 v[80:83], a[20:23], a[120:123], v[80:83]
    buffer_load_dwordx4 v[224:227], v9, s[16:19], s34 offen offset:0 sc1
    v_mfma_f32_16x16x32_bf16 v[104:107], a[20:23], a[124:127], v[104:107]
    ds_read_b128 a[4:7], v251 offset:21504
    v_mfma_f32_16x16x32_bf16 v[104:107], a[16:19], a[116:119], v[104:107]
    s_waitcnt lgkmcnt(6)
    v_mfma_f32_16x16x32_bf16 v[84:87], a[24:27], a[112:115], v[84:87]
    s_mov_b32 s35, 327680
    ds_read_b128 a[8:11], v251 offset:22528
    v_mfma_f32_16x16x32_bf16 v[84:87], a[28:31], a[120:123], v[84:87]
    buffer_load_dwordx4 v[228:231], v8, s[16:19], s35 offen offset:0 sc1
    v_mfma_f32_16x16x32_bf16 v[108:111], a[28:31], a[124:127], v[108:111]
    ds_read_b128 a[12:15], v251 offset:23552
    v_mfma_f32_16x16x32_bf16 v[108:111], a[24:27], a[116:119], v[108:111]
    s_waitcnt lgkmcnt(6)
    v_mfma_f32_16x16x32_bf16 v[88:91], a[32:35], a[112:115], v[88:91]
    ds_read_b128 a[16:19], v251 offset:24576
    v_mfma_f32_16x16x32_bf16 v[88:91], a[36:39], a[120:123], v[88:91]
    buffer_load_dwordx4 v[128:131], v8, s[16:19], s35 offen offset:1024 sc1
    v_mfma_f32_16x16x32_bf16 v[112:115], a[36:39], a[124:127], v[112:115]
    ds_read_b128 a[20:23], v251 offset:25600
    v_mfma_f32_16x16x32_bf16 v[112:115], a[32:35], a[116:119], v[112:115]
    s_waitcnt lgkmcnt(6)
    v_mfma_f32_16x16x32_bf16 v[92:95], a[40:43], a[112:115], v[92:95]
    ds_read_b128 a[24:27], v251 offset:26624
    v_mfma_f32_16x16x32_bf16 v[92:95], a[44:47], a[120:123], v[92:95]
    buffer_load_dwordx4 v[132:135], v8, s[16:19], s35 offen offset:2048 sc1
    v_mfma_f32_16x16x32_bf16 v[116:119], a[44:47], a[124:127], v[116:119]
    ds_read_b128 a[28:31], v251 offset:27648
    v_mfma_f32_16x16x32_bf16 v[116:119], a[40:43], a[116:119], v[116:119]
    s_waitcnt lgkmcnt(6)
    v_mfma_f32_16x16x32_bf16 v[96:99], a[0:3], a[112:115], v[96:99]
    ds_read_b128 a[32:35], v251 offset:28672
    v_mfma_f32_16x16x32_bf16 v[96:99], a[4:7], a[120:123], v[96:99]
    buffer_load_dwordx4 v[136:139], v8, s[16:19], s35 offen offset:3072 sc1
    v_mfma_f32_16x16x32_bf16 v[120:123], a[4:7], a[124:127], v[120:123]
    ds_read_b128 a[36:39], v251 offset:29696
    v_mfma_f32_16x16x32_bf16 v[120:123], a[0:3], a[116:119], v[120:123]
    s_waitcnt lgkmcnt(6)
    v_mfma_f32_16x16x32_bf16 v[100:103], a[8:11], a[112:115], v[100:103]
    ds_read_b128 a[40:43], v251 offset:30720
    v_mfma_f32_16x16x32_bf16 v[100:103], a[12:15], a[120:123], v[100:103]
    buffer_load_dwordx4 v[140:143], v9, s[16:19], s35 offen offset:0 sc1
    v_mfma_f32_16x16x32_bf16 v[124:127], a[12:15], a[124:127], v[124:127]
    ds_read_b128 a[44:47], v251 offset:31744
    v_mfma_f32_16x16x32_bf16 v[124:127], a[8:11], a[116:119], v[124:127]
    s_waitcnt lgkmcnt(6)
    v_mfma_f32_16x16x32_bf16 v[80:83], a[16:19], a[128:131], v[80:83]
    s_waitcnt vmcnt(12) lgkmcnt(15)
    ds_read_b128 a[0:3], v251 offset:32768
    v_lshrrev_b32 v7, 1, v5
    v_mfma_f32_16x16x32_bf16 v[80:83], a[20:23], a[136:139], v[80:83]
    buffer_store_dword v12, v13, s[52:55], s93 offen sc1
    v_mfma_f32_16x16x32_bf16 v[104:107], a[20:23], a[140:143], v[104:107]
    ds_read_b128 a[4:7], v251 offset:33792
    v_sub_u32 v10, v14, v7
    v_mfma_f32_16x16x32_bf16 v[104:107], a[16:19], a[132:135], v[104:107]
    s_waitcnt vmcnt(19) lgkmcnt(6)
    s_barrier
    v_sub_u32 v11, v15, v7
    v_mfma_f32_16x16x32_bf16 v[84:87], a[24:27], a[128:131], v[84:87]
    s_mov_b32 s34, 450560
    ds_read_b128 a[8:11], v251 offset:34816
    v_mul_u32_u24 v7, 14336, v2
    v_mfma_f32_16x16x32_bf16 v[84:87], a[28:31], a[136:139], v[84:87]
    buffer_load_dwordx4 v[144:147], v8, s[16:19], s34 offen offset:0 sc1
    v_mfma_f32_16x16x32_bf16 v[108:111], a[28:31], a[140:143], v[108:111]
    ds_read_b128 a[12:15], v251 offset:35840
    v_add_u32 v7, v7, v5
    v_mfma_f32_16x16x32_bf16 v[108:111], a[24:27], a[132:135], v[108:111]
    s_waitcnt lgkmcnt(6)
    v_add_u32 v252, 0, v2
    v_mfma_f32_16x16x32_bf16 v[88:91], a[32:35], a[128:131], v[88:91]
    ds_read_b128 a[16:19], v251 offset:36864
    v_and_b32 v252, 3, v252
    v_mfma_f32_16x16x32_bf16 v[88:91], a[36:39], a[136:139], v[88:91]
    buffer_load_dwordx4 v[148:151], v8, s[16:19], s34 offen offset:1024 sc1
    v_mfma_f32_16x16x32_bf16 v[112:115], a[36:39], a[140:143], v[112:115]
    ds_read_b128 a[20:23], v251 offset:37888
    v_mul_u32_u24 v252, 55296, v252
    v_mfma_f32_16x16x32_bf16 v[112:115], a[32:35], a[132:135], v[112:115]
    s_waitcnt lgkmcnt(6)
    v_add_u32 v236, v252, v7
    v_mfma_f32_16x16x32_bf16 v[92:95], a[40:43], a[128:131], v[92:95]
    ds_read_b128 a[24:27], v251 offset:38912
    v_add_u32 v252, 1, v2
    v_mfma_f32_16x16x32_bf16 v[92:95], a[44:47], a[136:139], v[92:95]
    buffer_load_dwordx4 v[152:155], v8, s[16:19], s34 offen offset:2048 sc1
    v_mfma_f32_16x16x32_bf16 v[116:119], a[44:47], a[140:143], v[116:119]
    ds_read_b128 a[28:31], v251 offset:39936
    v_and_b32 v252, 3, v252
    v_mfma_f32_16x16x32_bf16 v[116:119], a[40:43], a[132:135], v[116:119]
    s_waitcnt lgkmcnt(6)
    v_mul_u32_u24 v252, 55296, v252
    v_mfma_f32_16x16x32_bf16 v[96:99], a[0:3], a[128:131], v[96:99]
    ds_read_b128 a[32:35], v251 offset:40960
    v_add_u32 v237, v252, v7
    v_mfma_f32_16x16x32_bf16 v[96:99], a[4:7], a[136:139], v[96:99]
    buffer_load_dwordx4 v[156:159], v8, s[16:19], s34 offen offset:3072 sc1
    v_mfma_f32_16x16x32_bf16 v[120:123], a[4:7], a[140:143], v[120:123]
    ds_read_b128 a[36:39], v251 offset:41984
    v_add_u32 v252, 2, v2
    v_mfma_f32_16x16x32_bf16 v[120:123], a[0:3], a[132:135], v[120:123]
    s_waitcnt lgkmcnt(6)
    v_and_b32 v252, 3, v252
    v_mfma_f32_16x16x32_bf16 v[100:103], a[8:11], a[128:131], v[100:103]
    ds_read_b128 a[40:43], v251 offset:43008
    v_mul_u32_u24 v252, 55296, v252
    v_mfma_f32_16x16x32_bf16 v[100:103], a[12:15], a[136:139], v[100:103]
    buffer_load_dwordx4 a[48:51], v9, s[16:19], s34 offen offset:0 sc1
    v_mfma_f32_16x16x32_bf16 v[124:127], a[12:15], a[140:143], v[124:127]
    ds_read_b128 a[44:47], v251 offset:44032
    v_add_u32 v238, v252, v7
    v_mfma_f32_16x16x32_bf16 v[124:127], a[8:11], a[132:135], v[124:127]
    s_waitcnt lgkmcnt(6)
    v_add_u32 v252, 3, v2
    v_mfma_f32_16x16x32_bf16 v[80:83], a[16:19], a[144:147], v[80:83]
    s_mov_b32 s35, 491520
    ds_read_b128 a[0:3], v251 offset:45056
    v_and_b32 v252, 3, v252
    v_mfma_f32_16x16x32_bf16 v[80:83], a[20:23], a[152:155], v[80:83]
    buffer_load_dwordx4 a[52:55], v8, s[16:19], s35 offen offset:0 sc1
    v_mfma_f32_16x16x32_bf16 v[104:107], a[20:23], a[156:159], v[104:107]
    ds_read_b128 a[4:7], v251 offset:46080
    v_mul_u32_u24 v252, 55296, v252
    v_mfma_f32_16x16x32_bf16 v[104:107], a[16:19], a[148:151], v[104:107]
    s_waitcnt lgkmcnt(6)
    v_add_u32 v239, v252, v7
    v_mfma_f32_16x16x32_bf16 v[84:87], a[24:27], a[144:147], v[84:87]
    ds_read_b128 a[8:11], v251 offset:47104
    v_lshrrev_b32 v252, 1, v5
    v_mfma_f32_16x16x32_bf16 v[84:87], a[28:31], a[152:155], v[84:87]
    buffer_load_dwordx4 a[56:59], v8, s[16:19], s35 offen offset:1024 sc1
    v_mfma_f32_16x16x32_bf16 v[108:111], a[28:31], a[156:159], v[108:111]
    ds_read_b128 a[12:15], v251 offset:48128
    v_sub_u32 v232, v236, v252
    v_mfma_f32_16x16x32_bf16 v[108:111], a[24:27], a[148:151], v[108:111]
    s_waitcnt lgkmcnt(6)
    v_sub_u32 v233, v237, v252
    v_mfma_f32_16x16x32_bf16 v[88:91], a[32:35], a[144:147], v[88:91]
    ds_read_b128 a[16:19], v251 offset:49152
    v_sub_u32 v234, v238, v252
    v_mfma_f32_16x16x32_bf16 v[88:91], a[36:39], a[152:155], v[88:91]
    buffer_load_dwordx4 a[60:63], v8, s[16:19], s35 offen offset:2048 sc1
    v_mfma_f32_16x16x32_bf16 v[112:115], a[36:39], a[156:159], v[112:115]
    ds_read_b128 a[20:23], v251 offset:50176
    v_sub_u32 v235, v239, v252
    v_mfma_f32_16x16x32_bf16 v[112:115], a[32:35], a[148:151], v[112:115]
    s_waitcnt lgkmcnt(6)
    v_mfma_f32_16x16x32_bf16 v[92:95], a[40:43], a[144:147], v[92:95]
    s_and_b32 s39, s57, 63
    ds_read_b128 a[24:27], v251 offset:51200
    v_mfma_f32_16x16x32_bf16 v[92:95], a[44:47], a[152:155], v[92:95]
    s_mul_i32 s39, s39, 221184
    buffer_load_dwordx4 a[64:67], v8, s[16:19], s35 offen offset:3072 sc1
    v_mfma_f32_16x16x32_bf16 v[116:119], a[44:47], a[156:159], v[116:119]
    s_add_u32 s38, s39, 8388608
    ds_read_b128 a[28:31], v251 offset:52224
    v_mfma_f32_16x16x32_bf16 v[116:119], a[40:43], a[148:151], v[116:119]
    s_waitcnt lgkmcnt(6)
    v_mfma_f32_16x16x32_bf16 v[96:99], a[0:3], a[144:147], v[96:99]
    s_add_u32 s8, s42, s38
    s_addc_u32 s9, s43, 0
    ds_read_b128 a[32:35], v251 offset:53248
    v_mfma_f32_16x16x32_bf16 v[96:99], a[4:7], a[152:155], v[96:99]
    s_sub_u32 s10, 7077888, s39
    buffer_load_dwordx4 a[68:71], v9, s[16:19], s35 offen offset:0 sc1
    v_mfma_f32_16x16x32_bf16 v[120:123], a[4:7], a[156:159], v[120:123]
    s_mov_b32 s11, 0x20000
    ds_read_b128 a[36:39], v251 offset:54272
    v_mfma_f32_16x16x32_bf16 v[120:123], a[0:3], a[148:151], v[120:123]
    s_waitcnt lgkmcnt(6)
    v_mfma_f32_16x16x32_bf16 v[100:103], a[8:11], a[144:147], v[100:103]
    s_mov_b32 s34, 81920
    ds_read_b128 a[40:43], v251 offset:55296
    v_mfma_f32_16x16x32_bf16 v[100:103], a[12:15], a[152:155], v[100:103]
    buffer_load_dwordx4 a[72:75], v8, s[16:19], s34 offen offset:0 sc1
    v_mfma_f32_16x16x32_bf16 v[124:127], a[12:15], a[156:159], v[124:127]
    ds_read_b128 a[44:47], v251 offset:56320
    v_mfma_f32_16x16x32_bf16 v[124:127], a[8:11], a[148:151], v[124:127]
    s_waitcnt lgkmcnt(6)
    v_mfma_f32_16x16x32_bf16 v[80:83], a[16:19], a[160:163], v[80:83]
    ds_read_b128 a[0:3], v254 offset:0
    v_mfma_f32_16x16x32_bf16 v[80:83], a[20:23], a[168:171], v[80:83]
    buffer_load_dwordx4 a[76:79], v8, s[16:19], s34 offen offset:1024 sc1
    v_mfma_f32_16x16x32_bf16 v[104:107], a[20:23], a[172:175], v[104:107]
    ds_read_b128 a[4:7], v254 offset:1024
    v_mfma_f32_16x16x32_bf16 v[104:107], a[16:19], a[164:167], v[104:107]
    s_waitcnt lgkmcnt(6)
    v_mfma_f32_16x16x32_bf16 v[84:87], a[24:27], a[160:163], v[84:87]
    ds_read_b128 a[8:11], v254 offset:2048
    v_mfma_f32_16x16x32_bf16 v[84:87], a[28:31], a[168:171], v[84:87]
    buffer_load_dwordx4 a[80:83], v8, s[16:19], s34 offen offset:2048 sc1
    v_mfma_f32_16x16x32_bf16 v[108:111], a[28:31], a[172:175], v[108:111]
    ds_read_b128 a[12:15], v254 offset:3072
    v_mfma_f32_16x16x32_bf16 v[108:111], a[24:27], a[164:167], v[108:111]
    s_waitcnt lgkmcnt(6)
    v_mfma_f32_16x16x32_bf16 v[88:91], a[32:35], a[160:163], v[88:91]
    ds_read_b128 a[16:19], v254 offset:4096
    v_mfma_f32_16x16x32_bf16 v[88:91], a[36:39], a[168:171], v[88:91]
    buffer_load_dwordx4 a[84:87], v8, s[16:19], s34 offen offset:3072 sc1
    v_mfma_f32_16x16x32_bf16 v[112:115], a[36:39], a[172:175], v[112:115]
    ds_read_b128 a[20:23], v254 offset:5120
    v_mfma_f32_16x16x32_bf16 v[112:115], a[32:35], a[164:167], v[112:115]
    s_waitcnt lgkmcnt(6)
    v_mfma_f32_16x16x32_bf16 v[92:95], a[40:43], a[160:163], v[92:95]
    s_cmp_eq_u32 s28, 3
    s_cselect_b32 s47, 67108864, s47
    ds_read_b128 a[24:27], v254 offset:6144
    v_mfma_f32_16x16x32_bf16 v[92:95], a[44:47], a[168:171], v[92:95]
    buffer_load_dwordx4 a[88:91], v9, s[16:19], s34 offen offset:0 sc1
    v_mfma_f32_16x16x32_bf16 v[116:119], a[44:47], a[172:175], v[116:119]
    ds_read_b128 a[28:31], v254 offset:7168
    v_mfma_f32_16x16x32_bf16 v[116:119], a[40:43], a[164:167], v[116:119]
    s_waitcnt lgkmcnt(6)
    v_mfma_f32_16x16x32_bf16 v[96:99], a[0:3], a[160:163], v[96:99]
    s_mov_b32 s35, 122880
    ds_read_b128 a[32:35], v254 offset:8192
    v_mfma_f32_16x16x32_bf16 v[96:99], a[4:7], a[168:171], v[96:99]
    buffer_load_dwordx4 a[92:95], v8, s[16:19], s35 offen offset:0 sc1
    v_mfma_f32_16x16x32_bf16 v[120:123], a[4:7], a[172:175], v[120:123]
    ds_read_b128 a[36:39], v254 offset:9216
    v_mfma_f32_16x16x32_bf16 v[120:123], a[0:3], a[164:167], v[120:123]
    s_waitcnt lgkmcnt(6)
    v_mfma_f32_16x16x32_bf16 v[100:103], a[8:11], a[160:163], v[100:103]
    ds_read_b128 a[40:43], v254 offset:10240
    v_mfma_f32_16x16x32_bf16 v[100:103], a[12:15], a[168:171], v[100:103]
    buffer_load_dwordx4 a[96:99], v8, s[16:19], s35 offen offset:1024 sc1
    v_mfma_f32_16x16x32_bf16 v[124:127], a[12:15], a[172:175], v[124:127]
    ds_read_b128 a[44:47], v254 offset:11264
    v_mfma_f32_16x16x32_bf16 v[124:127], a[8:11], a[164:167], v[124:127]
    s_waitcnt lgkmcnt(6)
    v_mfma_f32_16x16x32_bf16 v[80:83], a[16:19], a[176:179], v[80:83]
    ds_read_b128 a[0:3], v254 offset:12288
    v_mfma_f32_16x16x32_bf16 v[80:83], a[20:23], a[184:187], v[80:83]
    buffer_load_dwordx4 a[100:103], v8, s[16:19], s35 offen offset:2048 sc1
    v_mfma_f32_16x16x32_bf16 v[104:107], a[20:23], a[188:191], v[104:107]
    ds_read_b128 a[4:7], v254 offset:13312
    v_mfma_f32_16x16x32_bf16 v[104:107], a[16:19], a[180:183], v[104:107]
    s_waitcnt lgkmcnt(6)
    v_mfma_f32_16x16x32_bf16 v[84:87], a[24:27], a[176:179], v[84:87]
    ds_read_b128 a[8:11], v254 offset:14336
    v_mfma_f32_16x16x32_bf16 v[84:87], a[28:31], a[184:187], v[84:87]
    buffer_load_dwordx4 a[104:107], v8, s[16:19], s35 offen offset:3072 sc1
    v_mfma_f32_16x16x32_bf16 v[108:111], a[28:31], a[188:191], v[108:111]
    ds_read_b128 a[12:15], v254 offset:15360
    v_mfma_f32_16x16x32_bf16 v[108:111], a[24:27], a[180:183], v[108:111]
    s_waitcnt lgkmcnt(6)
    v_mfma_f32_16x16x32_bf16 v[88:91], a[32:35], a[176:179], v[88:91]
    ds_read_b128 a[16:19], v254 offset:16384
    v_mfma_f32_16x16x32_bf16 v[88:91], a[36:39], a[184:187], v[88:91]
    buffer_load_dwordx4 a[108:111], v9, s[16:19], s35 offen offset:0 sc1
    v_mfma_f32_16x16x32_bf16 v[112:115], a[36:39], a[188:191], v[112:115]
    ds_read_b128 a[20:23], v254 offset:17408
    v_mfma_f32_16x16x32_bf16 v[112:115], a[32:35], a[180:183], v[112:115]
    s_waitcnt lgkmcnt(6)
    v_mfma_f32_16x16x32_bf16 v[92:95], a[40:43], a[176:179], v[92:95]
    s_mov_b32 s34, 245760
    ds_read_b128 a[24:27], v254 offset:18432
    v_mfma_f32_16x16x32_bf16 v[92:95], a[44:47], a[184:187], v[92:95]
    buffer_load_dwordx4 a[112:115], v8, s[16:19], s34 offen offset:0 sc1
    v_mfma_f32_16x16x32_bf16 v[116:119], a[44:47], a[188:191], v[116:119]
    ds_read_b128 a[28:31], v254 offset:19456
    v_mfma_f32_16x16x32_bf16 v[116:119], a[40:43], a[180:183], v[116:119]
    s_waitcnt lgkmcnt(6)
    v_mfma_f32_16x16x32_bf16 v[96:99], a[0:3], a[176:179], v[96:99]
    ds_read_b128 a[32:35], v254 offset:20480
    v_mfma_f32_16x16x32_bf16 v[96:99], a[4:7], a[184:187], v[96:99]
    buffer_load_dword v253, v255, s[52:55], s36 offen sc1
    v_mfma_f32_16x16x32_bf16 v[120:123], a[4:7], a[188:191], v[120:123]
    ds_read_b128 a[36:39], v254 offset:21504
    v_mfma_f32_16x16x32_bf16 v[120:123], a[0:3], a[180:183], v[120:123]
    s_waitcnt lgkmcnt(6)
    v_mfma_f32_16x16x32_bf16 v[100:103], a[8:11], a[176:179], v[100:103]
    ds_read_b128 a[40:43], v254 offset:22528
    v_mfma_f32_16x16x32_bf16 v[100:103], a[12:15], a[184:187], v[100:103]
    buffer_load_dwordx4 a[116:119], v8, s[16:19], s34 offen offset:1024 sc1
    v_mfma_f32_16x16x32_bf16 v[124:127], a[12:15], a[188:191], v[124:127]
    ds_read_b128 a[44:47], v254 offset:23552
    v_mfma_f32_16x16x32_bf16 v[124:127], a[8:11], a[180:183], v[124:127]
    s_waitcnt lgkmcnt(6)
    v_mfma_f32_16x16x32_bf16 v[80:83], a[16:19], a[192:195], v[80:83]
    ds_read_b128 a[0:3], v254 offset:24576
    v_mfma_f32_16x16x32_bf16 v[80:83], a[20:23], a[200:203], v[80:83]
    buffer_load_dwordx4 a[120:123], v8, s[16:19], s34 offen offset:2048 sc1
    v_mfma_f32_16x16x32_bf16 v[104:107], a[20:23], a[204:207], v[104:107]
    ds_read_b128 a[4:7], v254 offset:25600
    v_mfma_f32_16x16x32_bf16 v[104:107], a[16:19], a[196:199], v[104:107]
    s_waitcnt lgkmcnt(6)
    v_mfma_f32_16x16x32_bf16 v[84:87], a[24:27], a[192:195], v[84:87]
    ds_read_b128 a[8:11], v254 offset:26624
    v_mfma_f32_16x16x32_bf16 v[84:87], a[28:31], a[200:203], v[84:87]
    buffer_load_dwordx4 a[124:127], v8, s[16:19], s34 offen offset:3072 sc1
    v_mfma_f32_16x16x32_bf16 v[108:111], a[28:31], a[204:207], v[108:111]
    ds_read_b128 a[12:15], v254 offset:27648
    v_mfma_f32_16x16x32_bf16 v[108:111], a[24:27], a[196:199], v[108:111]
    s_waitcnt lgkmcnt(6)
    v_mfma_f32_16x16x32_bf16 v[88:91], a[32:35], a[192:195], v[88:91]
    v_mfma_f32_16x16x32_bf16 v[88:91], a[36:39], a[200:203], v[88:91]
    v_mfma_f32_16x16x32_bf16 v[112:115], a[36:39], a[204:207], v[112:115]
    v_mfma_f32_16x16x32_bf16 v[112:115], a[32:35], a[196:199], v[112:115]
    s_waitcnt lgkmcnt(4)
    v_mfma_f32_16x16x32_bf16 v[92:95], a[40:43], a[192:195], v[92:95]
    v_mfma_f32_16x16x32_bf16 v[92:95], a[44:47], a[200:203], v[92:95]
    v_mfma_f32_16x16x32_bf16 v[116:119], a[44:47], a[204:207], v[116:119]
    v_mfma_f32_16x16x32_bf16 v[116:119], a[40:43], a[196:199], v[116:119]
    s_waitcnt lgkmcnt(2)
    v_mfma_f32_16x16x32_bf16 v[96:99], a[0:3], a[192:195], v[96:99]
    v_mfma_f32_16x16x32_bf16 v[96:99], a[4:7], a[200:203], v[96:99]
    v_mfma_f32_16x16x32_bf16 v[120:123], a[4:7], a[204:207], v[120:123]
    v_mfma_f32_16x16x32_bf16 v[120:123], a[0:3], a[196:199], v[120:123]
    s_waitcnt lgkmcnt(0)
    v_mfma_f32_16x16x32_bf16 v[100:103], a[8:11], a[192:195], v[100:103]
    v_mfma_f32_16x16x32_bf16 v[100:103], a[12:15], a[200:203], v[100:103]
    v_mfma_f32_16x16x32_bf16 v[124:127], a[12:15], a[204:207], v[124:127]
    v_mfma_f32_16x16x32_bf16 v[124:127], a[8:11], a[196:199], v[124:127]
    s_waitcnt vmcnt(3)
    v_cmp_ne_u32 vcc, s3, v253
    s_nop 1
    s_cbranch_vccnz Lfa
    buffer_load_dwordx4 a[0:3], v236, s[8:11], s44 offen offset:0 sc1
    buffer_load_dwordx4 a[4:7], v236, s[8:11], s44 offen offset:1024 sc1
    buffer_load_dwordx4 a[8:11], v236, s[8:11], s45 offen offset:0 sc1
    buffer_load_dwordx4 a[12:15], v236, s[8:11], s45 offen offset:1024 sc1
    buffer_load_dwordx4 a[16:19], v237, s[8:11], s44 offen offset:0 sc1
    buffer_load_dwordx4 a[20:23], v237, s[8:11], s44 offen offset:1024 sc1
    buffer_load_dwordx4 a[24:27], v237, s[8:11], s45 offen offset:0 sc1
    buffer_load_dwordx4 a[28:31], v237, s[8:11], s45 offen offset:1024 sc1
    buffer_load_dwordx4 a[32:35], v238, s[8:11], s44 offen offset:0 sc1
    buffer_load_dwordx4 a[36:39], v238, s[8:11], s44 offen offset:1024 sc1
    buffer_load_dwordx4 a[40:43], v238, s[8:11], s45 offen offset:0 sc1
    buffer_load_dwordx4 a[44:47], v238, s[8:11], s45 offen offset:1024 sc1
    v_max_f32 v80, 0, v80
    v_max_f32 v81, 0, v81
    v_max_f32 v82, 0, v82
    v_max_f32 v83, 0, v83
    v_pk_mul_f32 v[92:93], v[92:93], v[242:243] op_sel_hi:[1,0]
    v_pk_mul_f32 v[94:95], v[94:95], v[242:243] op_sel_hi:[1,0]
    v_pk_mul_f32 v[80:81], v[80:81], v[92:93]
    v_pk_mul_f32 v[82:83], v[82:83], v[94:95]
    v_max_f32 v84, 0, v84
    v_max_f32 v85, 0, v85
    v_max_f32 v86, 0, v86
    v_max_f32 v87, 0, v87
    v_pk_mul_f32 v[96:97], v[96:97], v[242:243] op_sel_hi:[1,0]
    v_pk_mul_f32 v[98:99], v[98:99], v[242:243] op_sel_hi:[1,0]
    v_pk_mul_f32 v[84:85], v[84:85], v[96:97]
    v_pk_mul_f32 v[86:87], v[86:87], v[98:99]
    v_cvt_pk_bf16_f32 v92, v80, v81
    v_cvt_pk_bf16_f32 v93, v82, v83
    v_cvt_pk_bf16_f32 v94, v84, v85
    v_cvt_pk_bf16_f32 v95, v86, v87
    buffer_store_dwordx4 v[92:95], v14, s[24:27], s91 offen offset:2048 sc1
    v_max_f32 v88, 0, v88
    v_max_f32 v89, 0, v89
    v_max_f32 v90, 0, v90
    v_max_f32 v91, 0, v91
    v_pk_mul_f32 v[100:101], v[100:101], v[242:243] op_sel_hi:[1,0]
    v_pk_mul_f32 v[102:103], v[102:103], v[242:243] op_sel_hi:[1,0]
    v_pk_mul_f32 v[88:89], v[88:89], v[100:101]
    v_pk_mul_f32 v[90:91], v[90:91], v[102:103]
    v_cvt_pk_bf16_f32 v100, v88, v89
    v_cvt_pk_bf16_f32 v101, v90, v91
    buffer_store_dwordx2 v[100:101], v10, s[24:27], s92 offen offset:3072 sc1
    v_max_f32 v104, 0, v104
    v_max_f32 v105, 0, v105
    v_max_f32 v106, 0, v106
    v_max_f32 v107, 0, v107
    v_pk_mul_f32 v[116:117], v[116:117], v[246:247] op_sel_hi:[1,0]
    v_pk_mul_f32 v[118:119], v[118:119], v[246:247] op_sel_hi:[1,0]
    v_pk_mul_f32 v[104:105], v[104:105], v[116:117]
    v_pk_mul_f32 v[106:107], v[106:107], v[118:119]
    v_max_f32 v108, 0, v108
    v_max_f32 v109, 0, v109
    v_max_f32 v110, 0, v110
    v_max_f32 v111, 0, v111
    v_pk_mul_f32 v[120:121], v[120:121], v[246:247] op_sel_hi:[1,0]
    v_pk_mul_f32 v[122:123], v[122:123], v[246:247] op_sel_hi:[1,0]
    v_pk_mul_f32 v[108:109], v[108:109], v[120:121]
    v_pk_mul_f32 v[110:111], v[110:111], v[122:123]
    v_cvt_pk_bf16_f32 v116, v104, v105
    v_cvt_pk_bf16_f32 v117, v106, v107
    v_cvt_pk_bf16_f32 v118, v108, v109
    v_cvt_pk_bf16_f32 v119, v110, v111
    buffer_store_dwordx4 v[116:119], v15, s[24:27], s91 offen offset:2048 sc1
    v_max_f32 v112, 0, v112
    v_max_f32 v113, 0, v113
    v_max_f32 v114, 0, v114
    v_max_f32 v115, 0, v115
    v_pk_mul_f32 v[124:125], v[124:125], v[246:247] op_sel_hi:[1,0]
    v_pk_mul_f32 v[126:127], v[126:127], v[246:247] op_sel_hi:[1,0]
    v_pk_mul_f32 v[112:113], v[112:113], v[124:125]
    v_pk_mul_f32 v[114:115], v[114:115], v[126:127]
    v_cvt_pk_bf16_f32 v124, v112, v113
    v_cvt_pk_bf16_f32 v125, v114, v115
    buffer_store_dwordx2 v[124:125], v11, s[24:27], s92 offen offset:3072 sc1
Lfa_back:
    s_mov_b32 s20, s4
    s_mov_b32 s21, s5
    s_mov_b32 s22, 2621440
    s_mov_b32 s23, 0x20000
    s_waitcnt vmcnt(12)
    v_mfma_f32_16x16x32_bf16 v[16:19], a[208:211], a[0:3], 0
    v_mfma_f32_16x16x32_bf16 v[16:19], a[228:231], a[4:7], v[16:19]
    buffer_load_dwordx4 a[192:195], v239, s[8:11], s44 offen offset:0 sc1
    v_mfma_f32_16x16x32_bf16 v[16:19], v[168:171], a[8:11], v[16:19]
    v_mfma_f32_16x16x32_bf16 v[16:19], v[188:191], a[12:15], v[16:19]
    buffer_load_dwordx4 a[196:199], v239, s[8:11], s44 offen offset:1024 sc1
    v_mfma_f32_16x16x32_bf16 v[20:23], a[212:215], a[0:3], 0
    v_mfma_f32_16x16x32_bf16 v[20:23], a[232:235], a[4:7], v[20:23]
    buffer_load_dwordx4 a[200:203], v239, s[8:11], s45 offen offset:0 sc1
    v_mfma_f32_16x16x32_bf16 v[20:23], v[172:175], a[8:11], v[20:23]
    v_mfma_f32_16x16x32_bf16 v[20:23], v[192:195], a[12:15], v[20:23]
    buffer_load_dwordx4 a[204:207], v239, s[8:11], s45 offen offset:1024 sc1
    v_mfma_f32_16x16x32_bf16 v[24:27], a[216:219], a[0:3], 0
    s_waitcnt vmcnt(4)
    v_mfma_f32_16x16x32_bf16 v[24:27], a[236:239], a[4:7], v[24:27]
    buffer_store_dword v12, v13, s[52:55], s94 offen sc1
    v_mfma_f32_16x16x32_bf16 v[24:27], v[176:179], a[8:11], v[24:27]
    v_mfma_f32_16x16x32_bf16 v[24:27], v[196:199], a[12:15], v[24:27]
    buffer_load_dwordx4 a[128:131], v9, s[16:19], s34 offen offset:0 sc1
    v_mfma_f32_16x16x32_bf16 v[28:31], a[220:223], a[0:3], 0
    s_mov_b32 s35, 368640
    v_mfma_f32_16x16x32_bf16 v[28:31], v[160:163], a[4:7], v[28:31]
    buffer_load_dwordx4 a[132:135], v8, s[16:19], s35 offen offset:0 sc1
    v_mfma_f32_16x16x32_bf16 v[28:31], v[180:183], a[8:11], v[28:31]
    v_mfma_f32_16x16x32_bf16 v[28:31], v[200:203], a[12:15], v[28:31]
    buffer_load_dwordx4 a[136:139], v8, s[16:19], s35 offen offset:1024 sc1
    v_mfma_f32_16x16x32_bf16 v[32:35], a[224:227], a[0:3], 0
    v_mfma_f32_16x16x32_bf16 v[32:35], v[164:167], a[4:7], v[32:35]
    buffer_load_dwordx4 a[140:143], v8, s[16:19], s35 offen offset:2048 sc1
    v_mfma_f32_16x16x32_bf16 v[32:35], v[184:187], a[8:11], v[32:35]
    v_mfma_f32_16x16x32_bf16 v[32:35], v[204:207], a[12:15], v[32:35]
    s_waitcnt vmcnt(17)
    v_mfma_f32_16x16x32_bf16 v[36:39], a[208:211], a[16:19], 0
    s_lshl_b32 s39, s95, 6
    v_accvgpr_read_b32 v116, a240
    v_accvgpr_read_b32 v117, a241
    v_mfma_f32_16x16x32_bf16 v[36:39], a[228:231], a[20:23], v[36:39]
    s_add_u32 s39, s39, 147456
    buffer_load_dwordx4 a[0:3], v236, s[8:11], s45 offen offset:3072 sc1
    v_mfma_f32_16x16x32_bf16 v[36:39], v[168:171], a[24:27], v[36:39]
    v_add_u32 v248, s39, v6
    v_accvgpr_read_b32 v118, a242
    v_mfma_f32_16x16x32_bf16 v[36:39], v[188:191], a[28:31], v[36:39]
    s_lshl_b32 s39, s96, 6
    buffer_load_dwordx4 a[4:7], v236, s[8:11], s46 offen offset:0 sc1
    v_mfma_f32_16x16x32_bf16 v[40:43], a[212:215], a[16:19], 0
    s_add_u32 s39, s39, 147456
    v_accvgpr_read_b32 v119, a243
    v_accvgpr_read_b32 v120, a244
    v_mfma_f32_16x16x32_bf16 v[40:43], a[232:235], a[20:23], v[40:43]
    v_add_u32 v249, s39, v6
    v_accvgpr_read_b32 v121, a245
    v_mfma_f32_16x16x32_bf16 v[40:43], v[172:175], a[24:27], v[40:43]
    buffer_load_dwordx4 a[8:11], v236, s[8:11], s46 offen offset:3072 sc1
    v_mfma_f32_16x16x32_bf16 v[40:43], v[192:195], a[28:31], v[40:43]
    v_accvgpr_read_b32 v122, a246
    v_accvgpr_read_b32 v123, a247
    v_mfma_f32_16x16x32_bf16 v[44:47], a[216:219], a[16:19], 0
    v_accvgpr_read_b32 v124, a248
    v_accvgpr_read_b32 v125, a249
    v_mfma_f32_16x16x32_bf16 v[44:47], a[236:239], a[20:23], v[44:47]
    buffer_load_dwordx4 a[12:15], v236, s[8:11], s47 offen offset:0 sc1
    v_mfma_f32_16x16x32_bf16 v[44:47], v[176:179], a[24:27], v[44:47]
    v_mfma_f32_16x16x32_bf16 v[44:47], v[196:199], a[28:31], v[44:47]
    v_mfma_f32_16x16x32_bf16 v[48:51], a[220:223], a[16:19], 0
    buffer_load_dwordx4 a[144:147], v8, s[16:19], s35 offen offset:3072 sc1
    v_mfma_f32_16x16x32_bf16 v[48:51], v[160:163], a[20:23], v[48:51]
    v_mfma_f32_16x16x32_bf16 v[48:51], v[180:183], a[24:27], v[48:51]
    v_mfma_f32_16x16x32_bf16 v[48:51], v[200:203], a[28:31], v[48:51]
    buffer_load_dwordx4 a[148:151], v9, s[16:19], s35 offen offset:0 sc1
    v_mfma_f32_16x16x32_bf16 v[52:55], a[224:227], a[16:19], 0
    v_mfma_f32_16x16x32_bf16 v[52:55], v[164:167], a[20:23], v[52:55]
    s_mov_b32 s34, 409600
    v_mfma_f32_16x16x32_bf16 v[52:55], v[184:187], a[24:27], v[52:55]
    buffer_load_dwordx4 a[152:155], v8, s[16:19], s34 offen offset:0 sc1
    v_mfma_f32_16x16x32_bf16 v[52:55], v[204:207], a[28:31], v[52:55]
    s_waitcnt vmcnt(20)
    v_mfma_f32_16x16x32_bf16 v[56:59], a[208:211], a[32:35], 0
    ds_read_b128 v[96:99], v248 offset:0
    v_mfma_f32_16x16x32_bf16 v[56:59], a[228:231], a[36:39], v[56:59]
    buffer_load_dwordx4 a[16:19], v237, s[8:11], s45 offen offset:3072 sc1
    v_mfma_f32_16x16x32_bf16 v[56:59], v[168:171], a[40:43], v[56:59]
    ds_read_b128 v[100:103], v248 offset:64
    v_mfma_f32_16x16x32_bf16 v[56:59], v[188:191], a[44:47], v[56:59]
    buffer_load_dwordx4 a[20:23], v237, s[8:11], s46 offen offset:0 sc1
    v_mfma_f32_16x16x32_bf16 v[60:63], a[212:215], a[32:35], 0
    ds_read_b128 v[104:107], v248 offset:128
    v_mfma_f32_16x16x32_bf16 v[60:63], a[232:235], a[36:39], v[60:63]
    ds_read_b128 v[108:111], v248 offset:192
    v_mfma_f32_16x16x32_bf16 v[60:63], v[172:175], a[40:43], v[60:63]
    buffer_load_dwordx4 a[24:27], v237, s[8:11], s46 offen offset:3072 sc1
    v_mfma_f32_16x16x32_bf16 v[60:63], v[192:195], a[44:47], v[60:63]
    ds_read_b128 v[112:115], v249 offset:0
    v_add_u32 v7, 0, v2
    v_mfma_f32_16x16x32_bf16 v[64:67], a[216:219], a[32:35], 0
    v_and_b32 v7, 3, v7
    v_mfma_f32_16x16x32_bf16 v[64:67], a[236:239], a[36:39], v[64:67]
    buffer_load_dwordx4 a[28:31], v237, s[8:11], s47 offen offset:0 sc1
    v_mfma_f32_16x16x32_bf16 v[64:67], v[176:179], a[40:43], v[64:67]
    v_mul_u32_u24 v7, 15360, v7
    v_mfma_f32_16x16x32_bf16 v[64:67], v[196:199], a[44:47], v[64:67]
    v_add_u32 v7, v7, v5
    v_mfma_f32_16x16x32_bf16 v[68:71], a[220:223], a[32:35], 0
    buffer_load_dwordx4 a[156:159], v8, s[16:19], s34 offen offset:1024 sc1
    v_mfma_f32_16x16x32_bf16 v[68:71], v[160:163], a[36:39], v[68:71]
    v_add_u32 v244, 0, v7
    v_mfma_f32_16x16x32_bf16 v[68:71], v[180:183], a[40:43], v[68:71]
    v_add_u32 v7, 1, v2
    v_mfma_f32_16x16x32_bf16 v[68:71], v[200:203], a[44:47], v[68:71]
    buffer_load_dwordx4 a[160:163], v8, s[16:19], s34 offen offset:2048 sc1
    v_mfma_f32_16x16x32_bf16 v[72:75], a[224:227], a[32:35], 0
    v_and_b32 v7, 3, v7
    v_mfma_f32_16x16x32_bf16 v[72:75], v[164:167], a[36:39], v[72:75]
    v_mul_u32_u24 v7, 15360, v7
    v_mfma_f32_16x16x32_bf16 v[72:75], v[184:187], a[40:43], v[72:75]
    buffer_load_dwordx4 a[164:167], v8, s[16:19], s34 offen offset:3072 sc1
    v_mfma_f32_16x16x32_bf16 v[72:75], v[204:207], a[44:47], v[72:75]
    s_waitcnt vmcnt(19)
    v_add_u32 v7, v7, v5
    v_mfma_f32_16x16x32_bf16 v[76:79], a[208:211], a[192:195], 0
    v_add_u32 v245, 0, v7
    v_mfma_f32_16x16x32_bf16 v[76:79], a[228:231], a[196:199], v[76:79]
    buffer_load_dword v253, v255, s[52:55], s40 offen sc1
    v_mfma_f32_16x16x32_bf16 v[76:79], v[168:171], a[200:203], v[76:79]
    v_add_u32 v7, 2, v2
    v_mfma_f32_16x16x32_bf16 v[76:79], v[188:191], a[204:207], v[76:79]
    buffer_load_dwordx4 a[32:35], v238, s[8:11], s45 offen offset:3072 sc1
    v_mfma_f32_16x16x32_bf16 v[80:83], a[212:215], a[192:195], 0
    v_and_b32 v7, 3, v7
    v_mfma_f32_16x16x32_bf16 v[80:83], a[232:235], a[196:199], v[80:83]
    v_mul_u32_u24 v7, 15360, v7
    v_mfma_f32_16x16x32_bf16 v[80:83], v[172:175], a[200:203], v[80:83]
    buffer_load_dwordx4 a[36:39], v238, s[8:11], s46 offen offset:0 sc1
    v_mfma_f32_16x16x32_bf16 v[80:83], v[192:195], a[204:207], v[80:83]
    v_add_u32 v7, v7, v5
    v_mfma_f32_16x16x32_bf16 v[84:87], a[216:219], a[192:195], 0
    buffer_load_dwordx4 a[40:43], v238, s[8:11], s46 offen offset:3072 sc1
    v_mfma_f32_16x16x32_bf16 v[84:87], a[236:239], a[196:199], v[84:87]
    v_add_u32 v246, 5120, v7
    v_mfma_f32_16x16x32_bf16 v[84:87], v[176:179], a[200:203], v[84:87]
    v_add_u32 v7, 3, v2
    v_mfma_f32_16x16x32_bf16 v[84:87], v[196:199], a[204:207], v[84:87]
    buffer_load_dwordx4 a[44:47], v238, s[8:11], s47 offen offset:0 sc1
    v_mfma_f32_16x16x32_bf16 v[88:91], a[220:223], a[192:195], 0
    v_and_b32 v7, 3, v7
    v_mfma_f32_16x16x32_bf16 v[88:91], v[160:163], a[196:199], v[88:91]
    buffer_load_dwordx4 a[168:171], v9, s[16:19], s34 offen offset:0 sc1
    v_mfma_f32_16x16x32_bf16 v[88:91], v[180:183], a[200:203], v[88:91]
    v_mul_u32_u24 v7, 15360, v7
    v_mfma_f32_16x16x32_bf16 v[88:91], v[200:203], a[204:207], v[88:91]
    s_mov_b32 s35, 532480
    v_add_u32 v7, v7, v5
    v_mfma_f32_16x16x32_bf16 v[92:95], a[224:227], a[192:195], 0
    buffer_load_dwordx4 a[172:175], v8, s[16:19], s35 offen offset:0 sc1
    v_mfma_f32_16x16x32_bf16 v[92:95], v[164:167], a[196:199], v[92:95]
    v_add_u32 v247, 10240, v7
    v_mfma_f32_16x16x32_bf16 v[92:95], v[184:187], a[200:203], v[92:95]
    buffer_load_dwordx4 a[176:179], v8, s[16:19], s35 offen offset:1024 sc1
    v_mfma_f32_16x16x32_bf16 v[92:95], v[204:207], a[204:207], v[92:95]
    s_waitcnt vmcnt(18)
    v_mfma_f32_16x16x32_bf16 v[16:19], v[208:211], a[0:3], v[16:19]
    v_mfma_f32_16x16x32_bf16 v[16:19], v[228:231], a[4:7], v[16:19]
    buffer_load_dwordx4 a[192:195], v239, s[8:11], s45 offen offset:3072 sc1
    v_mfma_f32_16x16x32_bf16 v[16:19], v[144:147], a[8:11], v[16:19]
    v_mfma_f32_16x16x32_bf16 v[16:19], a[52:55], a[12:15], v[16:19]
    buffer_load_dwordx4 a[196:199], v239, s[8:11], s46 offen offset:0 sc1
    v_mfma_f32_16x16x32_bf16 v[20:23], v[212:215], a[0:3], v[20:23]
    v_mfma_f32_16x16x32_bf16 v[20:23], v[128:131], a[4:7], v[20:23]
    v_mfma_f32_16x16x32_bf16 v[20:23], v[148:151], a[8:11], v[20:23]
    buffer_load_dwordx4 a[200:203], v239, s[8:11], s46 offen offset:3072 sc1
    v_mfma_f32_16x16x32_bf16 v[20:23], a[56:59], a[12:15], v[20:23]
    v_mfma_f32_16x16x32_bf16 v[24:27], v[216:219], a[0:3], v[24:27]
    v_mfma_f32_16x16x32_bf16 v[24:27], v[132:135], a[4:7], v[24:27]
    buffer_load_dwordx4 a[204:207], v239, s[8:11], s47 offen offset:0 sc1
    v_mfma_f32_16x16x32_bf16 v[24:27], v[152:155], a[8:11], v[24:27]
    v_mfma_f32_16x16x32_bf16 v[24:27], a[60:63], a[12:15], v[24:27]
    v_mfma_f32_16x16x32_bf16 v[28:31], v[220:223], a[0:3], v[28:31]
    buffer_load_dwordx4 a[180:183], v8, s[16:19], s35 offen offset:2048 sc1
    v_mfma_f32_16x16x32_bf16 v[28:31], v[136:139], a[4:7], v[28:31]
    s_waitcnt vmcnt(12)
    v_mfma_f32_16x16x32_bf16 v[28:31], v[156:159], a[8:11], v[28:31]
    v_cmp_ne_u32 vcc, s3, v253
    v_mfma_f32_16x16x32_bf16 v[28:31], a[64:67], a[12:15], v[28:31]
    buffer_load_dwordx4 a[184:187], v8, s[16:19], s35 offen offset:3072 sc1
    v_mfma_f32_16x16x32_bf16 v[32:35], v[224:227], a[0:3], v[32:35]
    v_mfma_f32_16x16x32_bf16 v[32:35], v[140:143], a[4:7], v[32:35]
    v_mfma_f32_16x16x32_bf16 v[32:35], a[48:51], a[8:11], v[32:35]
    s_waitcnt vmcnt(17)
    buffer_load_dwordx4 a[188:191], v9, s[16:19], s35 offen offset:0 sc1
    v_mfma_f32_16x16x32_bf16 v[32:35], a[68:71], a[12:15], v[32:35]
    s_cbranch_vccnz Lfb
Lfb_back:
    v_mfma_f32_16x16x32_bf16 v[36:39], v[208:211], a[16:19], v[36:39]
    v_mfma_f32_16x16x32_bf16 v[36:39], v[228:231], a[20:23], v[36:39]
    buffer_load_dwordx4 a[208:211], v237, s[8:11], s44 offen offset:2048 sc1
    v_mfma_f32_16x16x32_bf16 v[36:39], v[144:147], a[24:27], v[36:39]
    v_mfma_f32_16x16x32_bf16 v[36:39], a[52:55], a[28:31], v[36:39]
    v_mfma_f32_16x16x32_bf16 v[40:43], v[212:215], a[16:19], v[40:43]
    buffer_load_dwordx2 a[212:213], v233, s[8:11], s44 offen offset:3072 sc1
    v_mfma_f32_16x16x32_bf16 v[40:43], v[128:131], a[20:23], v[40:43]
    v_mfma_f32_16x16x32_bf16 v[40:43], v[148:151], a[24:27], v[40:43]
    v_mfma_f32_16x16x32_bf16 v[40:43], a[56:59], a[28:31], v[40:43]
    buffer_load_dwordx2 a[214:215], v233, s[8:11], s44 offen offset:3584 sc1
    v_mfma_f32_16x16x32_bf16 v[44:47], v[216:219], a[16:19], v[44:47]
    v_mfma_f32_16x16x32_bf16 v[44:47], v[132:135], a[20:23], v[44:47]
    v_mfma_f32_16x16x32_bf16 v[44:47], v[152:155], a[24:27], v[44:47]
    buffer_load_dwordx4 a[216:219], v237, s[8:11], s45 offen offset:2048 sc1
    v_mfma_f32_16x16x32_bf16 v[44:47], a[60:63], a[28:31], v[44:47]
    v_mfma_f32_16x16x32_bf16 v[48:51], v[220:223], a[16:19], v[48:51]
    v_mfma_f32_16x16x32_bf16 v[48:51], v[136:139], a[20:23], v[48:51]
    buffer_load_dwordx4 a[220:223], v237, s[8:11], s46 offen offset:1024 sc1
    v_mfma_f32_16x16x32_bf16 v[48:51], v[156:159], a[24:27], v[48:51]
    v_mfma_f32_16x16x32_bf16 v[48:51], a[64:67], a[28:31], v[48:51]
    v_mfma_f32_16x16x32_bf16 v[52:55], v[224:227], a[16:19], v[52:55]
    buffer_load_dwordx2 a[224:225], v233, s[8:11], s46 offen offset:2048 sc1
    v_mfma_f32_16x16x32_bf16 v[52:55], v[140:143], a[20:23], v[52:55]
    v_mfma_f32_16x16x32_bf16 v[52:55], a[48:51], a[24:27], v[52:55]
    v_mfma_f32_16x16x32_bf16 v[52:55], a[68:71], a[28:31], v[52:55]
    s_waitcnt vmcnt(16)
    buffer_load_dwordx2 a[226:227], v233, s[8:11], s46 offen offset:2560 sc1
    v_mfma_f32_16x16x32_bf16 v[56:59], v[208:211], a[32:35], v[56:59]
    v_mfma_f32_16x16x32_bf16 v[56:59], v[228:231], a[36:39], v[56:59]
    v_mfma_f32_16x16x32_bf16 v[56:59], v[144:147], a[40:43], v[56:59]
    buffer_load_dwordx4 a[228:231], v237, s[8:11], s47 offen offset:1024 sc1
    v_mfma_f32_16x16x32_bf16 v[56:59], a[52:55], a[44:47], v[56:59]
    v_mfma_f32_16x16x32_bf16 v[60:63], v[212:215], a[32:35], v[60:63]
    v_mfma_f32_16x16x32_bf16 v[60:63], v[128:131], a[36:39], v[60:63]
    buffer_load_dwordx4 a[232:235], v238, s[8:11], s44 offen offset:2048 sc1
    v_mfma_f32_16x16x32_bf16 v[60:63], v[148:151], a[40:43], v[60:63]
    v_mfma_f32_16x16x32_bf16 v[60:63], a[56:59], a[44:47], v[60:63]
    v_mfma_f32_16x16x32_bf16 v[64:67], v[216:219], a[32:35], v[64:67]
    buffer_load_dwordx2 a[236:237], v234, s[8:11], s44 offen offset:3072 sc1
    v_mfma_f32_16x16x32_bf16 v[64:67], v[132:135], a[36:39], v[64:67]
    v_mfma_f32_16x16x32_bf16 v[64:67], v[152:155], a[40:43], v[64:67]
    v_mfma_f32_16x16x32_bf16 v[64:67], a[60:63], a[44:47], v[64:67]
    buffer_load_dwordx2 a[238:239], v234, s[8:11], s44 offen offset:3584 sc1
    v_mfma_f32_16x16x32_bf16 v[68:71], v[220:223], a[32:35], v[68:71]
    v_mfma_f32_16x16x32_bf16 v[68:71], v[136:139], a[36:39], v[68:71]
    v_mfma_f32_16x16x32_bf16 v[68:71], v[156:159], a[40:43], v[68:71]
    buffer_load_dwordx4 v[160:163], v238, s[8:11], s45 offen offset:2048 sc1
    v_mfma_f32_16x16x32_bf16 v[68:71], a[64:67], a[44:47], v[68:71]
    v_mfma_f32_16x16x32_bf16 v[72:75], v[224:227], a[32:35], v[72:75]
    s_waitcnt lgkmcnt(0)
    s_barrier
    v_mfma_f32_16x16x32_bf16 v[72:75], v[140:143], a[36:39], v[72:75]
    buffer_load_dwordx4 v[164:167], v238, s[8:11], s46 offen offset:1024 sc1
    v_mfma_f32_16x16x32_bf16 v[72:75], a[48:51], a[40:43], v[72:75]
    v_mfma_f32_16x16x32_bf16 v[72:75], a[68:71], a[44:47], v[72:75]
    s_waitcnt vmcnt(16)
    v_mfma_f32_16x16x32_bf16 v[76:79], v[208:211], a[192:195], v[76:79]
    buffer_load_dwordx2 v[168:169], v234, s[8:11], s46 offen offset:2048 sc1
    v_mfma_f32_16x16x32_bf16 v[76:79], v[228:231], a[196:199], v[76:79]
    v_mfma_f32_16x16x32_bf16 v[76:79], v[144:147], a[200:203], v[76:79]
    v_mfma_f32_16x16x32_bf16 v[76:79], a[52:55], a[204:207], v[76:79]
    buffer_load_dwordx2 v[170:171], v234, s[8:11], s46 offen offset:2560 sc1
    v_mfma_f32_16x16x32_bf16 v[80:83], v[212:215], a[192:195], v[80:83]
    v_mfma_f32_16x16x32_bf16 v[80:83], v[128:131], a[196:199], v[80:83]
    v_mfma_f32_16x16x32_bf16 v[80:83], v[148:151], a[200:203], v[80:83]
    buffer_load_dwordx4 v[172:175], v238, s[8:11], s47 offen offset:1024 sc1
    v_mfma_f32_16x16x32_bf16 v[80:83], a[56:59], a[204:207], v[80:83]
    v_mfma_f32_16x16x32_bf16 v[84:87], v[216:219], a[192:195], v[84:87]
    v_mfma_f32_16x16x32_bf16 v[84:87], v[132:135], a[196:199], v[84:87]
    buffer_load_dwordx4 v[176:179], v239, s[8:11], s44 offen offset:2048 sc1
    v_mfma_f32_16x16x32_bf16 v[84:87], v[152:155], a[200:203], v[84:87]
    v_mfma_f32_16x16x32_bf16 v[84:87], a[60:63], a[204:207], v[84:87]
    v_mfma_f32_16x16x32_bf16 v[88:91], v[220:223], a[192:195], v[88:91]
    buffer_load_dwordx2 v[180:181], v235, s[8:11], s44 offen offset:3072 sc1
    v_mfma_f32_16x16x32_bf16 v[88:91], v[136:139], a[196:199], v[88:91]
    v_mfma_f32_16x16x32_bf16 v[88:91], v[156:159], a[200:203], v[88:91]
    v_mfma_f32_16x16x32_bf16 v[88:91], a[64:67], a[204:207], v[88:91]
    buffer_load_dwordx2 v[182:183], v235, s[8:11], s44 offen offset:3584 sc1
    v_mfma_f32_16x16x32_bf16 v[92:95], v[224:227], a[192:195], v[92:95]
    v_mfma_f32_16x16x32_bf16 v[92:95], v[140:143], a[196:199], v[92:95]
    v_mfma_f32_16x16x32_bf16 v[92:95], a[48:51], a[200:203], v[92:95]
    buffer_load_dwordx4 v[184:187], v239, s[8:11], s45 offen offset:2048 sc1
    v_mfma_f32_16x16x32_bf16 v[92:95], a[68:71], a[204:207], v[92:95]
    s_waitcnt vmcnt(12)
    v_mfma_f32_16x16x32_bf16 v[36:39], a[72:75], a[208:211], v[36:39]
    v_mfma_f32_16x16x32_bf16 v[36:39], a[92:95], a[212:215], v[36:39]
    buffer_load_dwordx4 v[188:191], v239, s[8:11], s46 offen offset:1024 sc1
    v_mfma_f32_16x16x32_bf16 v[36:39], a[112:115], a[216:219], v[36:39]
    v_mfma_f32_16x16x32_bf16 v[36:39], a[132:135], a[220:223], v[36:39]
    v_mfma_f32_16x16x32_bf16 v[36:39], a[152:155], a[224:227], v[36:39]
    buffer_load_dwordx2 v[192:193], v235, s[8:11], s46 offen offset:2048 sc1
    v_mfma_f32_16x16x32_bf16 v[36:39], a[172:175], a[228:231], v[36:39]
    v_mfma_f32_16x16x32_bf16 v[40:43], a[76:79], a[208:211], v[40:43]
    v_mfma_f32_16x16x32_bf16 v[40:43], a[96:99], a[212:215], v[40:43]
    buffer_load_dwordx2 v[194:195], v235, s[8:11], s46 offen offset:2560 sc1
    v_mfma_f32_16x16x32_bf16 v[40:43], a[116:119], a[216:219], v[40:43]
    v_mfma_f32_16x16x32_bf16 v[40:43], a[136:139], a[220:223], v[40:43]
    v_mfma_f32_16x16x32_bf16 v[40:43], a[156:159], a[224:227], v[40:43]
    buffer_load_dwordx4 v[196:199], v239, s[8:11], s47 offen offset:1024 sc1
    v_mfma_f32_16x16x32_bf16 v[40:43], a[176:179], a[228:231], v[40:43]
    ds_write_b128 v245, v[36:39] offset:0
    v_mfma_f32_16x16x32_bf16 v[44:47], a[80:83], a[208:211], v[44:47]
    v_mfma_f32_16x16x32_bf16 v[44:47], a[100:103], a[212:215], v[44:47]
    buffer_load_dwordx4 v[200:203], v236, s[8:11], s44 offen offset:2048 sc1
    v_mfma_f32_16x16x32_bf16 v[44:47], a[120:123], a[216:219], v[44:47]
    v_mfma_f32_16x16x32_bf16 v[44:47], a[140:143], a[220:223], v[44:47]
    v_mfma_f32_16x16x32_bf16 v[44:47], a[160:163], a[224:227], v[44:47]
    buffer_load_dwordx2 v[204:205], v232, s[8:11], s44 offen offset:3072 sc1
    v_mfma_f32_16x16x32_bf16 v[44:47], a[180:183], a[228:231], v[44:47]
    ds_write_b128 v245, v[40:43] offset:1024
    v_mfma_f32_16x16x32_bf16 v[48:51], a[84:87], a[208:211], v[48:51]
    v_mfma_f32_16x16x32_bf16 v[48:51], a[104:107], a[212:215], v[48:51]
    buffer_load_dwordx2 v[206:207], v232, s[8:11], s44 offen offset:3584 sc1
    v_mfma_f32_16x16x32_bf16 v[48:51], a[124:127], a[216:219], v[48:51]
    v_mfma_f32_16x16x32_bf16 v[48:51], a[144:147], a[220:223], v[48:51]
    v_mfma_f32_16x16x32_bf16 v[48:51], a[164:167], a[224:227], v[48:51]
    buffer_load_dwordx4 a[0:3], v236, s[8:11], s45 offen offset:2048 sc1
    v_mfma_f32_16x16x32_bf16 v[48:51], a[184:187], a[228:231], v[48:51]
    ds_write_b128 v245, v[44:47] offset:2048
    v_mfma_f32_16x16x32_bf16 v[52:55], a[88:91], a[208:211], v[52:55]
    v_mfma_f32_16x16x32_bf16 v[52:55], a[108:111], a[212:215], v[52:55]
    buffer_load_dwordx4 a[4:7], v236, s[8:11], s46 offen offset:1024 sc1
    v_mfma_f32_16x16x32_bf16 v[52:55], a[128:131], a[216:219], v[52:55]
    v_mfma_f32_16x16x32_bf16 v[52:55], a[148:151], a[220:223], v[52:55]
    v_mfma_f32_16x16x32_bf16 v[52:55], a[168:171], a[224:227], v[52:55]
    buffer_load_dwordx2 a[8:9], v232, s[8:11], s46 offen offset:2048 sc1
    v_mfma_f32_16x16x32_bf16 v[52:55], a[188:191], a[228:231], v[52:55]
    s_waitcnt vmcnt(14)
    ds_write_b128 v245, v[48:51] offset:3072
    v_mfma_f32_16x16x32_bf16 v[56:59], a[72:75], a[232:235], v[56:59]
    v_mfma_f32_16x16x32_bf16 v[56:59], a[92:95], a[236:239], v[56:59]
    buffer_load_dwordx2 a[10:11], v232, s[8:11], s46 offen offset:2560 sc1
    v_mfma_f32_16x16x32_bf16 v[56:59], a[112:115], v[160:163], v[56:59]
    v_mfma_f32_16x16x32_bf16 v[56:59], a[132:135], v[164:167], v[56:59]
    v_mfma_f32_16x16x32_bf16 v[56:59], a[152:155], v[168:171], v[56:59]
    buffer_load_dwordx4 a[12:15], v236, s[8:11], s47 offen offset:1024 sc1
    v_mfma_f32_16x16x32_bf16 v[56:59], a[172:175], v[172:175], v[56:59]
    ds_write_b128 v245, v[52:55] offset:4096
    v_mfma_f32_16x16x32_bf16 v[60:63], a[76:79], a[232:235], v[60:63]
    v_mfma_f32_16x16x32_bf16 v[60:63], a[96:99], a[236:239], v[60:63]
    v_mfma_f32_16x16x32_bf16 v[60:63], a[116:119], v[160:163], v[60:63]
    v_mfma_f32_16x16x32_bf16 v[60:63], a[136:139], v[164:167], v[60:63]
    v_mfma_f32_16x16x32_bf16 v[60:63], a[156:159], v[168:171], v[60:63]
    v_mfma_f32_16x16x32_bf16 v[60:63], a[176:179], v[172:175], v[60:63]
    s_nop 0
    ds_write_b128 v246, v[56:59] offset:0
    v_mfma_f32_16x16x32_bf16 v[64:67], a[80:83], a[232:235], v[64:67]
    v_mfma_f32_16x16x32_bf16 v[64:67], a[100:103], a[236:239], v[64:67]
    v_mfma_f32_16x16x32_bf16 v[64:67], a[120:123], v[160:163], v[64:67]
    v_mfma_f32_16x16x32_bf16 v[64:67], a[140:143], v[164:167], v[64:67]
    v_mfma_f32_16x16x32_bf16 v[64:67], a[160:163], v[168:171], v[64:67]
    v_mfma_f32_16x16x32_bf16 v[64:67], a[180:183], v[172:175], v[64:67]
    ds_write_b128 v246, v[60:63] offset:1024
    v_mfma_f32_16x16x32_bf16 v[68:71], a[84:87], a[232:235], v[68:71]
    v_mfma_f32_16x16x32_bf16 v[68:71], a[104:107], a[236:239], v[68:71]
    v_mfma_f32_16x16x32_bf16 v[68:71], a[124:127], v[160:163], v[68:71]
    v_mfma_f32_16x16x32_bf16 v[68:71], a[144:147], v[164:167], v[68:71]
    v_mfma_f32_16x16x32_bf16 v[68:71], a[164:167], v[168:171], v[68:71]
    v_mfma_f32_16x16x32_bf16 v[68:71], a[184:187], v[172:175], v[68:71]
    s_nop 0
    ds_write_b128 v246, v[64:67] offset:2048
    v_mfma_f32_16x16x32_bf16 v[72:75], a[88:91], a[232:235], v[72:75]
    v_mfma_f32_16x16x32_bf16 v[72:75], a[108:111], a[236:239], v[72:75]
    v_mfma_f32_16x16x32_bf16 v[72:75], a[128:131], v[160:163], v[72:75]
    v_mfma_f32_16x16x32_bf16 v[72:75], a[148:151], v[164:167], v[72:75]
    v_mfma_f32_16x16x32_bf16 v[72:75], a[168:171], v[168:171], v[72:75]
    v_mfma_f32_16x16x32_bf16 v[72:75], a[188:191], v[172:175], v[72:75]
    s_waitcnt vmcnt(8)
    ds_write_b128 v246, v[68:71] offset:3072
    v_mfma_f32_16x16x32_bf16 v[76:79], a[72:75], v[176:179], v[76:79]
    v_mfma_f32_16x16x32_bf16 v[76:79], a[92:95], v[180:183], v[76:79]
    v_mfma_f32_16x16x32_bf16 v[76:79], a[112:115], v[184:187], v[76:79]
    v_mfma_f32_16x16x32_bf16 v[76:79], a[132:135], v[188:191], v[76:79]
    v_mfma_f32_16x16x32_bf16 v[76:79], a[152:155], v[192:195], v[76:79]
    v_mfma_f32_16x16x32_bf16 v[76:79], a[172:175], v[196:199], v[76:79]
    ds_write_b128 v246, v[72:75] offset:4096
    v_mfma_f32_16x16x32_bf16 v[80:83], a[76:79], v[176:179], v[80:83]
    v_mfma_f32_16x16x32_bf16 v[80:83], a[96:99], v[180:183], v[80:83]
    v_mfma_f32_16x16x32_bf16 v[80:83], a[116:119], v[184:187], v[80:83]
    v_mfma_f32_16x16x32_bf16 v[80:83], a[136:139], v[188:191], v[80:83]
    v_mfma_f32_16x16x32_bf16 v[80:83], a[156:159], v[192:195], v[80:83]
    s_waitcnt lgkmcnt(0)
    s_barrier
    v_mfma_f32_16x16x32_bf16 v[80:83], a[176:179], v[196:199], v[80:83]
    ds_read_b128 v[128:131], v244 offset:0
    v_lshlrev_b32 v36, 16, v116
    v_mfma_f32_16x16x32_bf16 v[84:87], a[80:83], v[176:179], v[84:87]
    ds_read_b128 v[132:135], v244 offset:1024
    v_and_b32 v37, 0xffff0000, v116
    v_mfma_f32_16x16x32_bf16 v[84:87], a[100:103], v[180:183], v[84:87]
    ds_write_b128 v247, v[76:79] offset:0
    v_lshlrev_b32 v38, 16, v117
    v_mfma_f32_16x16x32_bf16 v[84:87], a[120:123], v[184:187], v[84:87]
    ds_read_b128 v[136:139], v244 offset:2048
    v_and_b32 v39, 0xffff0000, v117
    v_mfma_f32_16x16x32_bf16 v[84:87], a[140:143], v[188:191], v[84:87]
    ds_read_b128 v[140:143], v244 offset:3072
    v_lshlrev_b32 v40, 16, v118
    v_mfma_f32_16x16x32_bf16 v[84:87], a[160:163], v[192:195], v[84:87]
    ds_read_b128 v[144:147], v244 offset:4096
    v_and_b32 v41, 0xffff0000, v118
    v_mfma_f32_16x16x32_bf16 v[84:87], a[180:183], v[196:199], v[84:87]
    ds_read_b128 v[208:211], v244 offset:5120
    v_lshlrev_b32 v42, 16, v119
    v_mfma_f32_16x16x32_bf16 v[88:91], a[84:87], v[176:179], v[88:91]
    ds_read_b128 v[212:215], v244 offset:6144
    v_and_b32 v43, 0xffff0000, v119
    v_mfma_f32_16x16x32_bf16 v[88:91], a[104:107], v[180:183], v[88:91]
    ds_write_b128 v247, v[80:83] offset:1024
    v_lshlrev_b32 v44, 16, v120
    v_mfma_f32_16x16x32_bf16 v[88:91], a[124:127], v[184:187], v[88:91]
    ds_read_b128 v[216:219], v244 offset:7168
    v_and_b32 v45, 0xffff0000, v120
    v_mfma_f32_16x16x32_bf16 v[88:91], a[144:147], v[188:191], v[88:91]
    ds_read_b128 v[220:223], v244 offset:8192
    v_lshlrev_b32 v46, 16, v121
    v_mfma_f32_16x16x32_bf16 v[88:91], a[164:167], v[192:195], v[88:91]
    ds_read_b128 v[224:227], v244 offset:9216
    v_and_b32 v47, 0xffff0000, v121
    v_mfma_f32_16x16x32_bf16 v[88:91], a[184:187], v[196:199], v[88:91]
    ds_write_b128 v247, v[84:87] offset:2048
    v_lshlrev_b32 v48, 16, v122
    v_mfma_f32_16x16x32_bf16 v[92:95], a[88:91], v[176:179], v[92:95]
    v_and_b32 v49, 0xffff0000, v122
    v_lshlrev_b32 v50, 16, v123
    v_mfma_f32_16x16x32_bf16 v[92:95], a[108:111], v[180:183], v[92:95]
    v_and_b32 v51, 0xffff0000, v123
    v_lshlrev_b32 v52, 16, v124
    v_mfma_f32_16x16x32_bf16 v[92:95], a[128:131], v[184:187], v[92:95]
    v_and_b32 v53, 0xffff0000, v124
    v_lshlrev_b32 v54, 16, v125
    v_mfma_f32_16x16x32_bf16 v[92:95], a[148:151], v[188:191], v[92:95]
    v_and_b32 v55, 0xffff0000, v125
    v_mfma_f32_16x16x32_bf16 v[92:95], a[168:171], v[192:195], v[92:95]
    v_mfma_f32_16x16x32_bf16 v[92:95], a[188:191], v[196:199], v[92:95]
    s_waitcnt vmcnt(0)
    ds_write_b128 v247, v[88:91] offset:3072
    v_mfma_f32_16x16x32_bf16 v[16:19], a[72:75], v[200:203], v[16:19]
    v_mfma_f32_16x16x32_bf16 v[16:19], a[92:95], v[204:207], v[16:19]
    v_mfma_f32_16x16x32_bf16 v[16:19], a[112:115], a[0:3], v[16:19]
    v_mfma_f32_16x16x32_bf16 v[16:19], a[132:135], a[4:7], v[16:19]
    v_mfma_f32_16x16x32_bf16 v[16:19], a[152:155], a[8:11], v[16:19]
    v_mfma_f32_16x16x32_bf16 v[16:19], a[172:175], a[12:15], v[16:19]
    ds_write_b128 v247, v[92:95] offset:4096
    v_mfma_f32_16x16x32_bf16 v[20:23], a[76:79], v[200:203], v[20:23]
    v_mfma_f32_16x16x32_bf16 v[20:23], a[96:99], v[204:207], v[20:23]
    v_mfma_f32_16x16x32_bf16 v[20:23], a[116:119], a[0:3], v[20:23]
    v_mfma_f32_16x16x32_bf16 v[20:23], a[136:139], a[4:7], v[20:23]
    v_mfma_f32_16x16x32_bf16 v[20:23], a[156:159], a[8:11], v[20:23]
    v_mfma_f32_16x16x32_bf16 v[20:23], a[176:179], a[12:15], v[20:23]
    s_waitcnt lgkmcnt(0)
    s_barrier
    v_mfma_f32_16x16x32_bf16 v[24:27], a[80:83], v[200:203], v[24:27]
    ds_read_b128 v[56:59], v244 offset:10240
    v_add_f32 v128, v128, v208
    v_mfma_f32_16x16x32_bf16 v[24:27], a[100:103], v[204:207], v[24:27]
    ds_read_b128 v[60:63], v244 offset:11264
    v_add_f32 v129, v129, v209
    v_mfma_f32_16x16x32_bf16 v[24:27], a[120:123], a[0:3], v[24:27]
    ds_read_b128 v[64:67], v244 offset:12288
    v_add_f32 v130, v130, v210
    v_mfma_f32_16x16x32_bf16 v[24:27], a[140:143], a[4:7], v[24:27]
    ds_read_b128 v[68:71], v244 offset:13312
    v_add_f32 v131, v131, v211
    v_mfma_f32_16x16x32_bf16 v[24:27], a[160:163], a[8:11], v[24:27]
    ds_read_b128 v[72:75], v244 offset:14336
    v_add_f32 v132, v132, v212
    v_mfma_f32_16x16x32_bf16 v[24:27], a[180:183], a[12:15], v[24:27]
    v_add_f32 v133, v133, v213
    v_add_f32 v134, v134, v214
    v_mfma_f32_16x16x32_bf16 v[28:31], a[84:87], v[200:203], v[28:31]
    v_add_f32 v135, v135, v215
    v_add_f32 v136, v136, v216
    v_mfma_f32_16x16x32_bf16 v[28:31], a[104:107], v[204:207], v[28:31]
    v_add_f32 v137, v137, v217
    v_add_f32 v138, v138, v218
    v_mfma_f32_16x16x32_bf16 v[28:31], a[124:127], a[0:3], v[28:31]
    v_add_f32 v139, v139, v219
    v_add_f32 v140, v140, v220
    v_mfma_f32_16x16x32_bf16 v[28:31], a[144:147], a[4:7], v[28:31]
    v_add_f32 v141, v141, v221
    v_add_f32 v142, v142, v222
    v_mfma_f32_16x16x32_bf16 v[28:31], a[164:167], a[8:11], v[28:31]
    v_add_f32 v143, v143, v223
    v_add_f32 v144, v144, v224
    v_mfma_f32_16x16x32_bf16 v[28:31], a[184:187], a[12:15], v[28:31]
    v_add_f32 v145, v145, v225
    v_add_f32 v146, v146, v226
    v_mfma_f32_16x16x32_bf16 v[32:35], a[88:91], v[200:203], v[32:35]
    v_add_f32 v147, v147, v227
    v_mfma_f32_16x16x32_bf16 v[32:35], a[108:111], v[204:207], v[32:35]
    v_mfma_f32_16x16x32_bf16 v[32:35], a[128:131], a[0:3], v[32:35]
    v_mfma_f32_16x16x32_bf16 v[32:35], a[148:151], a[4:7], v[32:35]
    v_mfma_f32_16x16x32_bf16 v[32:35], a[168:171], a[8:11], v[32:35]
    v_mfma_f32_16x16x32_bf16 v[32:35], a[188:191], a[12:15], v[32:35]
    s_waitcnt lgkmcnt(0)
    v_pk_add_f32 v[128:129], v[128:129], v[56:57]
    v_pk_add_f32 v[130:131], v[130:131], v[58:59]
    v_pk_add_f32 v[132:133], v[132:133], v[60:61]
    v_pk_add_f32 v[134:135], v[134:135], v[62:63]
    v_pk_add_f32 v[136:137], v[136:137], v[64:65]
    v_pk_add_f32 v[138:139], v[138:139], v[66:67]
    v_pk_add_f32 v[140:141], v[140:141], v[68:69]
    v_pk_add_f32 v[142:143], v[142:143], v[70:71]
    v_pk_add_f32 v[144:145], v[144:145], v[72:73]
    v_pk_add_f32 v[146:147], v[146:147], v[74:75]
    v_pk_add_f32 v[16:17], v[16:17], v[128:129]
    v_pk_add_f32 v[18:19], v[18:19], v[130:131]
    v_pk_add_f32 v[20:21], v[20:21], v[132:133]
    v_pk_add_f32 v[22:23], v[22:23], v[134:135]
    v_pk_add_f32 v[24:25], v[24:25], v[136:137]
    v_pk_add_f32 v[26:27], v[26:27], v[138:139]
    v_pk_add_f32 v[28:29], v[28:29], v[140:141]
    v_pk_add_f32 v[30:31], v[30:31], v[142:143]
    v_pk_add_f32 v[32:33], v[32:33], v[144:145]
    v_pk_add_f32 v[34:35], v[34:35], v[146:147]
    v_pk_fma_f32 v[16:17], v[16:17], v[96:97], v[36:37]
    v_pk_fma_f32 v[18:19], v[18:19], v[98:99], v[38:39]
    v_pk_fma_f32 v[20:21], v[20:21], v[100:101], v[40:41]
    v_pk_fma_f32 v[22:23], v[22:23], v[102:103], v[42:43]
    v_pk_fma_f32 v[24:25], v[24:25], v[104:105], v[44:45]
    v_pk_fma_f32 v[26:27], v[26:27], v[106:107], v[46:47]
    v_pk_fma_f32 v[28:29], v[28:29], v[108:109], v[48:49]
    v_pk_fma_f32 v[30:31], v[30:31], v[110:111], v[50:51]
    v_pk_fma_f32 v[32:33], v[32:33], v[112:113], v[52:53]
    v_pk_fma_f32 v[34:35], v[34:35], v[114:115], v[54:55]
    v_cvt_pk_bf16_f32 v116, v16, v17
    v_cvt_pk_bf16_f32 v117, v18, v19
    v_cvt_pk_bf16_f32 v118, v20, v21
    v_cvt_pk_bf16_f32 v119, v22, v23
    v_cvt_pk_bf16_f32 v120, v24, v25
    v_cvt_pk_bf16_f32 v121, v26, v27
    v_cvt_pk_bf16_f32 v122, v28, v29
    v_cvt_pk_bf16_f32 v123, v30, v31
    v_cvt_pk_bf16_f32 v124, v32, v33
    v_cvt_pk_bf16_f32 v125, v34, v35
    buffer_store_dwordx2 v[116:117], v250, s[20:23], s63 offen offset:0
    buffer_store_dwordx2 v[118:119], v250, s[20:23], s63 offen offset:32
    buffer_store_dwordx2 v[120:121], v250, s[20:23], s63 offen offset:64
    buffer_store_dwordx2 v[122:123], v250, s[20:23], s63 offen offset:96
    buffer_store_dwordx2 v[124:125], v250, s[20:23], s101 offen offset:0
Lend:
    s_endpgm
Lfa:
    s_nop 7
    v_max_f32 v80, 0, v80
    v_max_f32 v81, 0, v81
    v_max_f32 v82, 0, v82
    v_max_f32 v83, 0, v83
    v_pk_mul_f32 v[92:93], v[92:93], v[242:243] op_sel_hi:[1,0]
    v_pk_mul_f32 v[94:95], v[94:95], v[242:243] op_sel_hi:[1,0]
    v_pk_mul_f32 v[80:81], v[80:81], v[92:93]
    v_pk_mul_f32 v[82:83], v[82:83], v[94:95]
    v_max_f32 v84, 0, v84
    v_max_f32 v85, 0, v85
    v_max_f32 v86, 0, v86
    v_max_f32 v87, 0, v87
    v_pk_mul_f32 v[96:97], v[96:97], v[242:243] op_sel_hi:[1,0]
    v_pk_mul_f32 v[98:99], v[98:99], v[242:243] op_sel_hi:[1,0]
    v_pk_mul_f32 v[84:85], v[84:85], v[96:97]
    v_pk_mul_f32 v[86:87], v[86:87], v[98:99]
    v_cvt_pk_bf16_f32 v92, v80, v81
    v_cvt_pk_bf16_f32 v93, v82, v83
    v_cvt_pk_bf16_f32 v94, v84, v85
    v_cvt_pk_bf16_f32 v95, v86, v87
    buffer_store_dwordx4 v[92:95], v14, s[24:27], s91 offen offset:2048 sc1
    v_max_f32 v88, 0, v88
    v_max_f32 v89, 0, v89
    v_max_f32 v90, 0, v90
    v_max_f32 v91, 0, v91
    v_pk_mul_f32 v[100:101], v[100:101], v[242:243] op_sel_hi:[1,0]
    v_pk_mul_f32 v[102:103], v[102:103], v[242:243] op_sel_hi:[1,0]
    v_pk_mul_f32 v[88:89], v[88:89], v[100:101]
    v_pk_mul_f32 v[90:91], v[90:91], v[102:103]
    v_cvt_pk_bf16_f32 v100, v88, v89
    v_cvt_pk_bf16_f32 v101, v90, v91
    buffer_store_dwordx2 v[100:101], v10, s[24:27], s92 offen offset:3072 sc1
    v_max_f32 v104, 0, v104
    v_max_f32 v105, 0, v105
    v_max_f32 v106, 0, v106
    v_max_f32 v107, 0, v107
    v_pk_mul_f32 v[116:117], v[116:117], v[246:247] op_sel_hi:[1,0]
    v_pk_mul_f32 v[118:119], v[118:119], v[246:247] op_sel_hi:[1,0]
    v_pk_mul_f32 v[104:105], v[104:105], v[116:117]
    v_pk_mul_f32 v[106:107], v[106:107], v[118:119]
    v_max_f32 v108, 0, v108
    v_max_f32 v109, 0, v109
    v_max_f32 v110, 0, v110
    v_max_f32 v111, 0, v111
    v_pk_mul_f32 v[120:121], v[120:121], v[246:247] op_sel_hi:[1,0]
    v_pk_mul_f32 v[122:123], v[122:123], v[246:247] op_sel_hi:[1,0]
    v_pk_mul_f32 v[108:109], v[108:109], v[120:121]
    v_pk_mul_f32 v[110:111], v[110:111], v[122:123]
    v_cvt_pk_bf16_f32 v116, v104, v105
    v_cvt_pk_bf16_f32 v117, v106, v107
    v_cvt_pk_bf16_f32 v118, v108, v109
    v_cvt_pk_bf16_f32 v119, v110, v111
    buffer_store_dwordx4 v[116:119], v15, s[24:27], s91 offen offset:2048 sc1
    v_max_f32 v112, 0, v112
    v_max_f32 v113, 0, v113
    v_max_f32 v114, 0, v114
    v_max_f32 v115, 0, v115
    v_pk_mul_f32 v[124:125], v[124:125], v[246:247] op_sel_hi:[1,0]
    v_pk_mul_f32 v[126:127], v[126:127], v[246:247] op_sel_hi:[1,0]
    v_pk_mul_f32 v[112:113], v[112:113], v[124:125]
    v_pk_mul_f32 v[114:115], v[114:115], v[126:127]
    v_cvt_pk_bf16_f32 v124, v112, v113
    v_cvt_pk_bf16_f32 v125, v114, v115
    buffer_store_dwordx2 v[124:125], v11, s[24:27], s92 offen offset:3072 sc1
    s_waitcnt vmcnt(0)
    buffer_store_dword v12, v13, s[52:55], s94 offen sc1
    s_mov_b32 s33, 0
Lfap:
    buffer_load_dword v253, v255, s[52:55], s36 offen sc1
    s_add_u32 s33, s33, 1
    s_waitcnt vmcnt(0)
    v_cmp_ne_u32 vcc, s3, v253
    s_nop 1
    s_cbranch_vccz Lfap_ok
    s_cmp_gt_u32 s33, 0x10000
    s_cbranch_scc1 Lfap_ok
    s_branch Lfap
Lfap_ok:
    buffer_load_dwordx4 a[0:3], v236, s[8:11], s44 offen offset:0 sc1
    buffer_load_dwordx4 a[4:7], v236, s[8:11], s44 offen offset:1024 sc1
    buffer_load_dwordx4 a[8:11], v236, s[8:11], s45 offen offset:0 sc1
    buffer_load_dwordx4 a[12:15], v236, s[8:11], s45 offen offset:1024 sc1
    buffer_load_dwordx4 a[16:19], v237, s[8:11], s44 offen offset:0 sc1
    buffer_load_dwordx4 a[20:23], v237, s[8:11], s44 offen offset:1024 sc1
    buffer_load_dwordx4 a[24:27], v237, s[8:11], s45 offen offset:0 sc1
    buffer_load_dwordx4 a[28:31], v237, s[8:11], s45 offen offset:1024 sc1
    buffer_load_dwordx4 a[32:35], v238, s[8:11], s44 offen offset:0 sc1
    buffer_load_dwordx4 a[36:39], v238, s[8:11], s44 offen offset:1024 sc1
    buffer_load_dwordx4 a[40:43], v238, s[8:11], s45 offen offset:0 sc1
    buffer_load_dwordx4 a[44:47], v238, s[8:11], s45 offen offset:1024 sc1
    s_waitcnt vmcnt(0)
    s_branch Lfa_back
Lfb:
    s_mov_b32 s33, 0
Lfbp:
    buffer_load_dword v253, v255, s[52:55], s40 offen sc1
    s_add_u32 s33, s33, 1
    s_waitcnt vmcnt(0)
    v_cmp_ne_u32 vcc, s3, v253
    s_nop 1
    s_cbranch_vccz Lfbp_ok
    s_cmp_gt_u32 s33, 0x10000
    s_cbranch_scc1 Lfbp_ok
    s_branch Lfbp
Lfbp_ok:
    s_branch Lfb_back
Lwarm_end:
    s_endpgm
Lrs0:
    s_call_b64 s[34:35], Lrare1
    s_branch Lrb0
Lrs1:
    s_call_b64 s[34:35], Lrare0
    s_branch Lrb1
Lrs2:
    s_call_b64 s[34:35], Lrare1
    s_branch Lrb2
Lrs3:
    s_call_b64 s[34:35], Lrare0
    s_branch Lrb3
Lrs4:
    s_call_b64 s[34:35], Lrare1
    s_branch Lrb4
Lrs5:
    s_call_b64 s[34:35], Lrare0
    s_branch Lrb5
Lrs6:
    s_call_b64 s[34:35], Lrare1
    s_branch Lrb6
Lrs7:
    s_call_b64 s[34:35], Lrare0
    s_branch Lrb7
Lrs8:
    s_call_b64 s[34:35], Lrare1
    s_branch Lrb8
Lrs9:
    s_call_b64 s[34:35], Lrare0
    s_branch Lrb9
Lrs10:
    s_call_b64 s[34:35], Lrare1
    s_branch Lrb10
Lrs11:
    s_call_b64 s[34:35], Lrare0
    s_branch Lrb11
Lrs12:
    s_call_b64 s[34:35], Lrare1
    s_branch Lrb12
Lrs13:
    s_call_b64 s[34:35], Lrare0
    s_branch Lrb13
Lrs14:
    s_call_b64 s[34:35], Lrare1
    s_branch Lrb14
Lrs15:
    s_call_b64 s[34:35], Lrare0
    s_branch Lrb15
Lrs16:
    s_call_b64 s[34:35], Lrare1
    s_branch Lrb16
Lrare0:
    s_nop 15
    v_mov_b32 v188, 0
    v_mov_b32 v189, 0
    v_mov_b32 v190, 0
    v_mov_b32 v191, 0
    s_nop 1
    v_smfmac_f32_16x16x64_bf16 v[188:191], v[208:211], v[112:119], v255
    s_nop 7
    v_sub_f32 v152, v152, v188
    v_sub_f32 v153, v153, v189
    v_sub_f32 v154, v154, v190
    v_sub_f32 v155, v155, v191
    v_max_f32 v152, 0, v152
    v_max_f32 v153, 0, v153
    v_max_f32 v154, 0, v154
    v_max_f32 v155, 0, v155
    v_max3_f32 v194, v80, v81, v82
    v_max3_f32 v194, v194, v83, v84
    v_max3_f32 v194, v194, v85, v86
    v_max_f32 v194, v194, v87
    v_mov_b32 v195, v194
    s_nop 1
    v_permlane32_swap_b32 v194, v195
    v_max_f32 v194, v194, v195
    v_mov_b32 v195, v194
    s_nop 1
    v_permlane16_swap_b32 v194, v195
    v_max_f32 v194, v194, v195
    v_add_f32 v194, 0x42300000, v194
    v_max_f32 v194, 0, v194
    v_exp_f32_e64 v196, -v194
    v_sub_f32 v80, v80, v194
    v_sub_f32 v81, v81, v194
    v_sub_f32 v82, v82, v194
    v_sub_f32 v83, v83, v194
    v_sub_f32 v84, v84, v194
    v_sub_f32 v85, v85, v194
    v_sub_f32 v86, v86, v194
    v_sub_f32 v87, v87, v194
    v_sub_f32 v128, v128, v194
    v_sub_f32 v129, v129, v194
    v_sub_f32 v130, v130, v194
    v_sub_f32 v131, v131, v194
    v_cmp_gt_u32 vcc, 32, v1
    s_nop 1
    v_cndmask_b32 v188, 1.0, v196, vcc
    v_mov_b32 v195, 1.0
    v_cndmask_b32 v189, v196, v195, vcc
    v_mul_f32 v152, v152, v188
    v_mul_f32 v153, v153, v188
    v_mul_f32 v154, v154, v189
    v_mul_f32 v155, v155, v189
    v_accvgpr_read_b32 v195, a0
    v_mul_f32 v195, v195, v196
    v_accvgpr_write_b32 a0, v195
    v_accvgpr_read_b32 v195, a1
    v_mul_f32 v195, v195, v196
    v_accvgpr_write_b32 a1, v195
    v_accvgpr_read_b32 v195, a2
    v_mul_f32 v195, v195, v196
    v_accvgpr_write_b32 a2, v195
    v_accvgpr_read_b32 v195, a3
    v_mul_f32 v195, v195, v196
    v_accvgpr_write_b32 a3, v195
    v_accvgpr_read_b32 v195, a4
    v_mul_f32 v195, v195, v196
    v_accvgpr_write_b32 a4, v195
    v_accvgpr_read_b32 v195, a5
    v_mul_f32 v195, v195, v196
    v_accvgpr_write_b32 a5, v195
    v_accvgpr_read_b32 v195, a6
    v_mul_f32 v195, v195, v196
    v_accvgpr_write_b32 a6, v195
    v_accvgpr_read_b32 v195, a7
    v_mul_f32 v195, v195, v196
    v_accvgpr_write_b32 a7, v195
    v_accvgpr_read_b32 v195, a8
    v_mul_f32 v195, v195, v196
    v_accvgpr_write_b32 a8, v195
    v_accvgpr_read_b32 v195, a9
    v_mul_f32 v195, v195, v196
    v_accvgpr_write_b32 a9, v195
    v_accvgpr_read_b32 v195, a10
    v_mul_f32 v195, v195, v196
    v_accvgpr_write_b32 a10, v195
    v_accvgpr_read_b32 v195, a11
    v_mul_f32 v195, v195, v196
    v_accvgpr_write_b32 a11, v195
    v_accvgpr_read_b32 v195, a12
    v_mul_f32 v195, v195, v196
    v_accvgpr_write_b32 a12, v195
    v_accvgpr_read_b32 v195, a13
    v_mul_f32 v195, v195, v196
    v_accvgpr_write_b32 a13, v195
    v_accvgpr_read_b32 v195, a14
    v_mul_f32 v195, v195, v196
    v_accvgpr_write_b32 a14, v195
    v_accvgpr_read_b32 v195, a15
    v_mul_f32 v195, v195, v196
    v_accvgpr_write_b32 a15, v195
    v_accvgpr_read_b32 v195, a16
    v_mul_f32 v195, v195, v196
    v_accvgpr_write_b32 a16, v195
    v_accvgpr_read_b32 v195, a17
    v_mul_f32 v195, v195, v196
    v_accvgpr_write_b32 a17, v195
    v_accvgpr_read_b32 v195, a18
    v_mul_f32 v195, v195, v196
    v_accvgpr_write_b32 a18, v195
    v_accvgpr_read_b32 v195, a19
    v_mul_f32 v195, v195, v196
    v_accvgpr_write_b32 a19, v195
    v_accvgpr_read_b32 v195, a20
    v_mul_f32 v195, v195, v196
    v_accvgpr_write_b32 a20, v195
    v_accvgpr_read_b32 v195, a21
    v_mul_f32 v195, v195, v196
    v_accvgpr_write_b32 a21, v195
    v_accvgpr_read_b32 v195, a22
    v_mul_f32 v195, v195, v196
    v_accvgpr_write_b32 a22, v195
    v_accvgpr_read_b32 v195, a23
    v_mul_f32 v195, v195, v196
    v_accvgpr_write_b32 a23, v195
    v_accvgpr_read_b32 v195, a24
    v_mul_f32 v195, v195, v196
    v_accvgpr_write_b32 a24, v195
    v_accvgpr_read_b32 v195, a25
    v_mul_f32 v195, v195, v196
    v_accvgpr_write_b32 a25, v195
    v_accvgpr_read_b32 v195, a26
    v_mul_f32 v195, v195, v196
    v_accvgpr_write_b32 a26, v195
    v_accvgpr_read_b32 v195, a27
    v_mul_f32 v195, v195, v196
    v_accvgpr_write_b32 a27, v195
    v_accvgpr_read_b32 v195, a28
    v_mul_f32 v195, v195, v196
    v_accvgpr_write_b32 a28, v195
    v_accvgpr_read_b32 v195, a29
    v_mul_f32 v195, v195, v196
    v_accvgpr_write_b32 a29, v195
    v_accvgpr_read_b32 v195, a30
    v_mul_f32 v195, v195, v196
    v_accvgpr_write_b32 a30, v195
    v_accvgpr_read_b32 v195, a31
    v_mul_f32 v195, v195, v196
    v_accvgpr_write_b32 a31, v195
    v_exp_f32 v197, v80
    v_exp_f32 v198, v81
    s_nop 0
    v_cvt_pk_bf16_f32 v112, v197, v198
    v_exp_f32 v197, v82
    v_exp_f32 v198, v83
    s_nop 0
    v_cvt_pk_bf16_f32 v113, v197, v198
    v_exp_f32 v197, v84
    v_exp_f32 v198, v85
    s_nop 0
    v_cvt_pk_bf16_f32 v114, v197, v198
    v_exp_f32 v197, v86
    v_exp_f32 v198, v87
    s_nop 0
    v_cvt_pk_bf16_f32 v115, v197, v198
    v_max3_f32 v194, v88, v89, v90
    v_max3_f32 v194, v194, v91, v92
    v_max3_f32 v194, v194, v93, v94
    v_max_f32 v194, v194, v95
    v_mov_b32 v195, v194
    s_nop 1
    v_permlane32_swap_b32 v194, v195
    v_max_f32 v194, v194, v195
    v_mov_b32 v195, v194
    s_nop 1
    v_permlane16_swap_b32 v194, v195
    v_max_f32 v194, v194, v195
    v_add_f32 v194, 0x42300000, v194
    v_max_f32 v194, 0, v194
    v_exp_f32_e64 v196, -v194
    v_sub_f32 v88, v88, v194
    v_sub_f32 v89, v89, v194
    v_sub_f32 v90, v90, v194
    v_sub_f32 v91, v91, v194
    v_sub_f32 v92, v92, v194
    v_sub_f32 v93, v93, v194
    v_sub_f32 v94, v94, v194
    v_sub_f32 v95, v95, v194
    v_sub_f32 v132, v132, v194
    v_sub_f32 v133, v133, v194
    v_sub_f32 v134, v134, v194
    v_sub_f32 v135, v135, v194
    v_cmp_gt_u32 vcc, 32, v1
    s_nop 1
    v_cndmask_b32 v189, 1.0, v196, vcc
    v_mov_b32 v195, 1.0
    v_cndmask_b32 v188, v196, v195, vcc
    v_mul_f32 v152, v152, v188
    v_mul_f32 v153, v153, v188
    v_mul_f32 v154, v154, v189
    v_mul_f32 v155, v155, v189
    v_accvgpr_read_b32 v195, a32
    v_mul_f32 v195, v195, v196
    v_accvgpr_write_b32 a32, v195
    v_accvgpr_read_b32 v195, a33
    v_mul_f32 v195, v195, v196
    v_accvgpr_write_b32 a33, v195
    v_accvgpr_read_b32 v195, a34
    v_mul_f32 v195, v195, v196
    v_accvgpr_write_b32 a34, v195
    v_accvgpr_read_b32 v195, a35
    v_mul_f32 v195, v195, v196
    v_accvgpr_write_b32 a35, v195
    v_accvgpr_read_b32 v195, a36
    v_mul_f32 v195, v195, v196
    v_accvgpr_write_b32 a36, v195
    v_accvgpr_read_b32 v195, a37
    v_mul_f32 v195, v195, v196
    v_accvgpr_write_b32 a37, v195
    v_accvgpr_read_b32 v195, a38
    v_mul_f32 v195, v195, v196
    v_accvgpr_write_b32 a38, v195
    v_accvgpr_read_b32 v195, a39
    v_mul_f32 v195, v195, v196
    v_accvgpr_write_b32 a39, v195
    v_accvgpr_read_b32 v195, a40
    v_mul_f32 v195, v195, v196
    v_accvgpr_write_b32 a40, v195
    v_accvgpr_read_b32 v195, a41
    v_mul_f32 v195, v195, v196
    v_accvgpr_write_b32 a41, v195
    v_accvgpr_read_b32 v195, a42
    v_mul_f32 v195, v195, v196
    v_accvgpr_write_b32 a42, v195
    v_accvgpr_read_b32 v195, a43
    v_mul_f32 v195, v195, v196
    v_accvgpr_write_b32 a43, v195
    v_accvgpr_read_b32 v195, a44
    v_mul_f32 v195, v195, v196
    v_accvgpr_write_b32 a44, v195
    v_accvgpr_read_b32 v195, a45
    v_mul_f32 v195, v195, v196
    v_accvgpr_write_b32 a45, v195
    v_accvgpr_read_b32 v195, a46
    v_mul_f32 v195, v195, v196
    v_accvgpr_write_b32 a46, v195
    v_accvgpr_read_b32 v195, a47
    v_mul_f32 v195, v195, v196
    v_accvgpr_write_b32 a47, v195
    v_accvgpr_read_b32 v195, a48
    v_mul_f32 v195, v195, v196
    v_accvgpr_write_b32 a48, v195
    v_accvgpr_read_b32 v195, a49
    v_mul_f32 v195, v195, v196
    v_accvgpr_write_b32 a49, v195
    v_accvgpr_read_b32 v195, a50
    v_mul_f32 v195, v195, v196
    v_accvgpr_write_b32 a50, v195
    v_accvgpr_read_b32 v195, a51
    v_mul_f32 v195, v195, v196
    v_accvgpr_write_b32 a51, v195
    v_accvgpr_read_b32 v195, a52
    v_mul_f32 v195, v195, v196
    v_accvgpr_write_b32 a52, v195
    v_accvgpr_read_b32 v195, a53
    v_mul_f32 v195, v195, v196
    v_accvgpr_write_b32 a53, v195
    v_accvgpr_read_b32 v195, a54
    v_mul_f32 v195, v195, v196
    v_accvgpr_write_b32 a54, v195
    v_accvgpr_read_b32 v195, a55
    v_mul_f32 v195, v195, v196
    v_accvgpr_write_b32 a55, v195
    v_accvgpr_read_b32 v195, a56
    v_mul_f32 v195, v195, v196
    v_accvgpr_write_b32 a56, v195
    v_accvgpr_read_b32 v195, a57
    v_mul_f32 v195, v195, v196
    v_accvgpr_write_b32 a57, v195
    v_accvgpr_read_b32 v195, a58
    v_mul_f32 v195, v195, v196
    v_accvgpr_write_b32 a58, v195
    v_accvgpr_read_b32 v195, a59
    v_mul_f32 v195, v195, v196
    v_accvgpr_write_b32 a59, v195
    v_accvgpr_read_b32 v195, a60
    v_mul_f32 v195, v195, v196
    v_accvgpr_write_b32 a60, v195
    v_accvgpr_read_b32 v195, a61
    v_mul_f32 v195, v195, v196
    v_accvgpr_write_b32 a61, v195
    v_accvgpr_read_b32 v195, a62
    v_mul_f32 v195, v195, v196
    v_accvgpr_write_b32 a62, v195
    v_accvgpr_read_b32 v195, a63
    v_mul_f32 v195, v195, v196
    v_accvgpr_write_b32 a63, v195
    v_exp_f32 v197, v88
    v_exp_f32 v198, v89
    s_nop 0
    v_cvt_pk_bf16_f32 v116, v197, v198
    v_exp_f32 v197, v90
    v_exp_f32 v198, v91
    s_nop 0
    v_cvt_pk_bf16_f32 v117, v197, v198
    v_exp_f32 v197, v92
    v_exp_f32 v198, v93
    s_nop 0
    v_cvt_pk_bf16_f32 v118, v197, v198
    v_exp_f32 v197, v94
    v_exp_f32 v198, v95
    s_nop 0
    v_cvt_pk_bf16_f32 v119, v197, v198
    s_nop 1
    v_smfmac_f32_16x16x64_bf16 v[152:155], v[208:211], v[112:119], v255
    s_nop 15
    s_setpc_b64 s[34:35]
Lrare1:
    s_nop 15
    v_mov_b32 v188, 0
    v_mov_b32 v189, 0
    v_mov_b32 v190, 0
    v_mov_b32 v191, 0
    s_nop 1
    v_smfmac_f32_16x16x64_bf16 v[188:191], v[208:211], v[120:127], v255
    s_nop 7
    v_sub_f32 v156, v156, v188
    v_sub_f32 v157, v157, v189
    v_sub_f32 v158, v158, v190
    v_sub_f32 v159, v159, v191
    v_max_f32 v156, 0, v156
    v_max_f32 v157, 0, v157
    v_max_f32 v158, 0, v158
    v_max_f32 v159, 0, v159
    v_max3_f32 v194, v96, v97, v98
    v_max3_f32 v194, v194, v99, v100
    v_max3_f32 v194, v194, v101, v102
    v_max_f32 v194, v194, v103
    v_mov_b32 v195, v194
    s_nop 1
    v_permlane32_swap_b32 v194, v195
    v_max_f32 v194, v194, v195
    v_mov_b32 v195, v194
    s_nop 1
    v_permlane16_swap_b32 v194, v195
    v_max_f32 v194, v194, v195
    v_add_f32 v194, 0x42300000, v194
    v_max_f32 v194, 0, v194
    v_exp_f32_e64 v196, -v194
    v_sub_f32 v96, v96, v194
    v_sub_f32 v97, v97, v194
    v_sub_f32 v98, v98, v194
    v_sub_f32 v99, v99, v194
    v_sub_f32 v100, v100, v194
    v_sub_f32 v101, v101, v194
    v_sub_f32 v102, v102, v194
    v_sub_f32 v103, v103, v194
    v_sub_f32 v136, v136, v194
    v_sub_f32 v137, v137, v194
    v_sub_f32 v138, v138, v194
    v_sub_f32 v139, v139, v194
    v_cmp_gt_u32 vcc, 32, v1
    s_nop 1
    v_cndmask_b32 v188, 1.0, v196, vcc
    v_mov_b32 v195, 1.0
    v_cndmask_b32 v189, v196, v195, vcc
    v_mul_f32 v156, v156, v188
    v_mul_f32 v157, v157, v188
    v_mul_f32 v158, v158, v189
    v_mul_f32 v159, v159, v189
    v_accvgpr_read_b32 v195, a64
    v_mul_f32 v195, v195, v196
    v_accvgpr_write_b32 a64, v195
    v_accvgpr_read_b32 v195, a65
    v_mul_f32 v195, v195, v196
    v_accvgpr_write_b32 a65, v195
    v_accvgpr_read_b32 v195, a66
    v_mul_f32 v195, v195, v196
    v_accvgpr_write_b32 a66, v195
    v_accvgpr_read_b32 v195, a67
    v_mul_f32 v195, v195, v196
    v_accvgpr_write_b32 a67, v195
    v_accvgpr_read_b32 v195, a68
    v_mul_f32 v195, v195, v196
    v_accvgpr_write_b32 a68, v195
    v_accvgpr_read_b32 v195, a69
    v_mul_f32 v195, v195, v196
    v_accvgpr_write_b32 a69, v195
    v_accvgpr_read_b32 v195, a70
    v_mul_f32 v195, v195, v196
    v_accvgpr_write_b32 a70, v195
    v_accvgpr_read_b32 v195, a71
    v_mul_f32 v195, v195, v196
    v_accvgpr_write_b32 a71, v195
    v_accvgpr_read_b32 v195, a72
    v_mul_f32 v195, v195, v196
    v_accvgpr_write_b32 a72, v195
    v_accvgpr_read_b32 v195, a73
    v_mul_f32 v195, v195, v196
    v_accvgpr_write_b32 a73, v195
    v_accvgpr_read_b32 v195, a74
    v_mul_f32 v195, v195, v196
    v_accvgpr_write_b32 a74, v195
    v_accvgpr_read_b32 v195, a75
    v_mul_f32 v195, v195, v196
    v_accvgpr_write_b32 a75, v195
    v_accvgpr_read_b32 v195, a76
    v_mul_f32 v195, v195, v196
    v_accvgpr_write_b32 a76, v195
    v_accvgpr_read_b32 v195, a77
    v_mul_f32 v195, v195, v196
    v_accvgpr_write_b32 a77, v195
    v_accvgpr_read_b32 v195, a78
    v_mul_f32 v195, v195, v196
    v_accvgpr_write_b32 a78, v195
    v_accvgpr_read_b32 v195, a79
    v_mul_f32 v195, v195, v196
    v_accvgpr_write_b32 a79, v195
    v_accvgpr_read_b32 v195, a80
    v_mul_f32 v195, v195, v196
    v_accvgpr_write_b32 a80, v195
    v_accvgpr_read_b32 v195, a81
    v_mul_f32 v195, v195, v196
    v_accvgpr_write_b32 a81, v195
    v_accvgpr_read_b32 v195, a82
    v_mul_f32 v195, v195, v196
    v_accvgpr_write_b32 a82, v195
    v_accvgpr_read_b32 v195, a83
    v_mul_f32 v195, v195, v196
    v_accvgpr_write_b32 a83, v195
    v_accvgpr_read_b32 v195, a84
    v_mul_f32 v195, v195, v196
    v_accvgpr_write_b32 a84, v195
    v_accvgpr_read_b32 v195, a85
    v_mul_f32 v195, v195, v196
    v_accvgpr_write_b32 a85, v195
    v_accvgpr_read_b32 v195, a86
    v_mul_f32 v195, v195, v196
    v_accvgpr_write_b32 a86, v195
    v_accvgpr_read_b32 v195, a87
    v_mul_f32 v195, v195, v196
    v_accvgpr_write_b32 a87, v195
    v_accvgpr_read_b32 v195, a88
    v_mul_f32 v195, v195, v196
    v_accvgpr_write_b32 a88, v195
    v_accvgpr_read_b32 v195, a89
    v_mul_f32 v195, v195, v196
    v_accvgpr_write_b32 a89, v195
    v_accvgpr_read_b32 v195, a90
    v_mul_f32 v195, v195, v196
    v_accvgpr_write_b32 a90, v195
    v_accvgpr_read_b32 v195, a91
    v_mul_f32 v195, v195, v196
    v_accvgpr_write_b32 a91, v195
    v_accvgpr_read_b32 v195, a92
    v_mul_f32 v195, v195, v196
    v_accvgpr_write_b32 a92, v195
    v_accvgpr_read_b32 v195, a93
    v_mul_f32 v195, v195, v196
    v_accvgpr_write_b32 a93, v195
    v_accvgpr_read_b32 v195, a94
    v_mul_f32 v195, v195, v196
    v_accvgpr_write_b32 a94, v195
    v_accvgpr_read_b32 v195, a95
    v_mul_f32 v195, v195, v196
    v_accvgpr_write_b32 a95, v195
    v_exp_f32 v197, v96
    v_exp_f32 v198, v97
    s_nop 0
    v_cvt_pk_bf16_f32 v120, v197, v198
    v_exp_f32 v197, v98
    v_exp_f32 v198, v99
    s_nop 0
    v_cvt_pk_bf16_f32 v121, v197, v198
    v_exp_f32 v197, v100
    v_exp_f32 v198, v101
    s_nop 0
    v_cvt_pk_bf16_f32 v122, v197, v198
    v_exp_f32 v197, v102
    v_exp_f32 v198, v103
    s_nop 0
    v_cvt_pk_bf16_f32 v123, v197, v198
    v_max3_f32 v194, v104, v105, v106
    v_max3_f32 v194, v194, v107, v108
    v_max3_f32 v194, v194, v109, v110
    v_max_f32 v194, v194, v111
    v_mov_b32 v195, v194
    s_nop 1
    v_permlane32_swap_b32 v194, v195
    v_max_f32 v194, v194, v195
    v_mov_b32 v195, v194
    s_nop 1
    v_permlane16_swap_b32 v194, v195
    v_max_f32 v194, v194, v195
    v_add_f32 v194, 0x42300000, v194
    v_max_f32 v194, 0, v194
    v_exp_f32_e64 v196, -v194
    v_sub_f32 v104, v104, v194
    v_sub_f32 v105, v105, v194
    v_sub_f32 v106, v106, v194
    v_sub_f32 v107, v107, v194
    v_sub_f32 v108, v108, v194
    v_sub_f32 v109, v109, v194
    v_sub_f32 v110, v110, v194
    v_sub_f32 v111, v111, v194
    v_sub_f32 v140, v140, v194
    v_sub_f32 v141, v141, v194
    v_sub_f32 v142, v142, v194
    v_sub_f32 v143, v143, v194
    v_cmp_gt_u32 vcc, 32, v1
    s_nop 1
    v_cndmask_b32 v189, 1.0, v196, vcc
    v_mov_b32 v195, 1.0
    v_cndmask_b32 v188, v196, v195, vcc
    v_mul_f32 v156, v156, v188
    v_mul_f32 v157, v157, v188
    v_mul_f32 v158, v158, v189
    v_mul_f32 v159, v159, v189
    v_accvgpr_read_b32 v195, a96
    v_mul_f32 v195, v195, v196
    v_accvgpr_write_b32 a96, v195
    v_accvgpr_read_b32 v195, a97
    v_mul_f32 v195, v195, v196
    v_accvgpr_write_b32 a97, v195
    v_accvgpr_read_b32 v195, a98
    v_mul_f32 v195, v195, v196
    v_accvgpr_write_b32 a98, v195
    v_accvgpr_read_b32 v195, a99
    v_mul_f32 v195, v195, v196
    v_accvgpr_write_b32 a99, v195
    v_accvgpr_read_b32 v195, a100
    v_mul_f32 v195, v195, v196
    v_accvgpr_write_b32 a100, v195
    v_accvgpr_read_b32 v195, a101
    v_mul_f32 v195, v195, v196
    v_accvgpr_write_b32 a101, v195
    v_accvgpr_read_b32 v195, a102
    v_mul_f32 v195, v195, v196
    v_accvgpr_write_b32 a102, v195
    v_accvgpr_read_b32 v195, a103
    v_mul_f32 v195, v195, v196
    v_accvgpr_write_b32 a103, v195
    v_accvgpr_read_b32 v195, a104
    v_mul_f32 v195, v195, v196
    v_accvgpr_write_b32 a104, v195
    v_accvgpr_read_b32 v195, a105
    v_mul_f32 v195, v195, v196
    v_accvgpr_write_b32 a105, v195
    v_accvgpr_read_b32 v195, a106
    v_mul_f32 v195, v195, v196
    v_accvgpr_write_b32 a106, v195
    v_accvgpr_read_b32 v195, a107
    v_mul_f32 v195, v195, v196
    v_accvgpr_write_b32 a107, v195
    v_accvgpr_read_b32 v195, a108
    v_mul_f32 v195, v195, v196
    v_accvgpr_write_b32 a108, v195
    v_accvgpr_read_b32 v195, a109
    v_mul_f32 v195, v195, v196
    v_accvgpr_write_b32 a109, v195
    v_accvgpr_read_b32 v195, a110
    v_mul_f32 v195, v195, v196
    v_accvgpr_write_b32 a110, v195
    v_accvgpr_read_b32 v195, a111
    v_mul_f32 v195, v195, v196
    v_accvgpr_write_b32 a111, v195
    v_accvgpr_read_b32 v195, a112
    v_mul_f32 v195, v195, v196
    v_accvgpr_write_b32 a112, v195
    v_accvgpr_read_b32 v195, a113
    v_mul_f32 v195, v195, v196
    v_accvgpr_write_b32 a113, v195
    v_accvgpr_read_b32 v195, a114
    v_mul_f32 v195, v195, v196
    v_accvgpr_write_b32 a114, v195
    v_accvgpr_read_b32 v195, a115
    v_mul_f32 v195, v195, v196
    v_accvgpr_write_b32 a115, v195
    v_accvgpr_read_b32 v195, a116
    v_mul_f32 v195, v195, v196
    v_accvgpr_write_b32 a116, v195
    v_accvgpr_read_b32 v195, a117
    v_mul_f32 v195, v195, v196
    v_accvgpr_write_b32 a117, v195
    v_accvgpr_read_b32 v195, a118
    v_mul_f32 v195, v195, v196
    v_accvgpr_write_b32 a118, v195
    v_accvgpr_read_b32 v195, a119
    v_mul_f32 v195, v195, v196
    v_accvgpr_write_b32 a119, v195
    v_accvgpr_read_b32 v195, a120
    v_mul_f32 v195, v195, v196
    v_accvgpr_write_b32 a120, v195
    v_accvgpr_read_b32 v195, a121
    v_mul_f32 v195, v195, v196
    v_accvgpr_write_b32 a121, v195
    v_accvgpr_read_b32 v195, a122
    v_mul_f32 v195, v195, v196
    v_accvgpr_write_b32 a122, v195
    v_accvgpr_read_b32 v195, a123
    v_mul_f32 v195, v195, v196
    v_accvgpr_write_b32 a123, v195
    v_accvgpr_read_b32 v195, a124
    v_mul_f32 v195, v195, v196
    v_accvgpr_write_b32 a124, v195
    v_accvgpr_read_b32 v195, a125
    v_mul_f32 v195, v195, v196
    v_accvgpr_write_b32 a125, v195
    v_accvgpr_read_b32 v195, a126
    v_mul_f32 v195, v195, v196
    v_accvgpr_write_b32 a126, v195
    v_accvgpr_read_b32 v195, a127
    v_mul_f32 v195, v195, v196
    v_accvgpr_write_b32 a127, v195
    v_exp_f32 v197, v104
    v_exp_f32 v198, v105
    s_nop 0
    v_cvt_pk_bf16_f32 v124, v197, v198
    v_exp_f32 v197, v106
    v_exp_f32 v198, v107
    s_nop 0
    v_cvt_pk_bf16_f32 v125, v197, v198
    v_exp_f32 v197, v108
    v_exp_f32 v198, v109
    s_nop 0
    v_cvt_pk_bf16_f32 v126, v197, v198
    v_exp_f32 v197, v110
    v_exp_f32 v198, v111
    s_nop 0
    v_cvt_pk_bf16_f32 v127, v197, v198
    s_nop 1
    v_smfmac_f32_16x16x64_bf16 v[156:159], v[208:211], v[120:127], v255
    s_nop 15
    s_setpc_b64 s[34:35]
Llate:
    s_add_u32 s37, s36, 4
    s_mov_b32 s33, 0
Lf0:
    buffer_load_dword v14, v7, s[52:55], s36 offen sc1
    buffer_load_dword v15, v7, s[52:55], s37 offen sc1
    s_add_u32 s33, s33, 1
    s_waitcnt vmcnt(0)
    v_xor_b32 v14, s3, v14
    v_xor_b32 v15, s3, v15
    v_or_b32 v14, v14, v15
    v_cmp_ne_u32 vcc, 0, v14
    s_nop 1
    s_cbranch_vccz Lf0_ok
    s_cmp_gt_u32 s33, 0x10000
    s_cbranch_scc1 Lf0_ok
    s_branch Lf0
Lf0_ok:
    s_mov_b32 s8, s38
    s_mov_b32 s9, s39
    s_add_u32 m0, s29, 0
    s_mov_b32 s30, 0
    buffer_load_dwordx4 v224, s[8:11], s30 offen offset:0 sc1 nt lds
    buffer_load_dwordx4 v225, s[8:11], s30 offen offset:1024 sc1 nt lds
    buffer_load_dwordx4 v224, s[8:11], s30 offen offset:2048 sc1 nt lds
    buffer_load_dwordx4 v225, s[8:11], s30 offen offset:3072 sc1 nt lds
    s_add_u32 m0, s29, 65536
    s_mov_b32 s30, 4096
    buffer_load_dwordx4 v224, s[8:11], s30 offen offset:0 sc1 nt lds
    buffer_load_dwordx4 v225, s[8:11], s30 offen offset:1024 sc1 nt lds
    buffer_load_dwordx4 v224, s[8:11], s30 offen offset:2048 sc1 nt lds
    buffer_load_dwordx4 v225, s[8:11], s30 offen offset:3072 sc1 nt lds
    s_add_u32 m0, s29, 16384
    s_mov_b32 s30, 8192
    buffer_load_dwordx4 v224, s[8:11], s30 offen offset:0 sc1 nt lds
    buffer_load_dwordx4 v225, s[8:11], s30 offen offset:1024 sc1 nt lds
    buffer_load_dwordx4 v224, s[8:11], s30 offen offset:2048 sc1 nt lds
    buffer_load_dwordx4 v225, s[8:11], s30 offen offset:3072 sc1 nt lds
    s_add_u32 m0, s29, 81920
    s_mov_b32 s30, 12288
    buffer_load_dwordx4 v224, s[8:11], s30 offen offset:0 sc1 nt lds
    buffer_load_dwordx4 v225, s[8:11], s30 offen offset:1024 sc1 nt lds
    buffer_load_dwordx4 v224, s[8:11], s30 offen offset:2048 sc1 nt lds
    buffer_load_dwordx4 v225, s[8:11], s30 offen offset:3072 sc1 nt lds
    s_add_u32 m0, s29, 32768
    s_mov_b32 s30, 16384
    buffer_load_dwordx4 v224, s[8:11], s30 offen offset:0 sc1 nt lds
    buffer_load_dwordx4 v225, s[8:11], s30 offen offset:1024 sc1 nt lds
    buffer_load_dwordx4 v224, s[8:11], s30 offen offset:2048 sc1 nt lds
    buffer_load_dwordx4 v225, s[8:11], s30 offen offset:3072 sc1 nt lds
    s_add_u32 m0, s29, 98304
    s_mov_b32 s30, 20480
    buffer_load_dwordx4 v224, s[8:11], s30 offen offset:0 sc1 nt lds
    buffer_load_dwordx4 v225, s[8:11], s30 offen offset:1024 sc1 nt lds
    buffer_load_dwordx4 v224, s[8:11], s30 offen offset:2048 sc1 nt lds
    buffer_load_dwordx4 v225, s[8:11], s30 offen offset:3072 sc1 nt lds
    s_branch Lgo
Lf1:
    s_mov_b32 s33, 0
Lf1p:
    buffer_load_dword v228, v5, s[52:55], s90 offen sc1
    buffer_load_dword v229, v5, s[52:55], s91 offen sc1
    buffer_load_dword v230, v5, s[52:55], s92 offen sc1
    buffer_load_dword v231, v5, s[52:55], s93 offen sc1
    s_add_u32 s33, s33, 1
    s_waitcnt vmcnt(0)
    v_xor_b32 v228, s3, v228
    v_xor_b32 v229, s3, v229
    v_xor_b32 v230, s3, v230
    v_xor_b32 v231, s3, v231
    v_or_b32 v228, v228, v229
    v_or_b32 v228, v228, v230
    v_or_b32 v228, v228, v231
    v_cmp_ne_u32 vcc, 0, v228
    s_nop 1
    s_cbranch_vccz Lf1p_ok
    s_cmp_gt_u32 s33, 0x10000
    s_cbranch_scc1 Lf1p_ok
    s_branch Lf1p
Lf1p_ok:
    s_branch Lf1_back
Lpx:
    s_mov_b32 s33, 0
Lpxp:
    buffer_load_dword v14, v9, s[52:55], s23 offen sc1
    s_add_u32 s33, s33, 1
    s_waitcnt vmcnt(0)
    v_cmp_ne_u32 vcc, s3, v14
    s_nop 1
    s_cbranch_vccz Lpxp_ok
    s_cmp_gt_u32 s33, 0x10000
    s_cbranch_scc1 Lpxp_ok
    s_branch Lpxp
Lpxp_ok:
    s_branch Lpx_back

.section .rodata,"a"
.p2align 6
.amdhsa_kernel adaLN_cond__gqa_block_cached__glu_gated_reglu__prompt_kernel
  .amdhsa_next_free_vgpr 512
  .amdhsa_next_free_sgpr 102
  .amdhsa_accum_offset 256
  .amdhsa_group_segment_fixed_size 0
  .amdhsa_kernarg_size 112
  .amdhsa_user_sgpr_count 2
  .amdhsa_user_sgpr_kernarg_segment_ptr 1
  .amdhsa_system_sgpr_workgroup_id_x 1
.end_amdhsa_kernel
```
